```python
import torch

def _softmax(x, axis=-1):
    return torch.softmax(x, dim=axis)
def _gelu(x):
    return torch.nn.functional.gelu(x, approximate="tanh")
def _silu(x):
    return torch.nn.functional.silu(x)
def _sigmoid(x):
    return torch.sigmoid(x)
def _layernorm(x, axis=-1, eps=1e-5):
    m = x.mean(dim=axis, keepdim=True)
    v = x.var(dim=axis, keepdim=True, unbiased=False)
    return (x - m) / torch.sqrt(v + eps)
def _scatter_add(tgt, idx, src, axis=0):
    return tgt.clone().index_add_(axis, idx, src)
def _segment_sum(src, seg, n):
    out = torch.zeros((n,) + src.shape[1:], dtype=src.dtype)
    return out.index_add_(0, seg, src)
def _pad(x, pw):
    flat = tuple(v for pair in reversed(pw) for v in pair)
    return torch.nn.functional.pad(x, flat)

kernel_name = 'standalone__modern_conv_block_convnext_v2__vision'

def setup_inputs():

    _w = (lambda a: (lambda t: t.to(torch.bfloat16) if t.is_floating_point() else t)(torch.as_tensor(a)))
    H = W = 384
    C = 192
    K = 1
    return {
        "x": _w((lambda *s: torch.randn(*s, dtype=torch.bfloat16) * 0.05)(1, H, W, C)),
        "dw": _w((lambda *s: torch.randn(*s, dtype=torch.bfloat16) * 0.05)(K, K, C)),
        "w1": _w((lambda *s: torch.randn(*s, dtype=torch.bfloat16) * 0.05)(C, 4 * C)),
        "w2": _w((lambda *s: torch.randn(*s, dtype=torch.bfloat16) * 0.05)(4 * C, C)),
        "grn_gamma": _w((lambda *s: torch.randn(*s, dtype=torch.bfloat16) * 0.05)(4 * C)),
        "grn_beta": _w((lambda *s: torch.randn(*s, dtype=torch.bfloat16) * 0.05)(4 * C)),
    }

def reference(x, dw, w1, w2, grn_gamma, grn_beta):
    B, H, W, C = x.shape
    K = dw.shape[0]
    pad = K // 2
    xp = _pad(x, ((0,0),(pad,pad),(pad,pad),(0,0)))
    out = torch.zeros_like(x)
    for i in range(K):
        for j in range(K):
            out = out + xp[:, i:i+H, j:j+W, :] * dw[i, j][None, None, None, :]
    h = _layernorm(out, axis=-1)
    h = torch.einsum('bhwc,ce->bhwe', h, w1)
    h = _gelu(h)
    gx = torch.sqrt((h * h).sum(axis=(1, 2), keepdims=True) + 1e-6)
    nx = gx / (gx.mean(axis=-1, keepdims=True) + 1e-6)
    h = grn_gamma * (h * nx) + grn_beta + h
    h = torch.einsum('bhwe,ec->bhwc', h, w2)
    return x + h
```

```asm
; @launch grid=(256,1,1) block=(256,1,1) lds=163840
.amdgcn_target "amdgcn-amd-amdhsa--gfx950"
.text
.globl standalone__modern_conv_block_convnext_v2__vision_kernel
.p2align 8
.type standalone__modern_conv_block_convnext_v2__vision_kernel,@function
standalone__modern_conv_block_convnext_v2__vision_kernel:
    s_cmp_ge_u32 s2, 256
    s_cbranch_scc1 L_end
    s_load_dwordx8 s[8:15], s[0:1], 0
    s_load_dwordx4 s[56:59], s[0:1], 56
    v_lshrrev_b32 v7, 6, v0
    v_lshlrev_b32 v60, 3, v0
    v_lshlrev_b32 v64, 4, v0
    v_and_b32 v0, 63, v0
    v_readfirstlane_b32 s20, v7
    s_getpc_b64 s[80:81]
L1_pc:
    s_and_b32 s81, s81, 0xffff
    s_mov_b32 s82, L_code_end-L1_pc
    s_mov_b32 s83, 0x20000
    v_lshlrev_b32 v179, 7, v0
    s_sub_u32 s84, s20, 2
    s_lshl_b32 s84, s84, 13
    buffer_load_dword v224, v179, s[80:83], s84 offen
    s_mul_i32 s3, s2, 221184
    s_mul_i32 s4, s2, 589824
    s_add_u32 s4, s4, 0
    s_mul_i32 s5, s2, 2304
    s_add_u32 s5, s5, 251658240
    s_mul_i32 s21, s20, 3072
    v_lshl_add_u32 v4, v0, 4, s21
    v_lshrrev_b32 v8, 4, v0
    v_bfe_u32 v9, v0, 2, 2
    v_and_b32 v10, 3, v0
    v_lshlrev_b32 v10, 4, v10
    v_xor_b32 v11, v8, v9
    v_lshl_add_u32 v1, v11, 6, v10
    v_mul_u32_u24 v11, 1536, v8
    v_add_u32 v1, v1, v11
    v_lshl_add_u32 v1, v7, 8, v1
    v_xor_b32 v11, v8, v9
    v_and_b32 v11, 1, v11
    v_lshl_add_u32 v2, v11, 6, v10
    v_lshrrev_b32 v11, 3, v0
    v_mul_u32_u24 v11, 1536, v11
    v_add_u32 v2, v2, v11
    v_lshl_add_u32 v2, v7, 7, v2
    v_add_u32 v2, 1024, v2
    s_mov_b32 s54, 1
    s_and_b32 s55, s2, 7
    s_waitcnt lgkmcnt(0)
    s_mov_b32 s16, s58
    s_mov_b32 s17, s59
    s_mov_b32 s58, 256
    s_mov_b32 s59, 0x20000
    s_add_u32 s24, s8, s3
    s_addc_u32 s25, s9, 0
    s_mov_b32 s26, 221184
    s_mov_b32 s27, 0x20000
    s_add_u32 m0, s21, 32768
    s_mov_b32 s40, 0
    s_mov_b32 s44, s12
    s_mov_b32 s45, s13
    s_mov_b32 s46, 294912
    s_mov_b32 s47, 0x20000
    s_lshr_b32 s6, s2, 3
    s_lshl_b32 s6, s6, 1
    s_add_u32 s6, s6, s20
    s_mul_i32 s7, s6, 57
    s_lshr_b32 s7, s7, 11
    s_mul_i32 s7, s7, 36
    s_sub_u32 s6, s6, s7
    s_lshl_b32 s65, s6, 13
    s_cmp_lt_u32 s20, 2
    s_cselect_b32 s6, s65, 0x100000
    buffer_load_dword v225, v179, s[44:47], s6 offen
    s_lshl_b32 s6, s2, 6
    s_add_u32 s6, s6, s20
    s_cmp_lt_u32 s6, 512
    s_cselect_b32 s7, 0x3f, -1
    s_and_b32 s6, s6, s7
    s_cmp_eq_u32 s6, 0
    s_cselect_b32 s66, 0, 0x1000
    s_lshl_b32 s6, s55, 2
    s_add_u32 s6, s6, s66
    v_lshlrev_b32 v11, 20, v0
    v_mov_b32 v178, 1
    buffer_atomic_add v178, v11, s[56:59], s6 offen sc0
    buffer_load_dwordx4 v4, s[24:27], s40 offen offset:0 lds
    buffer_load_dwordx4 v4, s[24:27], s40 offen offset:1024 lds
    buffer_load_dwordx4 v4, s[24:27], s40 offen offset:2048 lds
    s_lshl_b32 s52, s20, 10
    s_add_u32 s52, s52, 65152
    v_add_u32 v200, 0, v1
    v_add_u32 v201, 6144, v1
    v_add_u32 v202, 12288, v1
    v_add_u32 v203, 18432, v1
    v_add_u32 v204, 0, v2
    v_add_u32 v205, 12288, v2
    s_mov_b32 s61, 4096
    s_mov_b32 s22, 0
    s_mov_b32 m0, s52
    s_nop 0
    buffer_load_dwordx4 v200, s[44:47], s22 offen lds
    s_add_u32 m0, m0, s61
    s_nop 0
    buffer_load_dwordx4 v201, s[44:47], s22 offen lds
    s_add_u32 m0, m0, s61
    s_nop 0
    buffer_load_dwordx4 v202, s[44:47], s22 offen lds
    s_add_u32 m0, m0, s61
    s_nop 0
    buffer_load_dwordx4 v203, s[44:47], s22 offen lds
    s_add_u32 m0, m0, s61
    s_nop 0
    buffer_load_dwordx4 v204, s[44:47], s22 offen lds
    s_add_u32 m0, m0, s61
    s_nop 0
    buffer_load_dwordx4 v205, s[44:47], s22 offen lds
    s_mov_b32 s22, 24576
    s_add_u32 m0, m0, s61
    s_nop 0
    buffer_load_dwordx4 v200, s[44:47], s22 offen lds
    s_add_u32 m0, m0, s61
    s_nop 0
    buffer_load_dwordx4 v201, s[44:47], s22 offen lds
    s_add_u32 m0, m0, s61
    s_nop 0
    buffer_load_dwordx4 v202, s[44:47], s22 offen lds
    s_add_u32 m0, m0, s61
    s_nop 0
    buffer_load_dwordx4 v203, s[44:47], s22 offen lds
    s_add_u32 m0, m0, s61
    s_nop 0
    buffer_load_dwordx4 v204, s[44:47], s22 offen lds
    s_add_u32 m0, m0, s61
    s_nop 0
    buffer_load_dwordx4 v205, s[44:47], s22 offen lds
    s_mov_b32 s22, 49152
    s_add_u32 m0, m0, s61
    s_nop 0
    buffer_load_dwordx4 v200, s[44:47], s22 offen lds
    s_add_u32 m0, m0, s61
    s_nop 0
    buffer_load_dwordx4 v201, s[44:47], s22 offen lds
    s_add_u32 m0, m0, s61
    s_nop 0
    buffer_load_dwordx4 v202, s[44:47], s22 offen lds
    s_add_u32 m0, m0, s61
    s_nop 0
    buffer_load_dwordx4 v203, s[44:47], s22 offen lds
    s_add_u32 m0, m0, s61
    s_nop 0
    buffer_load_dwordx4 v204, s[44:47], s22 offen lds
    s_add_u32 m0, m0, s61
    s_nop 0
    buffer_load_dwordx4 v205, s[44:47], s22 offen lds
    s_mov_b32 s22, 73728
    s_add_u32 m0, m0, s61
    s_nop 0
    buffer_load_dwordx4 v200, s[44:47], s22 offen lds
    s_add_u32 m0, m0, s61
    s_nop 0
    buffer_load_dwordx4 v201, s[44:47], s22 offen lds
    s_add_u32 m0, m0, s61
    s_nop 0
    buffer_load_dwordx4 v202, s[44:47], s22 offen lds
    s_add_u32 m0, m0, s61
    s_nop 0
    buffer_load_dwordx4 v203, s[44:47], s22 offen lds
    s_add_u32 m0, m0, s61
    s_nop 0
    buffer_load_dwordx4 v204, s[44:47], s22 offen lds
    s_add_u32 m0, m0, s61
    s_nop 0
    buffer_load_dwordx4 v205, s[44:47], s22 offen lds
    v_lshrrev_b32 v11, 5, v0
    v_and_b32 v8, 1, v8
    v_lshlrev_b32 v8, 5, v8
    v_lshrrev_b32 v10, 1, v10
    v_add_u32 v8, v8, v10
    v_add_u32 v8, s52, v8
    v_lshl_add_u32 v68, v11, 13, v8
    v_lshl_add_u32 v68, v9, 8, v68
    v_lshl_add_u32 v72, v11, 12, v8
    v_lshl_add_u32 v72, v9, 7, v72
    v_add_u32 v72, 16384, v72
    v_lshrrev_b32 v11, 1, v9
    v_xor_b32 v10, 1, v11
    v_lshl_add_u32 v73, v10, 6, v72
    v_lshl_add_u32 v72, v11, 6, v72
    v_xor_b32 v11, 3, v9
    v_lshl_add_u32 v71, v11, 6, v68
    v_xor_b32 v11, 2, v9
    v_lshl_add_u32 v70, v11, 6, v68
    v_xor_b32 v11, 1, v9
    v_lshl_add_u32 v69, v11, 6, v68
    v_xor_b32 v11, 0, v9
    v_lshl_add_u32 v68, v11, 6, v68
    v_add_u32 v190, 49152, v68
    v_add_u32 v191, 49152, v69
    v_add_u32 v192, 49152, v70
    v_add_u32 v193, 49152, v71
    v_add_u32 v194, 49152, v72
    v_add_u32 v195, 49152, v73
    v_add_u32 v65, 1, v60
    v_lshl_or_b32 v60, v65, 16, v60
    v_add_u32 v61, 0x20002, v60
    v_add_u32 v62, 0x40004, v60
    v_add_u32 v63, 0x60006, v60
    v_mov_b32 v65, 0x8000
    s_mov_b32 s62, 0x409d30fc
    s_mov_b32 s63, 0x409d30fc
    s_mov_b32 s64, 0xffff0000
    s_add_u32 s28, s16, s4
    s_addc_u32 s29, s17, 0
    s_mov_b32 s30, 589824
    s_mov_b32 s31, 0x20000
    s_add_u32 s32, s16, s5
    s_addc_u32 s33, s17, 0
    s_mov_b32 s34, 2304
    s_mov_b32 s35, 0x20000
    s_mov_b32 s41, 0
    s_mov_b32 s42, 0
    v_and_b32 v8, 7, v0
    v_and_b32 v11, 31, v0
    v_lshrrev_b32 v9, 5, v0
    v_mul_u32_u24 v1, 528, v9
    v_lshl_add_u32 v1, v11, 4, v1
    v_lshrrev_b32 v5, 4, v11
    v_lshlrev_b32 v5, 14, v5
    v_lshl_add_u32 v5, v9, 8, v5
    v_and_b32 v11, 15, v0
    v_lshl_add_u32 v5, v11, 4, v5
    v_lshl_add_u32 v5, v7, 12, v5
    v_lshrrev_b32 v9, 3, v0
    v_lshl_add_u32 v11, v7, 3, v9
    v_mul_u32_u24 v2, 528, v8
    v_lshl_add_u32 v2, v11, 4, v2
    v_mul_u32_u24 v3, 384, v11
    v_lshl_add_u32 v3, v8, 4, v3
    v_add_u32 v3, 32768, v3
    v_lshlrev_b32 v6, 2, v11
    v_lshl_add_u32 v6, v8, 28, v6
    s_mov_b32 s68, 0x08000800
    v_add_u32 v44, 0, v60
    v_add_u32 v45, 0, v61
    v_add_u32 v46, 0, v62
    v_add_u32 v47, 0, v63
    v_lshl_or_b32 v36, v44, 16, v65
    v_and_or_b32 v37, v44, s64, v65
    v_lshl_or_b32 v38, v45, 16, v65
    v_and_or_b32 v39, v45, s64, v65
    v_lshl_or_b32 v40, v46, 16, v65
    v_and_or_b32 v41, v46, s64, v65
    v_lshl_or_b32 v42, v47, 16, v65
    v_and_or_b32 v43, v47, s64, v65
    v_pk_fma_f32 v[44:45], v[36:37], v[36:37], s[62:63]
    v_pk_fma_f32 v[46:47], v[38:39], v[38:39], s[62:63]
    v_pk_fma_f32 v[48:49], v[40:41], v[40:41], s[62:63]
    v_pk_fma_f32 v[50:51], v[42:43], v[42:43], s[62:63]
    v_pk_mul_f32 v[44:45], v[44:45], v[36:37]
    v_pk_mul_f32 v[46:47], v[46:47], v[38:39]
    v_pk_mul_f32 v[48:49], v[48:49], v[40:41]
    v_pk_mul_f32 v[50:51], v[50:51], v[42:43]
    v_exp_f32_e64 v44, -v44
    v_exp_f32_e64 v45, -v45
    v_exp_f32_e64 v46, -v46
    v_exp_f32_e64 v47, -v47
    v_exp_f32_e64 v48, -v48
    v_exp_f32_e64 v49, -v49
    v_exp_f32_e64 v50, -v50
    v_exp_f32_e64 v51, -v51
    v_pk_add_f32 v[44:45], v[44:45], 1.0 op_sel_hi:[1,0]
    v_pk_add_f32 v[46:47], v[46:47], 1.0 op_sel_hi:[1,0]
    v_pk_add_f32 v[48:49], v[48:49], 1.0 op_sel_hi:[1,0]
    v_pk_add_f32 v[50:51], v[50:51], 1.0 op_sel_hi:[1,0]
    v_rcp_f32 v44, v44
    v_rcp_f32 v45, v45
    v_rcp_f32 v46, v46
    v_rcp_f32 v47, v47
    v_rcp_f32 v48, v48
    v_rcp_f32 v49, v49
    v_rcp_f32 v50, v50
    v_rcp_f32 v51, v51
    v_pk_mul_f32 v[36:37], v[36:37], v[44:45]
    v_pk_mul_f32 v[38:39], v[38:39], v[46:47]
    v_pk_mul_f32 v[40:41], v[40:41], v[48:49]
    v_pk_mul_f32 v[42:43], v[42:43], v[50:51]
    v_cvt_pk_bf16_f32 v78, v36, v37
    v_cvt_pk_bf16_f32 v79, v38, v39
    v_cvt_pk_bf16_f32 v80, v40, v41
    v_cvt_pk_bf16_f32 v81, v42, v43
    v_add_u32 v44, 939538432, v60
    v_add_u32 v45, 939538432, v61
    v_add_u32 v46, 939538432, v62
    v_add_u32 v47, 939538432, v63
    v_lshl_or_b32 v36, v44, 16, v65
    v_and_or_b32 v37, v44, s64, v65
    s_add_u32 m0, s21, 49152
    s_mov_b32 s40, 12288
    buffer_load_dwordx4 v4, s[24:27], s40 offen offset:0 lds
    buffer_load_dwordx4 v4, s[24:27], s40 offen offset:1024 lds
    buffer_load_dwordx4 v4, s[24:27], s40 offen offset:2048 lds
    s_mov_b32 s36, s10
    s_mov_b32 s37, s11
    s_mov_b32 s38, 384
    s_mov_b32 s39, 0x20000
    v_and_b32 v206, 7, v0
    v_lshlrev_b32 v206, 4, v206
    buffer_load_dwordx4 v[16:19], v206, s[36:39], 0 offen offset:0
    buffer_load_dwordx4 v[24:27], v206, s[36:39], 0 offen offset:128
    buffer_load_dwordx4 v[32:35], v206, s[36:39], 0 offen offset:256
    v_lshrrev_b32 v11, 5, v0
    v_lshlrev_b32 v11, 4, v11
    s_lshr_b32 s60, s2, 1
    s_lshl_b32 s6, s60, 5
    buffer_load_dwordx4 v[220:223], v11, s[36:39], s6 offen
    s_waitcnt vmcnt(25)
    ds_read_b64_tr_b16 a[0:1], v68 offset:0
    ds_read_b64_tr_b16 a[2:3], v68 offset:4096
    ds_read_b64_tr_b16 a[48:49], v69 offset:0
    ds_read_b64_tr_b16 a[50:51], v69 offset:4096
    ds_read_b64_tr_b16 a[96:97], v70 offset:0
    ds_read_b64_tr_b16 a[98:99], v70 offset:4096
    ds_read_b64_tr_b16 a[144:145], v71 offset:0
    ds_read_b64_tr_b16 a[146:147], v71 offset:4096
    ds_read_b64_tr_b16 a[192:193], v72 offset:0
    ds_read_b64_tr_b16 a[194:195], v72 offset:512
    ds_read_b64_tr_b16 a[240:241], v73 offset:0
    ds_read_b64_tr_b16 a[242:243], v73 offset:512
    s_mov_b32 s48, s14
    s_mov_b32 s49, s15
    s_mov_b32 s50, 294912
    s_mov_b32 s51, 0x20000
    s_cmp_ge_u32 s20, 2
    s_cselect_b32 s6, s65, 0x100000
    s_cmp_lt_u32 s2, 72
    s_cselect_b32 s6, s6, 0x100000
    buffer_load_dword v196, v179, s[48:51], s6 offen
    v_lshl_or_b32 v38, v45, 16, v65
    v_and_or_b32 v39, v45, s64, v65
    v_lshl_or_b32 v40, v46, 16, v65
    v_and_or_b32 v41, v46, s64, v65
    v_lshl_or_b32 v42, v47, 16, v65
    v_and_or_b32 v43, v47, s64, v65
    v_pk_fma_f32 v[44:45], v[36:37], v[36:37], s[62:63]
    v_pk_fma_f32 v[46:47], v[38:39], v[38:39], s[62:63]
    v_pk_fma_f32 v[48:49], v[40:41], v[40:41], s[62:63]
    v_pk_fma_f32 v[50:51], v[42:43], v[42:43], s[62:63]
    v_pk_mul_f32 v[44:45], v[44:45], v[36:37]
    v_pk_mul_f32 v[46:47], v[46:47], v[38:39]
    v_pk_mul_f32 v[48:49], v[48:49], v[40:41]
    v_pk_mul_f32 v[50:51], v[50:51], v[42:43]
    v_exp_f32_e64 v44, -v44
    v_exp_f32_e64 v45, -v45
    v_exp_f32_e64 v46, -v46
    v_exp_f32_e64 v47, -v47
    v_exp_f32_e64 v48, -v48
    v_exp_f32_e64 v49, -v49
    v_exp_f32_e64 v50, -v50
    v_exp_f32_e64 v51, -v51
    v_pk_add_f32 v[44:45], v[44:45], 1.0 op_sel_hi:[1,0]
    v_pk_add_f32 v[46:47], v[46:47], 1.0 op_sel_hi:[1,0]
    v_pk_add_f32 v[48:49], v[48:49], 1.0 op_sel_hi:[1,0]
    v_pk_add_f32 v[50:51], v[50:51], 1.0 op_sel_hi:[1,0]
    v_rcp_f32 v44, v44
    v_rcp_f32 v45, v45
    v_rcp_f32 v46, v46
    v_rcp_f32 v47, v47
    v_rcp_f32 v48, v48
    v_rcp_f32 v49, v49
    v_rcp_f32 v50, v50
    v_rcp_f32 v51, v51
    v_pk_mul_f32 v[36:37], v[36:37], v[44:45]
    v_pk_mul_f32 v[38:39], v[38:39], v[46:47]
    v_pk_mul_f32 v[40:41], v[40:41], v[48:49]
    v_pk_mul_f32 v[42:43], v[42:43], v[50:51]
    v_cvt_pk_bf16_f32 v106, v36, v37
    v_cvt_pk_bf16_f32 v107, v38, v39
    v_cvt_pk_bf16_f32 v108, v40, v41
    v_cvt_pk_bf16_f32 v109, v42, v43
    v_add_u32 v44, 1073758208, v60
    v_add_u32 v45, 1073758208, v61
    v_add_u32 v46, 1073758208, v62
    s_mov_b32 s22, 98304
    s_add_u32 m0, s52, 0
    s_waitcnt lgkmcnt(0)
    buffer_load_dwordx4 v200, s[44:47], s22 offen lds
    s_add_u32 m0, m0, s61
    s_nop 0
    buffer_load_dwordx4 v201, s[44:47], s22 offen lds
    s_add_u32 m0, m0, s61
    s_nop 0
    buffer_load_dwordx4 v202, s[44:47], s22 offen lds
    s_add_u32 m0, m0, s61
    s_nop 0
    buffer_load_dwordx4 v203, s[44:47], s22 offen lds
    s_add_u32 m0, m0, s61
    s_nop 0
    buffer_load_dwordx4 v204, s[44:47], s22 offen lds
    s_add_u32 m0, m0, s61
    s_nop 0
    buffer_load_dwordx4 v205, s[44:47], s22 offen lds
    s_waitcnt vmcnt(26)
    ds_read_b64_tr_b16 a[4:5], v68 offset:24576
    ds_read_b64_tr_b16 a[6:7], v68 offset:28672
    ds_read_b64_tr_b16 a[52:53], v69 offset:24576
    ds_read_b64_tr_b16 a[54:55], v69 offset:28672
    ds_read_b64_tr_b16 a[100:101], v70 offset:24576
    ds_read_b64_tr_b16 a[102:103], v70 offset:28672
    ds_read_b64_tr_b16 a[148:149], v71 offset:24576
    ds_read_b64_tr_b16 a[150:151], v71 offset:28672
    ds_read_b64_tr_b16 a[196:197], v72 offset:24576
    ds_read_b64_tr_b16 a[198:199], v72 offset:25088
    ds_read_b64_tr_b16 a[244:245], v73 offset:24576
    ds_read_b64_tr_b16 a[246:247], v73 offset:25088
    s_add_u32 s36, s16, 255852544
    s_addc_u32 s37, s17, 0
    s_mov_b32 s38, 32768
    s_mov_b32 s39, 0x20000
    v_readfirstlane_b32 s54, v178
    v_mov_b32 v252, 0
    v_mov_b32 v253, 0
    v_mov_b32 v254, 0
    v_mov_b32 v255, 0
    v_lshlrev_b32 v178, 4, v0
    s_or_b32 s54, s54, s66
    s_lshl_b32 s53, s55, 12
    s_cmp_lg_u32 s54, 0
    s_cbranch_scc1 L1_nozero
    buffer_store_dwordx4 v[252:255], v178, s[36:39], s53 offen sc1
    buffer_store_dwordx4 v[252:255], v178, s[36:39], s53 offen offset:1024 sc1
    buffer_store_dwordx4 v[252:255], v178, s[36:39], s53 offen offset:2048 sc1
    buffer_store_dwordx4 v[252:255], v178, s[36:39], s53 offen offset:3072 sc1
L1_nozero:
    v_add_u32 v47, 1073758208, v63
    v_lshl_or_b32 v36, v44, 16, v65
    v_and_or_b32 v37, v44, s64, v65
    v_lshl_or_b32 v38, v45, 16, v65
    v_and_or_b32 v39, v45, s64, v65
    v_lshl_or_b32 v40, v46, 16, v65
    v_and_or_b32 v41, v46, s64, v65
    v_lshl_or_b32 v42, v47, 16, v65
    v_and_or_b32 v43, v47, s64, v65
    v_pk_fma_f32 v[44:45], v[36:37], v[36:37], s[62:63]
    v_pk_fma_f32 v[46:47], v[38:39], v[38:39], s[62:63]
    v_pk_fma_f32 v[48:49], v[40:41], v[40:41], s[62:63]
    v_pk_fma_f32 v[50:51], v[42:43], v[42:43], s[62:63]
    v_pk_mul_f32 v[44:45], v[44:45], v[36:37]
    v_pk_mul_f32 v[46:47], v[46:47], v[38:39]
    v_pk_mul_f32 v[48:49], v[48:49], v[40:41]
    v_pk_mul_f32 v[50:51], v[50:51], v[42:43]
    v_exp_f32_e64 v44, -v44
    v_exp_f32_e64 v45, -v45
    v_exp_f32_e64 v46, -v46
    v_exp_f32_e64 v47, -v47
    v_exp_f32_e64 v48, -v48
    v_exp_f32_e64 v49, -v49
    v_exp_f32_e64 v50, -v50
    v_exp_f32_e64 v51, -v51
    v_pk_add_f32 v[44:45], v[44:45], 1.0 op_sel_hi:[1,0]
    v_pk_add_f32 v[46:47], v[46:47], 1.0 op_sel_hi:[1,0]
    v_pk_add_f32 v[48:49], v[48:49], 1.0 op_sel_hi:[1,0]
    v_pk_add_f32 v[50:51], v[50:51], 1.0 op_sel_hi:[1,0]
    v_rcp_f32 v44, v44
    v_rcp_f32 v45, v45
    v_rcp_f32 v46, v46
    v_rcp_f32 v47, v47
    v_rcp_f32 v48, v48
    v_rcp_f32 v49, v49
    v_rcp_f32 v50, v50
    v_rcp_f32 v51, v51
    v_pk_mul_f32 v[36:37], v[36:37], v[44:45]
    v_pk_mul_f32 v[38:39], v[38:39], v[46:47]
    v_pk_mul_f32 v[40:41], v[40:41], v[48:49]
    v_pk_mul_f32 v[42:43], v[42:43], v[50:51]
    v_cvt_pk_bf16_f32 v110, v36, v37
    v_cvt_pk_bf16_f32 v111, v38, v39
    v_cvt_pk_bf16_f32 v112, v40, v41
    v_cvt_pk_bf16_f32 v113, v42, v43
    s_mov_b32 s22, 122880
    s_add_u32 m0, s52, 24576
    s_waitcnt lgkmcnt(0)
    buffer_load_dwordx4 v200, s[44:47], s22 offen lds
    s_add_u32 m0, m0, s61
    s_nop 0
    buffer_load_dwordx4 v201, s[44:47], s22 offen lds
    s_add_u32 m0, m0, s61
    s_nop 0
    buffer_load_dwordx4 v202, s[44:47], s22 offen lds
    s_add_u32 m0, m0, s61
    s_nop 0
    buffer_load_dwordx4 v203, s[44:47], s22 offen lds
    s_add_u32 m0, m0, s61
    s_nop 0
    buffer_load_dwordx4 v204, s[44:47], s22 offen lds
    s_add_u32 m0, m0, s61
    s_nop 0
    buffer_load_dwordx4 v205, s[44:47], s22 offen lds
    s_waitcnt vmcnt(26)
    ds_read_b64_tr_b16 a[8:9], v190 offset:0
    ds_read_b64_tr_b16 a[10:11], v190 offset:4096
    ds_read_b64_tr_b16 a[56:57], v191 offset:0
    ds_read_b64_tr_b16 a[58:59], v191 offset:4096
    ds_read_b64_tr_b16 a[104:105], v192 offset:0
    ds_read_b64_tr_b16 a[106:107], v192 offset:4096
    ds_read_b64_tr_b16 a[152:153], v193 offset:0
    ds_read_b64_tr_b16 a[154:155], v193 offset:4096
    ds_read_b64_tr_b16 a[200:201], v194 offset:0
    ds_read_b64_tr_b16 a[202:203], v194 offset:512
    ds_read_b64_tr_b16 a[248:249], v195 offset:0
    ds_read_b64_tr_b16 a[250:251], v195 offset:512
    v_add_u32 v44, 2147516416, v60
    v_add_u32 v45, 2147516416, v61
    v_add_u32 v46, 2147516416, v62
    v_add_u32 v47, 2147516416, v63
    v_lshl_or_b32 v36, v44, 16, v65
    v_and_or_b32 v37, v44, s64, v65
    v_lshl_or_b32 v38, v45, 16, v65
    v_and_or_b32 v39, v45, s64, v65
    v_lshl_or_b32 v40, v46, 16, v65
    v_and_or_b32 v41, v46, s64, v65
    v_lshl_or_b32 v42, v47, 16, v65
    v_and_or_b32 v43, v47, s64, v65
    v_pk_fma_f32 v[44:45], v[36:37], v[36:37], s[62:63]
    v_pk_fma_f32 v[46:47], v[38:39], v[38:39], s[62:63]
    v_pk_fma_f32 v[48:49], v[40:41], v[40:41], s[62:63]
    v_pk_fma_f32 v[50:51], v[42:43], v[42:43], s[62:63]
    v_pk_mul_f32 v[44:45], v[44:45], v[36:37]
    v_pk_mul_f32 v[46:47], v[46:47], v[38:39]
    v_pk_mul_f32 v[48:49], v[48:49], v[40:41]
    v_pk_mul_f32 v[50:51], v[50:51], v[42:43]
    v_exp_f32_e64 v44, -v44
    v_exp_f32_e64 v45, -v45
    v_exp_f32_e64 v46, -v46
    v_exp_f32_e64 v47, -v47
    v_exp_f32_e64 v48, -v48
    v_exp_f32_e64 v49, -v49
    v_exp_f32_e64 v50, -v50
    v_exp_f32_e64 v51, -v51
    v_pk_add_f32 v[44:45], v[44:45], 1.0 op_sel_hi:[1,0]
    v_pk_add_f32 v[46:47], v[46:47], 1.0 op_sel_hi:[1,0]
    v_pk_add_f32 v[48:49], v[48:49], 1.0 op_sel_hi:[1,0]
    v_pk_add_f32 v[50:51], v[50:51], 1.0 op_sel_hi:[1,0]
    v_rcp_f32 v44, v44
    v_rcp_f32 v45, v45
    v_rcp_f32 v46, v46
    v_rcp_f32 v47, v47
    v_rcp_f32 v48, v48
    v_rcp_f32 v49, v49
    v_rcp_f32 v50, v50
    v_rcp_f32 v51, v51
    v_pk_mul_f32 v[36:37], v[36:37], v[44:45]
    v_pk_mul_f32 v[38:39], v[38:39], v[46:47]
    v_pk_mul_f32 v[40:41], v[40:41], v[48:49]
    v_pk_mul_f32 v[42:43], v[42:43], v[50:51]
    v_cvt_pk_bf16_f32 v142, v36, v37
    s_mov_b32 s22, 147456
    s_add_u32 m0, s52, 49152
    s_waitcnt lgkmcnt(0)
    buffer_load_dwordx4 v200, s[44:47], s22 offen lds
    s_add_u32 m0, m0, s61
    s_nop 0
    buffer_load_dwordx4 v201, s[44:47], s22 offen lds
    s_add_u32 m0, m0, s61
    s_nop 0
    buffer_load_dwordx4 v202, s[44:47], s22 offen lds
    s_add_u32 m0, m0, s61
    s_nop 0
    buffer_load_dwordx4 v203, s[44:47], s22 offen lds
    s_add_u32 m0, m0, s61
    s_nop 0
    buffer_load_dwordx4 v204, s[44:47], s22 offen lds
    s_add_u32 m0, m0, s61
    s_nop 0
    buffer_load_dwordx4 v205, s[44:47], s22 offen lds
    s_waitcnt vmcnt(26)
    ds_read_b64_tr_b16 a[12:13], v190 offset:24576
    ds_read_b64_tr_b16 a[14:15], v190 offset:28672
    ds_read_b64_tr_b16 a[60:61], v191 offset:24576
    ds_read_b64_tr_b16 a[62:63], v191 offset:28672
    ds_read_b64_tr_b16 a[108:109], v192 offset:24576
    ds_read_b64_tr_b16 a[110:111], v192 offset:28672
    ds_read_b64_tr_b16 a[156:157], v193 offset:24576
    ds_read_b64_tr_b16 a[158:159], v193 offset:28672
    ds_read_b64_tr_b16 a[204:205], v194 offset:24576
    ds_read_b64_tr_b16 a[206:207], v194 offset:25088
    ds_read_b64_tr_b16 a[252:253], v195 offset:24576
    ds_read_b64_tr_b16 a[254:255], v195 offset:25088
    v_cvt_pk_bf16_f32 v143, v38, v39
    v_cvt_pk_bf16_f32 v144, v40, v41
    v_cvt_pk_bf16_f32 v145, v42, v43
    v_add_u32 v44, 3087054848, v60
    v_add_u32 v45, 3087054848, v61
    v_add_u32 v46, 3087054848, v62
    v_add_u32 v47, 3087054848, v63
    v_lshl_or_b32 v36, v44, 16, v65
    v_and_or_b32 v37, v44, s64, v65
    v_lshl_or_b32 v38, v45, 16, v65
    v_and_or_b32 v39, v45, s64, v65
    v_lshl_or_b32 v40, v46, 16, v65
    v_and_or_b32 v41, v46, s64, v65
    v_lshl_or_b32 v42, v47, 16, v65
    v_and_or_b32 v43, v47, s64, v65
    v_pk_fma_f32 v[44:45], v[36:37], v[36:37], s[62:63]
    v_pk_fma_f32 v[46:47], v[38:39], v[38:39], s[62:63]
    v_pk_fma_f32 v[48:49], v[40:41], v[40:41], s[62:63]
    v_pk_fma_f32 v[50:51], v[42:43], v[42:43], s[62:63]
    v_pk_mul_f32 v[44:45], v[44:45], v[36:37]
    v_pk_mul_f32 v[46:47], v[46:47], v[38:39]
    v_pk_mul_f32 v[48:49], v[48:49], v[40:41]
    v_pk_mul_f32 v[50:51], v[50:51], v[42:43]
    v_exp_f32_e64 v44, -v44
    v_exp_f32_e64 v45, -v45
    v_exp_f32_e64 v46, -v46
    v_exp_f32_e64 v47, -v47
    v_exp_f32_e64 v48, -v48
    v_exp_f32_e64 v49, -v49
    v_exp_f32_e64 v50, -v50
    v_exp_f32_e64 v51, -v51
    v_pk_add_f32 v[44:45], v[44:45], 1.0 op_sel_hi:[1,0]
    v_pk_add_f32 v[46:47], v[46:47], 1.0 op_sel_hi:[1,0]
    v_pk_add_f32 v[48:49], v[48:49], 1.0 op_sel_hi:[1,0]
    v_pk_add_f32 v[50:51], v[50:51], 1.0 op_sel_hi:[1,0]
    v_rcp_f32 v44, v44
    v_rcp_f32 v45, v45
    v_rcp_f32 v46, v46
    v_rcp_f32 v47, v47
    v_rcp_f32 v48, v48
    v_rcp_f32 v49, v49
    v_rcp_f32 v50, v50
    v_rcp_f32 v51, v51
    v_pk_mul_f32 v[36:37], v[36:37], v[44:45]
    v_pk_mul_f32 v[38:39], v[38:39], v[46:47]
    s_mov_b32 s22, 172032
    s_add_u32 m0, s52, 73728
    s_waitcnt lgkmcnt(0)
    buffer_load_dwordx4 v200, s[44:47], s22 offen lds
    s_add_u32 m0, m0, s61
    s_nop 0
    buffer_load_dwordx4 v201, s[44:47], s22 offen lds
    s_add_u32 m0, m0, s61
    s_nop 0
    buffer_load_dwordx4 v202, s[44:47], s22 offen lds
    s_add_u32 m0, m0, s61
    s_nop 0
    buffer_load_dwordx4 v203, s[44:47], s22 offen lds
    s_add_u32 m0, m0, s61
    s_nop 0
    buffer_load_dwordx4 v204, s[44:47], s22 offen lds
    s_add_u32 m0, m0, s61
    s_nop 0
    buffer_load_dwordx4 v205, s[44:47], s22 offen lds
    s_waitcnt vmcnt(18)
    ds_read_b64_tr_b16 a[16:17], v68 offset:0
    ds_read_b64_tr_b16 a[18:19], v68 offset:4096
    ds_read_b64_tr_b16 a[64:65], v69 offset:0
    ds_read_b64_tr_b16 a[66:67], v69 offset:4096
    ds_read_b64_tr_b16 a[112:113], v70 offset:0
    ds_read_b64_tr_b16 a[114:115], v70 offset:4096
    ds_read_b64_tr_b16 a[160:161], v71 offset:0
    ds_read_b64_tr_b16 a[162:163], v71 offset:4096
    ds_read_b64_tr_b16 a[208:209], v72 offset:0
    ds_read_b64_tr_b16 a[210:211], v72 offset:512
    ds_read_b64_tr_b16 v[224:225], v73 offset:0
    ds_read_b64_tr_b16 v[226:227], v73 offset:512
    v_pk_mul_f32 v[40:41], v[40:41], v[48:49]
    v_pk_mul_f32 v[42:43], v[42:43], v[50:51]
    v_cvt_pk_bf16_f32 v170, v36, v37
    v_cvt_pk_bf16_f32 v171, v38, v39
    v_cvt_pk_bf16_f32 v172, v40, v41
    v_cvt_pk_bf16_f32 v173, v42, v43
    v_add_u32 v44, 3221274624, v60
    v_add_u32 v45, 3221274624, v61
    v_add_u32 v46, 3221274624, v62
    v_add_u32 v47, 3221274624, v63
    v_lshl_or_b32 v36, v44, 16, v65
    v_and_or_b32 v37, v44, s64, v65
    v_lshl_or_b32 v38, v45, 16, v65
    v_and_or_b32 v39, v45, s64, v65
    v_lshl_or_b32 v40, v46, 16, v65
    v_and_or_b32 v41, v46, s64, v65
    v_lshl_or_b32 v42, v47, 16, v65
    v_and_or_b32 v43, v47, s64, v65
    v_pk_fma_f32 v[44:45], v[36:37], v[36:37], s[62:63]
    v_pk_fma_f32 v[46:47], v[38:39], v[38:39], s[62:63]
    v_pk_fma_f32 v[48:49], v[40:41], v[40:41], s[62:63]
    v_pk_fma_f32 v[50:51], v[42:43], v[42:43], s[62:63]
    v_pk_mul_f32 v[44:45], v[44:45], v[36:37]
    v_pk_mul_f32 v[46:47], v[46:47], v[38:39]
    v_pk_mul_f32 v[48:49], v[48:49], v[40:41]
    v_pk_mul_f32 v[50:51], v[50:51], v[42:43]
    v_exp_f32_e64 v44, -v44
    v_exp_f32_e64 v45, -v45
    v_exp_f32_e64 v46, -v46
    v_exp_f32_e64 v47, -v47
    v_exp_f32_e64 v48, -v48
    v_exp_f32_e64 v49, -v49
    v_exp_f32_e64 v50, -v50
    v_exp_f32_e64 v51, -v51
    v_pk_add_f32 v[44:45], v[44:45], 1.0 op_sel_hi:[1,0]
    v_pk_add_f32 v[46:47], v[46:47], 1.0 op_sel_hi:[1,0]
    v_pk_add_f32 v[48:49], v[48:49], 1.0 op_sel_hi:[1,0]
    v_pk_add_f32 v[50:51], v[50:51], 1.0 op_sel_hi:[1,0]
    v_rcp_f32 v44, v44
    v_rcp_f32 v45, v45
    v_rcp_f32 v46, v46
    v_rcp_f32 v47, v47
    v_rcp_f32 v48, v48
    v_rcp_f32 v49, v49
    v_rcp_f32 v50, v50
    s_mov_b32 s22, 196608
    s_add_u32 m0, s52, 0
    s_waitcnt lgkmcnt(0)
    buffer_load_dwordx4 v200, s[44:47], s22 offen lds
    s_add_u32 m0, m0, s61
    s_nop 0
    buffer_load_dwordx4 v201, s[44:47], s22 offen lds
    s_add_u32 m0, m0, s61
    s_nop 0
    buffer_load_dwordx4 v202, s[44:47], s22 offen lds
    s_add_u32 m0, m0, s61
    s_nop 0
    buffer_load_dwordx4 v203, s[44:47], s22 offen lds
    s_add_u32 m0, m0, s61
    s_nop 0
    buffer_load_dwordx4 v204, s[44:47], s22 offen lds
    s_add_u32 m0, m0, s61
    s_nop 0
    buffer_load_dwordx4 v205, s[44:47], s22 offen lds
    s_waitcnt vmcnt(18)
    ds_read_b64_tr_b16 a[20:21], v68 offset:24576
    ds_read_b64_tr_b16 a[22:23], v68 offset:28672
    ds_read_b64_tr_b16 a[68:69], v69 offset:24576
    ds_read_b64_tr_b16 a[70:71], v69 offset:28672
    ds_read_b64_tr_b16 a[116:117], v70 offset:24576
    ds_read_b64_tr_b16 a[118:119], v70 offset:28672
    ds_read_b64_tr_b16 a[164:165], v71 offset:24576
    ds_read_b64_tr_b16 a[166:167], v71 offset:28672
    ds_read_b64_tr_b16 a[212:213], v72 offset:24576
    ds_read_b64_tr_b16 a[214:215], v72 offset:25088
    ds_read_b64_tr_b16 v[228:229], v73 offset:24576
    ds_read_b64_tr_b16 v[230:231], v73 offset:25088
    v_rcp_f32 v51, v51
    v_pk_mul_f32 v[36:37], v[36:37], v[44:45]
    v_pk_mul_f32 v[38:39], v[38:39], v[46:47]
    v_pk_mul_f32 v[40:41], v[40:41], v[48:49]
    v_pk_mul_f32 v[42:43], v[42:43], v[50:51]
    v_cvt_pk_bf16_f32 v174, v36, v37
    v_cvt_pk_bf16_f32 v175, v38, v39
    v_cvt_pk_bf16_f32 v176, v40, v41
    v_cvt_pk_bf16_f32 v177, v42, v43
    v_add_u32 v82, 125831040, v60
    v_add_u32 v83, 125831040, v61
    v_add_u32 v84, 125831040, v62
    v_add_u32 v85, 125831040, v63
    v_add_u32 v86, s68, v82
    v_add_u32 v87, s68, v83
    v_add_u32 v88, s68, v84
    v_add_u32 v89, s68, v85
    v_add_u32 v90, s68, v86
    v_add_u32 v91, s68, v87
    v_add_u32 v92, s68, v88
    v_add_u32 v93, s68, v89
    v_add_u32 v94, s68, v90
    v_add_u32 v95, s68, v91
    v_add_u32 v96, s68, v92
    v_add_u32 v97, s68, v93
    v_add_u32 v98, s68, v94
    v_add_u32 v99, s68, v95
    v_add_u32 v100, s68, v96
    v_add_u32 v101, s68, v97
    v_add_u32 v102, s68, v98
    v_add_u32 v103, s68, v99
    v_add_u32 v104, s68, v100
    v_add_u32 v105, s68, v101
    v_add_u32 v114, 1207977984, v60
    v_add_u32 v115, 1207977984, v61
    v_add_u32 v116, 1207977984, v62
    v_add_u32 v117, 1207977984, v63
    v_add_u32 v118, s68, v114
    v_add_u32 v119, s68, v115
    v_add_u32 v120, s68, v116
    v_add_u32 v121, s68, v117
    v_add_u32 v122, s68, v118
    v_add_u32 v123, s68, v119
    v_add_u32 v124, s68, v120
    v_add_u32 v125, s68, v121
    s_mov_b32 s22, 221184
    s_add_u32 m0, s52, 24576
    s_waitcnt lgkmcnt(0)
    buffer_load_dwordx4 v200, s[44:47], s22 offen lds
    s_add_u32 m0, m0, s61
    s_nop 0
    buffer_load_dwordx4 v201, s[44:47], s22 offen lds
    s_add_u32 m0, m0, s61
    s_nop 0
    buffer_load_dwordx4 v202, s[44:47], s22 offen lds
    s_add_u32 m0, m0, s61
    s_nop 0
    buffer_load_dwordx4 v203, s[44:47], s22 offen lds
    s_add_u32 m0, m0, s61
    s_nop 0
    buffer_load_dwordx4 v204, s[44:47], s22 offen lds
    s_add_u32 m0, m0, s61
    s_nop 0
    buffer_load_dwordx4 v205, s[44:47], s22 offen lds
    s_waitcnt vmcnt(18)
    ds_read_b64_tr_b16 a[24:25], v190 offset:0
    ds_read_b64_tr_b16 a[26:27], v190 offset:4096
    ds_read_b64_tr_b16 a[72:73], v191 offset:0
    ds_read_b64_tr_b16 a[74:75], v191 offset:4096
    ds_read_b64_tr_b16 a[120:121], v192 offset:0
    ds_read_b64_tr_b16 a[122:123], v192 offset:4096
    ds_read_b64_tr_b16 a[168:169], v193 offset:0
    ds_read_b64_tr_b16 a[170:171], v193 offset:4096
    ds_read_b64_tr_b16 a[216:217], v194 offset:0
    ds_read_b64_tr_b16 a[218:219], v194 offset:512
    ds_read_b64_tr_b16 v[232:233], v195 offset:0
    ds_read_b64_tr_b16 v[234:235], v195 offset:512
    v_add_u32 v126, s68, v122
    v_add_u32 v127, s68, v123
    v_add_u32 v128, s68, v124
    v_add_u32 v129, s68, v125
    v_add_u32 v130, s68, v126
    v_add_u32 v131, s68, v127
    v_add_u32 v132, s68, v128
    v_add_u32 v133, s68, v129
    v_add_u32 v134, s68, v130
    v_add_u32 v135, s68, v131
    v_add_u32 v136, s68, v132
    v_add_u32 v137, s68, v133
    v_add_u32 v138, s68, v134
    v_add_u32 v139, s68, v135
    v_add_u32 v140, s68, v136
    v_add_u32 v141, s68, v137
    v_add_u32 v146, 2273347456, v60
    v_add_u32 v147, 2273347456, v61
    v_add_u32 v148, 2273347456, v62
    v_add_u32 v149, 2273347456, v63
    v_add_u32 v150, s68, v146
    v_add_u32 v151, s68, v147
    v_add_u32 v152, s68, v148
    v_add_u32 v153, s68, v149
    v_add_u32 v154, s68, v150
    v_add_u32 v155, s68, v151
    v_add_u32 v156, s68, v152
    v_add_u32 v157, s68, v153
    v_add_u32 v158, s68, v154
    v_add_u32 v159, s68, v155
    v_add_u32 v160, s68, v156
    v_add_u32 v161, s68, v157
    v_add_u32 v162, s68, v158
    v_add_u32 v163, s68, v159
    v_add_u32 v164, s68, v160
    v_add_u32 v165, s68, v161
    v_add_u32 v166, s68, v162
    v_add_u32 v167, s68, v163
    v_add_u32 v168, s68, v164
    v_add_u32 v169, s68, v165
    ds_read_b128 v[40:43], v3 offset:0
    ds_read_b128 v[48:51], v3 offset:128
    ds_read_b128 v[56:59], v3 offset:256
    v_lshlrev_b32 v12, 16, v16
    v_and_b32 v13, 0xffff0000, v16
    s_mov_b32 s22, 245760
    s_add_u32 m0, s52, 49152
    s_waitcnt lgkmcnt(3)
    buffer_load_dwordx4 v200, s[44:47], s22 offen lds
    s_add_u32 m0, m0, s61
    s_nop 0
    buffer_load_dwordx4 v201, s[44:47], s22 offen lds
    s_add_u32 m0, m0, s61
    s_nop 0
    buffer_load_dwordx4 v202, s[44:47], s22 offen lds
    s_add_u32 m0, m0, s61
    s_nop 0
    buffer_load_dwordx4 v203, s[44:47], s22 offen lds
    s_add_u32 m0, m0, s61
    s_nop 0
    buffer_load_dwordx4 v204, s[44:47], s22 offen lds
    s_add_u32 m0, m0, s61
    s_nop 0
    buffer_load_dwordx4 v205, s[44:47], s22 offen lds
    s_waitcnt vmcnt(18)
    ds_read_b64_tr_b16 a[28:29], v190 offset:24576
    ds_read_b64_tr_b16 a[30:31], v190 offset:28672
    ds_read_b64_tr_b16 a[76:77], v191 offset:24576
    ds_read_b64_tr_b16 a[78:79], v191 offset:28672
    ds_read_b64_tr_b16 a[124:125], v192 offset:24576
    ds_read_b64_tr_b16 a[126:127], v192 offset:28672
    ds_read_b64_tr_b16 a[172:173], v193 offset:24576
    ds_read_b64_tr_b16 a[174:175], v193 offset:28672
    ds_read_b64_tr_b16 a[220:221], v194 offset:24576
    ds_read_b64_tr_b16 a[222:223], v194 offset:25088
    ds_read_b64_tr_b16 v[236:237], v195 offset:24576
    ds_read_b64_tr_b16 v[238:239], v195 offset:25088
    s_lshl_b32 s67, s2, 2
    s_add_u32 s67, s67, s20
    s_cmp_ge_u32 s67, 288
    s_cbranch_scc1 L1_now2
    s_mul_i32 s68, s67, 57
    s_lshr_b32 s68, s68, 12
    s_mul_i32 s69, s68, 72
    s_sub_u32 s69, s67, s69
    s_mul_i32 s70, s69, 86
    s_lshr_b32 s70, s70, 8
    s_mul_i32 s71, s70, 3
    s_sub_u32 s71, s69, s71
    s_lshl_b32 s71, s71, 5
    s_mul_i32 s68, s68, 96
    s_add_u32 s71, s71, s68
    s_mul_i32 s70, s70, 12288
    s_add_u32 s70, s70, s71
    s_add_u32 s71, s70, 3072
    v_lshrrev_b32 v188, 5, v0
    v_lshlrev_b32 v188, 4, v188
    v_bfe_u32 v189, v0, 4, 1
    v_lshl_add_u32 v188, v189, 2, v188
    v_mul_u32_u24 v188, 384, v188
    v_and_b32 v189, 15, v0
    v_lshl_add_u32 v188, v189, 1, v188
    buffer_load_ushort v180, v188, s[48:51], s70 offen offset:0
    buffer_load_short_d16_hi v181, v188, s[48:51], s70 offen offset:384
    buffer_load_ushort v182, v188, s[48:51], s70 offen offset:768
    buffer_load_short_d16_hi v183, v188, s[48:51], s70 offen offset:1152
    buffer_load_ushort v184, v188, s[48:51], s71 offen offset:0
    buffer_load_short_d16_hi v185, v188, s[48:51], s71 offen offset:384
    buffer_load_ushort v186, v188, s[48:51], s71 offen offset:768
    buffer_load_short_d16_hi v187, v188, s[48:51], s71 offen offset:1152
L1_now2:
    v_lshlrev_b32 v14, 16, v17
    v_and_b32 v15, 0xffff0000, v17
    v_lshlrev_b32 v16, 16, v18
    v_and_b32 v17, 0xffff0000, v18
    v_lshlrev_b32 v18, 16, v19
    v_and_b32 v19, 0xffff0000, v19
    v_lshlrev_b32 v20, 16, v24
    v_and_b32 v21, 0xffff0000, v24
    v_lshlrev_b32 v22, 16, v25
    v_and_b32 v23, 0xffff0000, v25
    v_lshlrev_b32 v24, 16, v26
    v_and_b32 v25, 0xffff0000, v26
    v_lshlrev_b32 v26, 16, v27
    v_and_b32 v27, 0xffff0000, v27
    v_lshlrev_b32 v28, 16, v32
    v_and_b32 v29, 0xffff0000, v32
    v_lshlrev_b32 v30, 16, v33
    v_and_b32 v31, 0xffff0000, v33
    v_lshlrev_b32 v32, 16, v34
    v_and_b32 v33, 0xffff0000, v34
    v_lshlrev_b32 v34, 16, v35
    v_and_b32 v35, 0xffff0000, v35
    s_mov_b32 s40, 24576
    s_waitcnt lgkmcnt(14)
    v_lshlrev_b32 v36, 16, v40
    v_and_b32 v37, 0xffff0000, v40
    v_lshlrev_b32 v38, 16, v41
    v_and_b32 v39, 0xffff0000, v41
    v_lshlrev_b32 v40, 16, v42
    v_and_b32 v41, 0xffff0000, v42
    v_lshlrev_b32 v42, 16, v43
    v_and_b32 v43, 0xffff0000, v43
    v_mul_f32 v36, v36, v12
    v_mul_f32 v37, v37, v13
    v_mul_f32 v38, v38, v14
    v_mul_f32 v39, v39, v15
    v_mul_f32 v40, v40, v16
    v_mul_f32 v41, v41, v17
    v_mul_f32 v42, v42, v18
    v_mul_f32 v43, v43, v19
    v_mul_f32 v9, v36, v36
    v_add_f32 v8, v36, v37
    v_fmac_f32 v9, v37, v37
    v_add_f32 v8, v8, v38
    v_fmac_f32 v9, v38, v38
    v_add_f32 v8, v8, v39
    s_mov_b32 s22, 270336
    s_add_u32 m0, s52, 73728
    s_waitcnt lgkmcnt(0)
    buffer_load_dwordx4 v200, s[44:47], s22 offen lds
    s_add_u32 m0, m0, s61
    s_nop 0
    buffer_load_dwordx4 v201, s[44:47], s22 offen lds
    s_add_u32 m0, m0, s61
    s_nop 0
    buffer_load_dwordx4 v202, s[44:47], s22 offen lds
    s_add_u32 m0, m0, s61
    s_nop 0
    buffer_load_dwordx4 v203, s[44:47], s22 offen lds
    s_add_u32 m0, m0, s61
    s_nop 0
    buffer_load_dwordx4 v204, s[44:47], s22 offen lds
    s_add_u32 m0, m0, s61
    s_nop 0
    buffer_load_dwordx4 v205, s[44:47], s22 offen lds
    s_waitcnt vmcnt(18)
    ds_read_b64_tr_b16 a[32:33], v68 offset:0
    ds_read_b64_tr_b16 a[34:35], v68 offset:4096
    ds_read_b64_tr_b16 a[80:81], v69 offset:0
    ds_read_b64_tr_b16 a[82:83], v69 offset:4096
    ds_read_b64_tr_b16 a[128:129], v70 offset:0
    ds_read_b64_tr_b16 a[130:131], v70 offset:4096
    ds_read_b64_tr_b16 a[176:177], v71 offset:0
    ds_read_b64_tr_b16 a[178:179], v71 offset:4096
    ds_read_b64_tr_b16 a[224:225], v72 offset:0
    ds_read_b64_tr_b16 a[226:227], v72 offset:512
    ds_read_b64_tr_b16 v[240:241], v73 offset:0
    ds_read_b64_tr_b16 v[242:243], v73 offset:512
    v_add_u32 v64, 65152, v64
    v_add_u32 v65, 0x10000, v64
    v_fmac_f32 v9, v39, v39
    v_add_f32 v8, v8, v40
    v_fmac_f32 v9, v40, v40
    v_add_f32 v8, v8, v41
    v_fmac_f32 v9, v41, v41
    v_add_f32 v8, v8, v42
    v_fmac_f32 v9, v42, v42
    v_add_f32 v8, v8, v43
    v_fmac_f32 v9, v43, v43
    v_lshlrev_b32 v44, 16, v48
    v_and_b32 v45, 0xffff0000, v48
    v_lshlrev_b32 v46, 16, v49
    v_and_b32 v47, 0xffff0000, v49
    v_lshlrev_b32 v48, 16, v50
    v_and_b32 v49, 0xffff0000, v50
    v_lshlrev_b32 v50, 16, v51
    v_and_b32 v51, 0xffff0000, v51
    v_mul_f32 v44, v44, v20
    v_mul_f32 v45, v45, v21
    v_mul_f32 v46, v46, v22
    v_mul_f32 v47, v47, v23
    v_mul_f32 v48, v48, v24
    v_mul_f32 v49, v49, v25
    v_mul_f32 v50, v50, v26
    v_mul_f32 v51, v51, v27
    v_add_f32 v8, v8, v44
    v_fmac_f32 v9, v44, v44
    v_add_f32 v8, v8, v45
    v_fmac_f32 v9, v45, v45
    v_add_f32 v8, v8, v46
    v_fmac_f32 v9, v46, v46
    v_add_f32 v8, v8, v47
    v_fmac_f32 v9, v47, v47
    v_add_f32 v8, v8, v48
    v_fmac_f32 v9, v48, v48
    v_add_f32 v8, v8, v49
    v_fmac_f32 v9, v49, v49
    v_add_f32 v8, v8, v50
    v_fmac_f32 v9, v50, v50
    v_add_f32 v8, v8, v51
    v_fmac_f32 v9, v51, v51
    v_lshlrev_b32 v52, 16, v56
    v_and_b32 v53, 0xffff0000, v56
    v_lshlrev_b32 v54, 16, v57
    v_and_b32 v55, 0xffff0000, v57
    s_waitcnt vmcnt(12)
    ds_read_b64_tr_b16 a[36:37], v68 offset:24576
    ds_read_b64_tr_b16 a[38:39], v68 offset:28672
    ds_read_b64_tr_b16 a[84:85], v69 offset:24576
    s_waitcnt lgkmcnt(14)
    ds_read_b64_tr_b16 a[86:87], v69 offset:28672
    s_waitcnt lgkmcnt(14)
    ds_read_b64_tr_b16 a[132:133], v70 offset:24576
    s_waitcnt lgkmcnt(14)
    ds_read_b64_tr_b16 a[134:135], v70 offset:28672
    s_waitcnt lgkmcnt(14)
    ds_read_b64_tr_b16 a[180:181], v71 offset:24576
    s_waitcnt lgkmcnt(14)
    ds_read_b64_tr_b16 a[182:183], v71 offset:28672
    s_waitcnt lgkmcnt(14)
    ds_read_b64_tr_b16 a[228:229], v72 offset:24576
    s_waitcnt lgkmcnt(14)
    ds_read_b64_tr_b16 a[230:231], v72 offset:25088
    s_waitcnt lgkmcnt(14)
    ds_read_b64_tr_b16 v[244:245], v73 offset:24576
    s_waitcnt lgkmcnt(14)
    ds_read_b64_tr_b16 v[246:247], v73 offset:25088
    v_lshlrev_b32 v56, 16, v58
    v_and_b32 v57, 0xffff0000, v58
    v_lshlrev_b32 v58, 16, v59
    v_and_b32 v59, 0xffff0000, v59
    v_mul_f32 v52, v52, v28
    v_mul_f32 v53, v53, v29
    s_add_u32 m0, s21, 32768
    s_nop 0
    buffer_load_dwordx4 v4, s[24:27], s40 offen offset:0 lds
    buffer_load_dwordx4 v4, s[24:27], s40 offen offset:1024 lds
    buffer_load_dwordx4 v4, s[24:27], s40 offen offset:2048 lds
    v_mul_f32 v54, v54, v30
    v_mul_f32 v55, v55, v31
    v_mul_f32 v56, v56, v32
    v_mul_f32 v57, v57, v33
    v_mul_f32 v58, v58, v34
    v_mul_f32 v59, v59, v35
    v_add_f32 v8, v8, v52
    v_fmac_f32 v9, v52, v52
    v_add_f32 v8, v8, v53
    v_fmac_f32 v9, v53, v53
    v_add_f32 v8, v8, v54
    v_fmac_f32 v9, v54, v54
    v_add_f32 v8, v8, v55
    v_fmac_f32 v9, v55, v55
    v_add_f32 v8, v8, v56
    v_fmac_f32 v9, v56, v56
    v_add_f32 v8, v8, v57
    v_fmac_f32 v9, v57, v57
    v_add_f32 v8, v8, v58
    v_fmac_f32 v9, v58, v58
    v_add_f32 v8, v8, v59
    v_fmac_f32 v9, v59, v59
    s_nop 0
    v_add_f32_dpp v8, v8, v8 quad_perm:[1,0,3,2] row_mask:0xf bank_mask:0xf
    v_add_f32_dpp v9, v9, v9 quad_perm:[1,0,3,2] row_mask:0xf bank_mask:0xf
    s_nop 0
    v_add_f32_dpp v8, v8, v8 quad_perm:[2,3,0,1] row_mask:0xf bank_mask:0xf
    v_add_f32_dpp v9, v9, v9 quad_perm:[2,3,0,1] row_mask:0xf bank_mask:0xf
    s_nop 0
    v_add_f32_dpp v8, v8, v8 row_half_mirror row_mask:0xf bank_mask:0xf
    v_add_f32_dpp v9, v9, v9 row_half_mirror row_mask:0xf bank_mask:0xf
    v_mul_f32 v8, 0x3baaaaab, v8
    v_mul_f32 v9, 0x3baaaaab, v9
    v_fma_f32 v9, -v8, v8, v9
    v_max_f32 v9, 0, v9
    v_add_f32 v9, 0x3727c5ac, v9
    v_rsq_f32 v10, v9
    s_nop 0
    v_mul_f32 v9, 0x3eeff558, v10
    s_waitcnt vmcnt(9) lgkmcnt(14)
    ds_read_b64_tr_b16 a[40:41], v190 offset:0
    s_waitcnt lgkmcnt(14)
    ds_read_b64_tr_b16 a[42:43], v190 offset:4096
    s_waitcnt lgkmcnt(14)
    ds_read_b64_tr_b16 a[88:89], v191 offset:0
    s_waitcnt lgkmcnt(14)
    ds_read_b64_tr_b16 a[90:91], v191 offset:4096
    s_waitcnt lgkmcnt(14)
    ds_read_b64_tr_b16 a[136:137], v192 offset:0
    s_waitcnt lgkmcnt(14)
    ds_read_b64_tr_b16 a[138:139], v192 offset:4096
    s_waitcnt lgkmcnt(14)
    ds_read_b64_tr_b16 a[184:185], v193 offset:0
    s_waitcnt lgkmcnt(14)
    ds_read_b64_tr_b16 a[186:187], v193 offset:4096
    s_waitcnt lgkmcnt(14)
    ds_read_b64_tr_b16 a[232:233], v194 offset:0
    s_waitcnt lgkmcnt(14)
    ds_read_b64_tr_b16 a[234:235], v194 offset:512
    s_waitcnt lgkmcnt(14)
    ds_read_b64_tr_b16 v[248:249], v195 offset:0
    s_waitcnt lgkmcnt(14)
    ds_read_b64_tr_b16 v[250:251], v195 offset:512
    buffer_store_dword v10, v6, s[32:35], s42 offen
    v_mul_f32_e64 v11, -v8, v9
    v_fma_f32 v36, v36, v9, v11
    v_fma_f32 v37, v37, v9, v11
    v_fma_f32 v38, v38, v9, v11
    v_fma_f32 v39, v39, v9, v11
    v_fma_f32 v40, v40, v9, v11
    v_fma_f32 v41, v41, v9, v11
    v_fma_f32 v42, v42, v9, v11
    v_fma_f32 v43, v43, v9, v11
    v_cvt_pk_bf16_f32 v36, v36, v37
    v_cvt_pk_bf16_f32 v37, v38, v39
    v_cvt_pk_bf16_f32 v38, v40, v41
    v_cvt_pk_bf16_f32 v39, v42, v43
    s_waitcnt lgkmcnt(14)
    ds_write_b128 v2, v[36:39] offset:0
    v_fma_f32 v44, v44, v9, v11
    v_fma_f32 v45, v45, v9, v11
    v_fma_f32 v46, v46, v9, v11
    v_fma_f32 v47, v47, v9, v11
    v_fma_f32 v48, v48, v9, v11
    v_fma_f32 v49, v49, v9, v11
    v_fma_f32 v50, v50, v9, v11
    v_fma_f32 v51, v51, v9, v11
    v_cvt_pk_bf16_f32 v44, v44, v45
    v_cvt_pk_bf16_f32 v45, v46, v47
    v_cvt_pk_bf16_f32 v46, v48, v49
    v_cvt_pk_bf16_f32 v47, v50, v51
    s_waitcnt lgkmcnt(14)
    ds_write_b128 v2, v[44:47] offset:4224
    v_fma_f32 v52, v52, v9, v11
    v_fma_f32 v53, v53, v9, v11
    v_fma_f32 v54, v54, v9, v11
    v_fma_f32 v55, v55, v9, v11
    v_fma_f32 v56, v56, v9, v11
    v_fma_f32 v57, v57, v9, v11
    v_fma_f32 v58, v58, v9, v11
    v_fma_f32 v59, v59, v9, v11
    v_cvt_pk_bf16_f32 v52, v52, v53
    v_cvt_pk_bf16_f32 v53, v54, v55
    v_cvt_pk_bf16_f32 v54, v56, v57
    v_cvt_pk_bf16_f32 v55, v58, v59
    s_waitcnt lgkmcnt(14)
    ds_write_b128 v2, v[52:55] offset:8448
    s_waitcnt vmcnt(4) lgkmcnt(14)
    ds_read_b64_tr_b16 a[44:45], v190 offset:24576
    s_waitcnt lgkmcnt(14)
    ds_read_b64_tr_b16 a[46:47], v190 offset:28672
    s_waitcnt lgkmcnt(14)
    ds_read_b64_tr_b16 a[92:93], v191 offset:24576
    s_waitcnt lgkmcnt(14)
    ds_read_b64_tr_b16 a[94:95], v191 offset:28672
    s_waitcnt lgkmcnt(14)
    ds_read_b64_tr_b16 a[140:141], v192 offset:24576
    s_waitcnt lgkmcnt(14)
    ds_read_b64_tr_b16 a[142:143], v192 offset:28672
    s_waitcnt lgkmcnt(14)
    ds_read_b64_tr_b16 a[188:189], v193 offset:24576
    s_waitcnt lgkmcnt(14)
    ds_read_b64_tr_b16 a[190:191], v193 offset:28672
    s_waitcnt lgkmcnt(14)
    ds_read_b64_tr_b16 a[236:237], v194 offset:24576
    s_waitcnt lgkmcnt(14)
    ds_read_b64_tr_b16 a[238:239], v194 offset:25088
    s_waitcnt lgkmcnt(14)
    ds_read_b64_tr_b16 v[252:253], v195 offset:24576
    s_waitcnt lgkmcnt(14)
    ds_read_b64_tr_b16 v[254:255], v195 offset:25088
    s_add_u32 s48, s16, 254803968
    s_addc_u32 s49, s17, 0
    s_mov_b32 s50, 294912
    s_mov_b32 s51, 0x20000
    s_cmp_ge_u32 s67, 288
    s_cbranch_scc1 L1_now2b
    s_lshl_b32 s67, s67, 10
    v_or_b32 v180, v180, v181
    v_or_b32 v181, v182, v183
    v_or_b32 v182, v184, v185
    v_or_b32 v183, v186, v187
    buffer_store_dwordx4 v[180:183], v178, s[48:51], s67 offen sc1
L1_now2b:
    s_waitcnt lgkmcnt(14)
    ds_write_b128 v64, v[78:81] offset:0
    s_waitcnt lgkmcnt(14)
    ds_write_b128 v64, v[82:85] offset:4096
    s_waitcnt lgkmcnt(14)
    ds_write_b128 v64, v[86:89] offset:8192
    s_waitcnt lgkmcnt(14)
    ds_write_b128 v64, v[90:93] offset:12288
    s_waitcnt lgkmcnt(14)
    ds_write_b128 v64, v[94:97] offset:16384
    s_waitcnt lgkmcnt(14)
    ds_write_b128 v64, v[98:101] offset:20480
    s_waitcnt lgkmcnt(14)
    ds_write_b128 v64, v[102:105] offset:24576
    s_waitcnt lgkmcnt(14)
    ds_write_b128 v64, v[106:109] offset:28672
    s_waitcnt lgkmcnt(14)
    ds_write_b128 v64, v[110:113] offset:32768
    s_waitcnt lgkmcnt(14)
    ds_write_b128 v64, v[114:117] offset:36864
    s_waitcnt lgkmcnt(14)
    ds_write_b128 v64, v[118:121] offset:40960
    s_waitcnt lgkmcnt(14)
    ds_write_b128 v64, v[122:125] offset:45056
    s_waitcnt lgkmcnt(14)
    ds_write_b128 v64, v[126:129] offset:49152
    s_waitcnt lgkmcnt(14)
    ds_write_b128 v64, v[130:133] offset:53248
    s_waitcnt lgkmcnt(14)
    ds_write_b128 v64, v[134:137] offset:57344
    s_waitcnt lgkmcnt(14)
    ds_write_b128 v64, v[138:141] offset:61440
    s_waitcnt lgkmcnt(14)
    ds_write_b128 v65, v[142:145] offset:0
    s_waitcnt lgkmcnt(14)
    ds_write_b128 v65, v[146:149] offset:4096
    s_waitcnt lgkmcnt(14)
    ds_write_b128 v65, v[150:153] offset:8192
    s_waitcnt lgkmcnt(14)
    ds_write_b128 v65, v[154:157] offset:12288
    s_waitcnt lgkmcnt(14)
    ds_write_b128 v65, v[158:161] offset:16384
    s_waitcnt lgkmcnt(14)
    ds_write_b128 v65, v[162:165] offset:20480
    s_waitcnt lgkmcnt(14)
    ds_write_b128 v65, v[166:169] offset:24576
    s_waitcnt lgkmcnt(14)
    ds_write_b128 v65, v[170:173] offset:28672
    s_waitcnt lgkmcnt(14)
    ds_write_b128 v65, v[174:177] offset:32768
    v_mov_b64 v[78:79], 0
    v_mov_b64 v[80:81], 0
    v_mov_b64 v[82:83], 0
    v_mov_b64 v[84:85], 0
    v_mov_b64 v[86:87], 0
    v_mov_b64 v[88:89], 0
    v_mov_b64 v[90:91], 0
    v_mov_b64 v[92:93], 0
    v_mov_b64 v[94:95], 0
    v_mov_b64 v[96:97], 0
    v_mov_b64 v[98:99], 0
    v_mov_b64 v[100:101], 0
    v_mov_b64 v[102:103], 0
    v_mov_b64 v[104:105], 0
    v_mov_b64 v[106:107], 0
    v_mov_b64 v[108:109], 0
    v_mov_b64 v[110:111], 0
    v_mov_b64 v[112:113], 0
    v_mov_b64 v[114:115], 0
    v_mov_b64 v[116:117], 0
    v_mov_b64 v[118:119], 0
    v_mov_b64 v[120:121], 0
    v_mov_b64 v[122:123], 0
    v_mov_b64 v[124:125], 0
    v_mov_b64 v[126:127], 0
    v_mov_b64 v[128:129], 0
    v_mov_b64 v[130:131], 0
    v_mov_b64 v[132:133], 0
    v_mov_b64 v[134:135], 0
    v_mov_b64 v[136:137], 0
    v_mov_b64 v[138:139], 0
    v_mov_b64 v[140:141], 0
    v_mov_b64 v[142:143], 0
    v_mov_b64 v[160:161], 0
    v_mov_b64 v[162:163], 0
    v_mov_b64 v[164:165], 0
    v_mov_b64 v[166:167], 0
    v_mov_b64 v[168:169], 0
    v_mov_b64 v[170:171], 0
    v_mov_b64 v[172:173], 0
    v_mov_b64 v[174:175], 0
    v_mov_b64 v[68:69], 0
    v_mov_b64 v[70:71], 0
    v_mov_b64 v[72:73], 0
    v_mov_b64 v[74:75], 0
    v_mov_b64 v[76:77], 0
    v_mov_b32 v7, 0
    s_cmp_ge_u32 s2, 24
    s_cbranch_scc1 L1_nojob
    s_waitcnt lgkmcnt(0)
    v_mov_b32 v40, 0x3f803f80
    v_mov_b32 v41, 0x3f803f80
    v_mov_b32 v42, 0x3f803f80
    v_mov_b32 v43, 0x3f803f80
    s_getpc_b64 s[62:63]
L1_jpc:
    s_mul_i32 s61, s2, 36
    s_add_u32 s61, s61, L1_jtab-L1_jpc
    s_add_u32 s62, s62, s61
    s_addc_u32 s63, s63, 0
    s_setpc_b64 s[62:63]
L1_jtab:
    v_accvgpr_read_b32 v44, a192
    v_accvgpr_read_b32 v45, a193
    v_accvgpr_read_b32 v46, a194
    v_accvgpr_read_b32 v47, a195
    s_branch L1_j0
    v_accvgpr_read_b32 v44, a240
    v_accvgpr_read_b32 v45, a241
    v_accvgpr_read_b32 v46, a242
    v_accvgpr_read_b32 v47, a243
    s_branch L1_j1
    v_accvgpr_read_b32 v44, a196
    v_accvgpr_read_b32 v45, a197
    v_accvgpr_read_b32 v46, a198
    v_accvgpr_read_b32 v47, a199
    s_branch L1_j0
    v_accvgpr_read_b32 v44, a244
    v_accvgpr_read_b32 v45, a245
    v_accvgpr_read_b32 v46, a246
    v_accvgpr_read_b32 v47, a247
    s_branch L1_j1
    v_accvgpr_read_b32 v44, a200
    v_accvgpr_read_b32 v45, a201
    v_accvgpr_read_b32 v46, a202
    v_accvgpr_read_b32 v47, a203
    s_branch L1_j0
    v_accvgpr_read_b32 v44, a248
    v_accvgpr_read_b32 v45, a249
    v_accvgpr_read_b32 v46, a250
    v_accvgpr_read_b32 v47, a251
    s_branch L1_j1
    v_accvgpr_read_b32 v44, a204
    v_accvgpr_read_b32 v45, a205
    v_accvgpr_read_b32 v46, a206
    v_accvgpr_read_b32 v47, a207
    s_branch L1_j0
    v_accvgpr_read_b32 v44, a252
    v_accvgpr_read_b32 v45, a253
    v_accvgpr_read_b32 v46, a254
    v_accvgpr_read_b32 v47, a255
    s_branch L1_j1
    v_accvgpr_read_b32 v44, a208
    v_accvgpr_read_b32 v45, a209
    v_accvgpr_read_b32 v46, a210
    v_accvgpr_read_b32 v47, a211
    s_branch L1_j0
    v_mov_b32_e64 v44, v224
    v_mov_b32_e64 v45, v225
    v_mov_b32_e64 v46, v226
    v_mov_b32_e64 v47, v227
    s_branch L1_j1
    v_accvgpr_read_b32 v44, a212
    v_accvgpr_read_b32 v45, a213
    v_accvgpr_read_b32 v46, a214
    v_accvgpr_read_b32 v47, a215
    s_branch L1_j0
    v_mov_b32_e64 v44, v228
    v_mov_b32_e64 v45, v229
    v_mov_b32_e64 v46, v230
    v_mov_b32_e64 v47, v231
    s_branch L1_j1
    v_accvgpr_read_b32 v44, a216
    v_accvgpr_read_b32 v45, a217
    v_accvgpr_read_b32 v46, a218
    v_accvgpr_read_b32 v47, a219
    s_branch L1_j0
    v_mov_b32_e64 v44, v232
    v_mov_b32_e64 v45, v233
    v_mov_b32_e64 v46, v234
    v_mov_b32_e64 v47, v235
    s_branch L1_j1
    v_accvgpr_read_b32 v44, a220
    v_accvgpr_read_b32 v45, a221
    v_accvgpr_read_b32 v46, a222
    v_accvgpr_read_b32 v47, a223
    s_branch L1_j0
    v_mov_b32_e64 v44, v236
    v_mov_b32_e64 v45, v237
    v_mov_b32_e64 v46, v238
    v_mov_b32_e64 v47, v239
    s_branch L1_j1
    v_accvgpr_read_b32 v44, a224
    v_accvgpr_read_b32 v45, a225
    v_accvgpr_read_b32 v46, a226
    v_accvgpr_read_b32 v47, a227
    s_branch L1_j0
    v_mov_b32_e64 v44, v240
    v_mov_b32_e64 v45, v241
    v_mov_b32_e64 v46, v242
    v_mov_b32_e64 v47, v243
    s_branch L1_j1
    v_accvgpr_read_b32 v44, a228
    v_accvgpr_read_b32 v45, a229
    v_accvgpr_read_b32 v46, a230
    v_accvgpr_read_b32 v47, a231
    s_branch L1_j0
    v_mov_b32_e64 v44, v244
    v_mov_b32_e64 v45, v245
    v_mov_b32_e64 v46, v246
    v_mov_b32_e64 v47, v247
    s_branch L1_j1
    v_accvgpr_read_b32 v44, a232
    v_accvgpr_read_b32 v45, a233
    v_accvgpr_read_b32 v46, a234
    v_accvgpr_read_b32 v47, a235
    s_branch L1_j0
    v_mov_b32_e64 v44, v248
    v_mov_b32_e64 v45, v249
    v_mov_b32_e64 v46, v250
    v_mov_b32_e64 v47, v251
    s_branch L1_j1
    v_accvgpr_read_b32 v44, a236
    v_accvgpr_read_b32 v45, a237
    v_accvgpr_read_b32 v46, a238
    v_accvgpr_read_b32 v47, a239
    s_branch L1_j0
    v_mov_b32_e64 v44, v252
    v_mov_b32_e64 v45, v253
    v_mov_b32_e64 v46, v254
    v_mov_b32_e64 v47, v255
    s_branch L1_j1
L1_j0:
    s_nop 1
    v_mfma_f32_32x32x16_bf16 v[144:159], v[40:43], a[192:195], 0
    v_mfma_f32_32x32x16_bf16 v[144:159], v[40:43], a[196:199], v[144:159]
    v_mfma_f32_32x32x16_bf16 v[144:159], v[40:43], a[200:203], v[144:159]
    v_mfma_f32_32x32x16_bf16 v[144:159], v[40:43], a[204:207], v[144:159]
    v_mfma_f32_32x32x16_bf16 v[144:159], v[40:43], a[208:211], v[144:159]
    v_mfma_f32_32x32x16_bf16 v[144:159], v[40:43], a[212:215], v[144:159]
    v_mfma_f32_32x32x16_bf16 v[144:159], v[40:43], a[216:219], v[144:159]
    v_mfma_f32_32x32x16_bf16 v[144:159], v[40:43], a[220:223], v[144:159]
    v_mfma_f32_32x32x16_bf16 v[144:159], v[40:43], a[224:227], v[144:159]
    v_mfma_f32_32x32x16_bf16 v[144:159], v[40:43], a[228:231], v[144:159]
    v_mfma_f32_32x32x16_bf16 v[144:159], v[40:43], a[232:235], v[144:159]
    v_mfma_f32_32x32x16_bf16 v[144:159], v[40:43], a[236:239], v[144:159]
    s_branch L1_jc
L1_j1:
    s_nop 1
    s_nop 8
    v_mfma_f32_32x32x16_bf16 v[144:159], v[40:43], a[240:243], 0
    v_mfma_f32_32x32x16_bf16 v[144:159], v[40:43], a[244:247], v[144:159]
    v_mfma_f32_32x32x16_bf16 v[144:159], v[40:43], a[248:251], v[144:159]
    v_mfma_f32_32x32x16_bf16 v[144:159], v[40:43], a[252:255], v[144:159]
    v_mfma_f32_32x32x16_bf16 v[144:159], v[40:43], v[224:227], v[144:159]
    v_mfma_f32_32x32x16_bf16 v[144:159], v[40:43], v[228:231], v[144:159]
    v_mfma_f32_32x32x16_bf16 v[144:159], v[40:43], v[232:235], v[144:159]
    v_mfma_f32_32x32x16_bf16 v[144:159], v[40:43], v[236:239], v[144:159]
    v_mfma_f32_32x32x16_bf16 v[144:159], v[40:43], v[240:243], v[144:159]
    v_mfma_f32_32x32x16_bf16 v[144:159], v[40:43], v[244:247], v[144:159]
    v_mfma_f32_32x32x16_bf16 v[144:159], v[40:43], v[248:251], v[144:159]
    v_mfma_f32_32x32x16_bf16 v[144:159], v[40:43], v[252:255], v[144:159]
L1_jc:
    s_add_u32 s44, s16, 255098880
    s_addc_u32 s45, s17, 0
    s_mov_b32 s46, 98304
    s_mov_b32 s47, 0x20000
    v_lshlrev_b32 v180, 16, v220
    v_and_b32 v181, 0xffff0000, v220
    v_lshlrev_b32 v48, 16, v44
    v_and_b32 v49, 0xffff0000, v44
    v_lshlrev_b32 v182, 16, v221
    v_and_b32 v183, 0xffff0000, v221
    v_lshlrev_b32 v50, 16, v45
    v_and_b32 v51, 0xffff0000, v45
    v_lshlrev_b32 v184, 16, v222
    v_and_b32 v185, 0xffff0000, v222
    v_lshlrev_b32 v52, 16, v46
    v_and_b32 v53, 0xffff0000, v46
    v_lshlrev_b32 v186, 16, v223
    v_and_b32 v187, 0xffff0000, v223
    v_lshlrev_b32 v54, 16, v47
    v_and_b32 v55, 0xffff0000, v47
    v_mul_f32 v180, 0x3eeff558, v180
    v_mul_f32 v181, 0x3eeff558, v181
    v_mul_f32 v182, 0x3eeff558, v182
    v_mul_f32 v183, 0x3eeff558, v183
    v_mul_f32 v184, 0x3eeff558, v184
    v_mul_f32 v185, 0x3eeff558, v185
    v_mul_f32 v186, 0x3eeff558, v186
    v_mul_f32 v187, 0x3eeff558, v187
    s_lshl_b32 s61, s20, 1
    s_and_b32 s7, s2, 1
    s_add_u32 s61, s61, s7
    s_mul_i32 s61, s61, 12
    s_add_u32 s61, s61, s60
    s_lshl_b32 s61, s61, 10
    v_mul_f32 v144, 0x3baaaaab, v144
    v_sub_f32 v48, v48, v144
    v_sub_f32 v49, v49, v144
    v_sub_f32 v50, v50, v144
    v_sub_f32 v51, v51, v144
    v_sub_f32 v52, v52, v144
    v_sub_f32 v53, v53, v144
    v_sub_f32 v54, v54, v144
    v_sub_f32 v55, v55, v144
    v_mul_f32 v48, v48, v180
    v_mul_f32 v49, v49, v181
    v_mul_f32 v50, v50, v182
    v_mul_f32 v51, v51, v183
    v_mul_f32 v52, v52, v184
    v_mul_f32 v53, v53, v185
    v_mul_f32 v54, v54, v186
    v_mul_f32 v55, v55, v187
    v_cvt_pk_bf16_f32 v36, v48, v49
    v_cvt_pk_bf16_f32 v37, v50, v51
    v_cvt_pk_bf16_f32 v38, v52, v53
    v_cvt_pk_bf16_f32 v39, v54, v55
    buffer_store_dwordx4 v[36:39], v178, s[44:47], s61 offen sc1
L1_nojob:
    s_lshl_b32 s6, s55, 2
    s_add_u32 s6, s6, 64
    s_cmp_eq_u32 s54, 0
    s_cselect_b32 s7, s6, 0x1000
    v_mov_b32 v8, 1
    v_mov_b32 v0, 0
    buffer_store_dword v8, v0, s[56:59], s7 offen sc1
    s_mov_b32 m0, 62464
    s_add_u32 s84, s84, 32768
    buffer_load_dword v179, s[80:83], s84 offen lds
    s_add_u32 s84, s84, 32768
    buffer_load_dword v179, s[80:83], s84 offen lds
    s_mov_b32 s85, 0
    s_mov_b64 s[72:73], s[16:17]
    s_mov_b64 s[74:75], s[16:17]
    s_mov_b64 s[76:77], s[16:17]
    s_cmp_lt_u32 s2, 72
    s_cselect_b32 s78, 3, 16
    s_lshl_b32 s78, s78, 15
    s_and_b32 s79, s2, 7
    s_lshl_b32 s79, s79, 2
    s_add_u32 s79, s79, 128
    s_mov_b32 s40, 36864
    s_add_u32 m0, s21, 49152
    s_mov_b32 s42, 128
    v_xor_b32 v2, 16384, v2
    v_xor_b32 v3, 16384, v3
    s_waitcnt lgkmcnt(0)
    s_barrier
    ds_read_b128 v[176:179], v1 offset:0
    ds_read_b128 v[180:183], v1 offset:1056
    ds_read_b128 v[184:187], v1 offset:2112
    ds_read_b128 v[188:191], v1 offset:3168
    ds_read_b128 v[192:195], v1 offset:4224
    ds_read_b128 v[196:199], v1 offset:5280
    ds_read_b128 v[200:203], v1 offset:6336
    ds_read_b128 v[204:207], v1 offset:7392
    ds_read_b128 v[208:211], v1 offset:8448
    ds_read_b128 v[212:215], v1 offset:9504
    ds_read_b128 v[216:219], v1 offset:10560
    ds_read_b128 v[220:223], v1 offset:11616
    v_xor_b32 v1, 16384, v1
    ds_read_b128 v[40:43], v3 offset:0
    ds_read_b128 v[48:51], v3 offset:128
    ds_read_b128 v[56:59], v3 offset:256
    s_waitcnt lgkmcnt(2)
    v_lshlrev_b32 v36, 16, v40
    v_and_b32 v37, 0xffff0000, v40
    v_lshlrev_b32 v38, 16, v41
    v_and_b32 v39, 0xffff0000, v41
    v_lshlrev_b32 v40, 16, v42
    v_and_b32 v41, 0xffff0000, v42
    v_lshlrev_b32 v42, 16, v43
    v_and_b32 v43, 0xffff0000, v43
    v_mul_f32 v36, v36, v12
    v_mul_f32 v37, v37, v13
    v_mul_f32 v38, v38, v14
    v_mul_f32 v39, v39, v15
    v_mul_f32 v40, v40, v16
    v_mul_f32 v41, v41, v17
    v_mul_f32 v42, v42, v18
    v_mul_f32 v43, v43, v19
    v_mul_f32 v9, v36, v36
    v_add_f32 v8, v36, v37
    v_fmac_f32 v9, v37, v37
    v_add_f32 v8, v8, v38
    v_fmac_f32 v9, v38, v38
    s_waitcnt lgkmcnt(0)
.p2align 6
L1_loop:
    v_mfma_f32_32x32x16_bf16 v[144:159], a[0:3], v[176:179], 0
    s_waitcnt lgkmcnt(8)
    v_fmac_f32 v142, v68, v68
    v_fmac_f32 v142, v69, v69
    v_add_f32 v8, v8, v39
    v_fmac_f32 v142, v70, v70
    v_fmac_f32 v142, v71, v71
    v_fmac_f32 v9, v39, v39
    v_add_f32 v8, v8, v40
    v_mfma_f32_32x32x16_bf16 v[144:159], a[4:7], v[180:183], v[144:159]
    v_fmac_f32 v9, v40, v40
    v_lshlrev_b32_sdwa v160, 1, v160 dst_sel:DWORD dst_unused:UNUSED_PAD src0_sel:DWORD src1_sel:WORD_1
    v_lshlrev_b32_sdwa v161, 1, v161 dst_sel:DWORD dst_unused:UNUSED_PAD src0_sel:DWORD src1_sel:WORD_1
    v_add_f32 v8, v8, v41
    v_fmac_f32 v9, v41, v41
    v_mfma_f32_32x32x16_bf16 v[144:159], a[8:11], v[184:187], v[144:159]
    ds_read_u16_d16_hi v76, v160 offset:65152
    ds_read_u16_d16_hi v77, v161 offset:65152
    v_add_f32 v8, v8, v42
    v_lshlrev_b32_sdwa v162, 1, v162 dst_sel:DWORD dst_unused:UNUSED_PAD src0_sel:DWORD src1_sel:WORD_1
    v_lshlrev_b32_sdwa v163, 1, v163 dst_sel:DWORD dst_unused:UNUSED_PAD src0_sel:DWORD src1_sel:WORD_1
    v_fmac_f32 v9, v42, v42
    v_add_f32 v8, v8, v43
    v_mfma_f32_32x32x16_bf16 v[144:159], a[12:15], v[188:191], v[144:159]
    s_waitcnt lgkmcnt(3)
    ds_read_u16_d16_hi v7, v162 offset:65152
    ds_read_u16_d16_hi v0, v163 offset:65152
    v_fmac_f32 v9, v43, v43
    v_fmac_f32 v142, v72, v72
    v_fmac_f32 v142, v73, v73
    v_lshlrev_b32_sdwa v164, 1, v164 dst_sel:DWORD dst_unused:UNUSED_PAD src0_sel:DWORD src1_sel:WORD_1
    v_lshlrev_b32 v44, 16, v48
    v_mfma_f32_32x32x16_bf16 v[144:159], a[16:19], v[192:195], v[144:159]
    ds_read_u16_d16_hi v68, v164 offset:65152
    v_fmac_f32 v142, v74, v74
    v_fmac_f32 v142, v75, v75
    v_and_b32 v45, 0xffff0000, v48
    v_lshlrev_b32 v46, 16, v49
    v_lshlrev_b32_sdwa v165, 1, v165 dst_sel:DWORD dst_unused:UNUSED_PAD src0_sel:DWORD src1_sel:WORD_1
    v_lshlrev_b32_sdwa v166, 1, v166 dst_sel:DWORD dst_unused:UNUSED_PAD src0_sel:DWORD src1_sel:WORD_1
    v_mfma_f32_32x32x16_bf16 v[144:159], a[20:23], v[196:199], v[144:159]
    ds_read_u16_d16_hi v69, v165 offset:65152
    ds_read_u16_d16_hi v70, v166 offset:65152
    v_and_b32 v47, 0xffff0000, v49
    v_lshlrev_b32 v48, 16, v50
    v_and_b32 v49, 0xffff0000, v50
    v_lshlrev_b32 v50, 16, v51
    v_lshlrev_b32_sdwa v167, 1, v167 dst_sel:DWORD dst_unused:UNUSED_PAD src0_sel:DWORD src1_sel:WORD_1
    v_mfma_f32_32x32x16_bf16 v[144:159], a[24:27], v[200:203], v[144:159]
    ds_read_u16_d16_hi v71, v167 offset:65152
    v_and_b32 v51, 0xffff0000, v51
    v_mul_f32 v44, v44, v20
    v_mul_f32 v45, v45, v21
    v_lshlrev_b32_sdwa v168, 1, v168 dst_sel:DWORD dst_unused:UNUSED_PAD src0_sel:DWORD src1_sel:WORD_1
    v_lshlrev_b32_sdwa v169, 1, v169 dst_sel:DWORD dst_unused:UNUSED_PAD src0_sel:DWORD src1_sel:WORD_1
    v_mul_f32 v46, v46, v22
    v_mfma_f32_32x32x16_bf16 v[144:159], a[28:31], v[204:207], v[144:159]
    s_waitcnt lgkmcnt(4)
    ds_read_u16_d16_hi v72, v168 offset:65152
    ds_read_u16_d16_hi v73, v169 offset:65152
    v_mul_f32 v47, v47, v23
    v_mul_f32 v48, v48, v24
    v_fmac_f32 v143, v76, v76
    v_lshlrev_b32_sdwa v170, 1, v170 dst_sel:DWORD dst_unused:UNUSED_PAD src0_sel:DWORD src1_sel:WORD_1
    v_lshlrev_b32_sdwa v171, 1, v171 dst_sel:DWORD dst_unused:UNUSED_PAD src0_sel:DWORD src1_sel:WORD_1
    v_mfma_f32_32x32x16_bf16 v[144:159], a[32:35], v[208:211], v[144:159]
    ds_read_u16_d16_hi v74, v170 offset:65152
    ds_read_u16_d16_hi v75, v171 offset:65152
    v_fmac_f32 v143, v77, v77
    v_mul_f32 v49, v49, v25
    v_fmac_f32 v143, v7, v7
    v_fmac_f32 v143, v0, v0
    v_mul_f32 v50, v50, v26
    v_mul_f32 v51, v51, v27
    v_lshlrev_b32_sdwa v172, 1, v172 dst_sel:DWORD dst_unused:UNUSED_PAD src0_sel:DWORD src1_sel:WORD_1
    v_mfma_f32_32x32x16_bf16 v[144:159], a[36:39], v[212:215], v[144:159]
    ds_read_u16_d16_hi v76, v172 offset:65152
    v_add_f32 v8, v8, v44
    v_fmac_f32 v9, v44, v44
    v_add_f32 v8, v8, v45
    v_fmac_f32 v9, v45, v45
    v_lshlrev_b32_sdwa v173, 1, v173 dst_sel:DWORD dst_unused:UNUSED_PAD src0_sel:DWORD src1_sel:WORD_1
    v_lshlrev_b32_sdwa v174, 1, v174 dst_sel:DWORD dst_unused:UNUSED_PAD src0_sel:DWORD src1_sel:WORD_1
    v_mfma_f32_32x32x16_bf16 v[144:159], a[40:43], v[216:219], v[144:159]
    s_waitcnt lgkmcnt(5)
    ds_read_u16_d16_hi v77, v173 offset:65152
    ds_read_u16_d16_hi v7, v174 offset:65152
    v_add_f32 v8, v8, v46
    v_fmac_f32 v9, v46, v46
    v_fmac_f32 v143, v68, v68
    v_fmac_f32 v143, v69, v69
    v_lshlrev_b32_sdwa v175, 1, v175 dst_sel:DWORD dst_unused:UNUSED_PAD src0_sel:DWORD src1_sel:WORD_1
    v_mfma_f32_32x32x16_bf16 v[144:159], a[44:47], v[220:223], v[144:159]
    ds_read_u16_d16_hi v0, v175 offset:65152
    v_add_f32 v8, v8, v47
    v_fmac_f32 v9, v47, v47
    v_fmac_f32 v143, v70, v70
    v_fmac_f32 v143, v71, v71
    v_add_f32 v8, v8, v48
    v_fmac_f32 v9, v48, v48
    v_mfma_f32_32x32x16_bf16 v[160:175], a[48:51], v[176:179], 0
    s_waitcnt lgkmcnt(4)
    v_add_f32 v8, v8, v49
    v_fmac_f32 v9, v49, v49
    v_add_f32 v8, v8, v50
    v_fmac_f32 v143, v72, v72
    v_fmac_f32 v143, v73, v73
    v_fmac_f32 v9, v50, v50
    v_fmac_f32 v143, v74, v74
    v_mfma_f32_32x32x16_bf16 v[160:175], a[52:55], v[180:183], v[160:175]
    v_fmac_f32 v143, v75, v75
    v_add_f32 v8, v8, v51
    v_fmac_f32 v9, v51, v51
    v_lshlrev_b32_sdwa v144, 1, v144 dst_sel:DWORD dst_unused:UNUSED_PAD src0_sel:DWORD src1_sel:WORD_1
    v_lshlrev_b32_sdwa v145, 1, v145 dst_sel:DWORD dst_unused:UNUSED_PAD src0_sel:DWORD src1_sel:WORD_1
    v_lshlrev_b32 v52, 16, v56
    v_mfma_f32_32x32x16_bf16 v[160:175], a[56:59], v[184:187], v[160:175]
    ds_read_u16_d16_hi v68, v144 offset:65152
    ds_read_u16_d16_hi v69, v145 offset:65152
    v_and_b32 v53, 0xffff0000, v56
    v_lshlrev_b32_sdwa v146, 1, v146 dst_sel:DWORD dst_unused:UNUSED_PAD src0_sel:DWORD src1_sel:WORD_1
    v_lshlrev_b32_sdwa v147, 1, v147 dst_sel:DWORD dst_unused:UNUSED_PAD src0_sel:DWORD src1_sel:WORD_1
    v_lshlrev_b32 v54, 16, v57
    v_and_b32 v55, 0xffff0000, v57
    v_mfma_f32_32x32x16_bf16 v[160:175], a[60:63], v[188:191], v[160:175]
    s_waitcnt lgkmcnt(2)
    ds_read_u16_d16_hi v70, v146 offset:65152
    ds_read_u16_d16_hi v71, v147 offset:65152
    v_fmac_f32 v143, v76, v76
    v_fmac_f32 v143, v77, v77
    v_lshlrev_b32_sdwa v148, 1, v148 dst_sel:DWORD dst_unused:UNUSED_PAD src0_sel:DWORD src1_sel:WORD_1
    v_lshlrev_b32 v56, 16, v58
    v_fmac_f32 v143, v7, v7
    v_mfma_f32_32x32x16_bf16 v[160:175], a[64:67], v[192:195], v[160:175]
    ds_read_u16_d16_hi v72, v148 offset:65152
    v_fmac_f32 v143, v0, v0
    v_and_b32 v57, 0xffff0000, v58
    v_lshlrev_b32 v58, 16, v59
    v_lshlrev_b32_sdwa v149, 1, v149 dst_sel:DWORD dst_unused:UNUSED_PAD src0_sel:DWORD src1_sel:WORD_1
    v_lshlrev_b32_sdwa v150, 1, v150 dst_sel:DWORD dst_unused:UNUSED_PAD src0_sel:DWORD src1_sel:WORD_1
    v_and_b32 v59, 0xffff0000, v59
    v_mfma_f32_32x32x16_bf16 v[160:175], a[68:71], v[196:199], v[160:175]
    ds_read_u16_d16_hi v73, v149 offset:65152
    ds_read_u16_d16_hi v74, v150 offset:65152
    v_mul_f32 v52, v52, v28
    v_lshlrev_b32_sdwa v151, 1, v151 dst_sel:DWORD dst_unused:UNUSED_PAD src0_sel:DWORD src1_sel:WORD_1
    v_mul_f32 v53, v53, v29
    v_mfma_f32_32x32x16_bf16 v[160:175], a[72:75], v[200:203], v[160:175]
    buffer_load_dwordx4 v4, s[24:27], s40 offen offset:0 lds
    ds_read_u16_d16_hi v75, v151 offset:65152
    v_lshlrev_b32_sdwa v152, 1, v152 dst_sel:DWORD dst_unused:UNUSED_PAD src0_sel:DWORD src1_sel:WORD_1
    v_lshlrev_b32_sdwa v153, 1, v153 dst_sel:DWORD dst_unused:UNUSED_PAD src0_sel:DWORD src1_sel:WORD_1
    v_mul_f32 v54, v54, v30
    v_mul_f32 v55, v55, v31
    v_mfma_f32_32x32x16_bf16 v[160:175], a[76:79], v[204:207], v[160:175]
    s_waitcnt lgkmcnt(4)
    ds_read_u16_d16_hi v76, v152 offset:65152
    ds_read_u16_d16_hi v77, v153 offset:65152
    v_fmac_f32 v78, v68, v68
    v_fmac_f32 v79, v69, v69
    v_cvt_pk_bf16_f32 v60, v68, v69
    v_lshlrev_b32_sdwa v154, 1, v154 dst_sel:DWORD dst_unused:UNUSED_PAD src0_sel:DWORD src1_sel:WORD_1
    v_lshlrev_b32_sdwa v155, 1, v155 dst_sel:DWORD dst_unused:UNUSED_PAD src0_sel:DWORD src1_sel:WORD_1
    v_mfma_f32_32x32x16_bf16 v[160:175], a[80:83], v[208:211], v[160:175]
    ds_read_u16_d16_hi v7, v154 offset:65152
    ds_read_u16_d16_hi v0, v155 offset:65152
    v_mul_f32 v56, v56, v32
    v_fmac_f32 v80, v70, v70
    v_fmac_f32 v81, v71, v71
    v_cvt_pk_bf16_f32 v61, v70, v71
    v_mul_f32 v57, v57, v33
    v_lshlrev_b32_sdwa v156, 1, v156 dst_sel:DWORD dst_unused:UNUSED_PAD src0_sel:DWORD src1_sel:WORD_1
    v_mfma_f32_32x32x16_bf16 v[160:175], a[84:87], v[212:215], v[160:175]
    ds_read_u16_d16_hi v68, v156 offset:65152
    v_mul_f32 v58, v58, v34
    v_mul_f32 v59, v59, v35
    v_add_f32 v8, v8, v52
    v_lshlrev_b32_sdwa v157, 1, v157 dst_sel:DWORD dst_unused:UNUSED_PAD src0_sel:DWORD src1_sel:WORD_1
    v_lshlrev_b32_sdwa v158, 1, v158 dst_sel:DWORD dst_unused:UNUSED_PAD src0_sel:DWORD src1_sel:WORD_1
    v_mfma_f32_32x32x16_bf16 v[160:175], a[88:91], v[216:219], v[160:175]
    s_waitcnt lgkmcnt(5)
    buffer_load_dwordx4 v4, s[24:27], s40 offen offset:1024 lds
    ds_read_u16_d16_hi v69, v157 offset:65152
    ds_read_u16_d16_hi v70, v158 offset:65152
    v_fmac_f32 v9, v52, v52
    v_fmac_f32 v82, v72, v72
    v_lshlrev_b32_sdwa v159, 1, v159 dst_sel:DWORD dst_unused:UNUSED_PAD src0_sel:DWORD src1_sel:WORD_1
    v_mfma_f32_32x32x16_bf16 v[160:175], a[92:95], v[220:223], v[160:175]
    ds_read_u16_d16_hi v71, v159 offset:65152
    v_fmac_f32 v83, v73, v73
    v_cvt_pk_bf16_f32 v62, v72, v73
    v_add_f32 v8, v8, v53
    v_fmac_f32 v84, v74, v74
    v_fmac_f32 v85, v75, v75
    v_cvt_pk_bf16_f32 v63, v74, v75
    v_fmac_f32 v9, v53, v53
    v_mfma_f32_32x32x16_bf16 v[144:159], a[96:99], v[176:179], 0
    s_waitcnt lgkmcnt(4)
    buffer_store_dwordx4 v[60:63], v5, s[28:31], s41 offen offset:0
    v_add_f32 v8, v8, v54
    v_fmac_f32 v9, v54, v54
    v_add_f32 v8, v8, v55
    v_fmac_f32 v86, v76, v76
    v_fmac_f32 v87, v77, v77
    v_mfma_f32_32x32x16_bf16 v[144:159], a[100:103], v[180:183], v[144:159]
    v_cvt_pk_bf16_f32 v64, v76, v77
    v_fmac_f32 v9, v55, v55
    v_fmac_f32 v88, v7, v7
    v_fmac_f32 v89, v0, v0
    v_cvt_pk_bf16_f32 v65, v7, v0
    buffer_load_dwordx4 v4, s[24:27], s40 offen offset:2048 lds
    v_lshlrev_b32_sdwa v160, 1, v160 dst_sel:DWORD dst_unused:UNUSED_PAD src0_sel:DWORD src1_sel:WORD_1
    v_lshlrev_b32_sdwa v161, 1, v161 dst_sel:DWORD dst_unused:UNUSED_PAD src0_sel:DWORD src1_sel:WORD_1
    v_mfma_f32_32x32x16_bf16 v[144:159], a[104:107], v[184:187], v[144:159]
    ds_read_u16_d16_hi v72, v160 offset:65152
    ds_read_u16_d16_hi v73, v161 offset:65152
    v_add_f32 v8, v8, v56
    v_fmac_f32 v9, v56, v56
    v_lshlrev_b32_sdwa v162, 1, v162 dst_sel:DWORD dst_unused:UNUSED_PAD src0_sel:DWORD src1_sel:WORD_1
    v_lshlrev_b32_sdwa v163, 1, v163 dst_sel:DWORD dst_unused:UNUSED_PAD src0_sel:DWORD src1_sel:WORD_1
    v_add_f32 v8, v8, v57
    v_mfma_f32_32x32x16_bf16 v[144:159], a[108:111], v[188:191], v[144:159]
    s_waitcnt lgkmcnt(2)
    ds_read_u16_d16_hi v74, v162 offset:65152
    ds_read_u16_d16_hi v75, v163 offset:65152
    v_fmac_f32 v9, v57, v57
    v_fmac_f32 v90, v68, v68
    v_fmac_f32 v91, v69, v69
    v_cvt_pk_bf16_f32 v66, v68, v69
    v_lshlrev_b32_sdwa v164, 1, v164 dst_sel:DWORD dst_unused:UNUSED_PAD src0_sel:DWORD src1_sel:WORD_1
    v_mfma_f32_32x32x16_bf16 v[144:159], a[112:115], v[192:195], v[144:159]
    ds_read_u16_d16_hi v76, v164 offset:65152
    v_add_f32 v8, v8, v58
    v_fmac_f32 v92, v70, v70
    v_fmac_f32 v93, v71, v71
    v_cvt_pk_bf16_f32 v67, v70, v71
    v_fmac_f32 v9, v58, v58
    v_lshlrev_b32_sdwa v165, 1, v165 dst_sel:DWORD dst_unused:UNUSED_PAD src0_sel:DWORD src1_sel:WORD_1
    v_lshlrev_b32_sdwa v166, 1, v166 dst_sel:DWORD dst_unused:UNUSED_PAD src0_sel:DWORD src1_sel:WORD_1
    v_mfma_f32_32x32x16_bf16 v[144:159], a[116:119], v[196:199], v[144:159]
    buffer_store_dwordx4 v[64:67], v5, s[28:31], s41 offen offset:512
    ds_read_u16_d16_hi v77, v165 offset:65152
    ds_read_u16_d16_hi v7, v166 offset:65152
    v_add_f32 v8, v8, v59
    v_fmac_f32 v9, v59, v59
    v_lshlrev_b32_sdwa v167, 1, v167 dst_sel:DWORD dst_unused:UNUSED_PAD src0_sel:DWORD src1_sel:WORD_1
    v_mfma_f32_32x32x16_bf16 v[144:159], a[120:123], v[200:203], v[144:159]
    ds_read_u16_d16_hi v0, v167 offset:65152
    v_add_f32_dpp v8, v8, v8 quad_perm:[1,0,3,2] row_mask:0xf bank_mask:0xf
    v_add_f32_dpp v9, v9, v9 quad_perm:[1,0,3,2] row_mask:0xf bank_mask:0xf
    v_lshlrev_b32_sdwa v168, 1, v168 dst_sel:DWORD dst_unused:UNUSED_PAD src0_sel:DWORD src1_sel:WORD_1
    v_lshlrev_b32_sdwa v169, 1, v169 dst_sel:DWORD dst_unused:UNUSED_PAD src0_sel:DWORD src1_sel:WORD_1
    v_add_f32_dpp v8, v8, v8 quad_perm:[2,3,0,1] row_mask:0xf bank_mask:0xf
    v_add_f32_dpp v9, v9, v9 quad_perm:[2,3,0,1] row_mask:0xf bank_mask:0xf
    v_mfma_f32_32x32x16_bf16 v[144:159], a[124:127], v[204:207], v[144:159]
    s_waitcnt lgkmcnt(4)
    ds_read_u16_d16_hi v68, v168 offset:65152
    ds_read_u16_d16_hi v69, v169 offset:65152
    v_fmac_f32 v94, v72, v72
    v_fmac_f32 v95, v73, v73
    v_cvt_pk_bf16_f32 v60, v72, v73
    v_lshlrev_b32_sdwa v170, 1, v170 dst_sel:DWORD dst_unused:UNUSED_PAD src0_sel:DWORD src1_sel:WORD_1
    v_lshlrev_b32_sdwa v171, 1, v171 dst_sel:DWORD dst_unused:UNUSED_PAD src0_sel:DWORD src1_sel:WORD_1
    v_mfma_f32_32x32x16_bf16 v[144:159], a[128:131], v[208:211], v[144:159]
    ds_read_u16_d16_hi v70, v170 offset:65152
    ds_read_u16_d16_hi v71, v171 offset:65152
    v_add_f32_dpp v8, v8, v8 row_half_mirror row_mask:0xf bank_mask:0xf
    v_fmac_f32 v96, v74, v74
    v_fmac_f32 v97, v75, v75
    v_cvt_pk_bf16_f32 v61, v74, v75
    v_add_f32_dpp v9, v9, v9 row_half_mirror row_mask:0xf bank_mask:0xf
    v_lshlrev_b32_sdwa v172, 1, v172 dst_sel:DWORD dst_unused:UNUSED_PAD src0_sel:DWORD src1_sel:WORD_1
    v_mfma_f32_32x32x16_bf16 v[144:159], a[132:135], v[212:215], v[144:159]
    ds_read_u16_d16_hi v72, v172 offset:65152
    v_mul_f32 v8, 0x3baaaaab, v8
    v_mul_f32 v9, 0x3baaaaab, v9
    v_lshlrev_b32_sdwa v173, 1, v173 dst_sel:DWORD dst_unused:UNUSED_PAD src0_sel:DWORD src1_sel:WORD_1
    v_lshlrev_b32_sdwa v174, 1, v174 dst_sel:DWORD dst_unused:UNUSED_PAD src0_sel:DWORD src1_sel:WORD_1
    v_fma_f32 v9, -v8, v8, v9
    v_max_f32 v9, 0, v9
    v_mfma_f32_32x32x16_bf16 v[144:159], a[136:139], v[216:219], v[144:159]
    s_waitcnt lgkmcnt(5)
    ds_read_u16_d16_hi v73, v173 offset:65152
    ds_read_u16_d16_hi v74, v174 offset:65152
    v_fmac_f32 v98, v76, v76
    v_fmac_f32 v99, v77, v77
    v_cvt_pk_bf16_f32 v62, v76, v77
    v_add_f32 v9, 0x3727c5ac, v9
    v_lshlrev_b32_sdwa v175, 1, v175 dst_sel:DWORD dst_unused:UNUSED_PAD src0_sel:DWORD src1_sel:WORD_1
    v_mfma_f32_32x32x16_bf16 v[144:159], a[140:143], v[220:223], v[144:159]
    ds_read_u16_d16_hi v75, v175 offset:65152
    v_fmac_f32 v100, v7, v7
    v_fmac_f32 v101, v0, v0
    v_cvt_pk_bf16_f32 v63, v7, v0
    v_rsq_f32 v10, v9
    s_nop 0
    v_mul_f32 v9, 0x3eeff558, v10
    v_mfma_f32_32x32x16_bf16 v[160:175], a[144:147], v[176:179], 0
    s_waitcnt lgkmcnt(4)
    buffer_store_dword v10, v6, s[32:35], s42 offen
    buffer_store_dwordx4 v[60:63], v5, s[28:31], s41 offen offset:1024
    v_fmac_f32 v102, v68, v68
    v_fmac_f32 v103, v69, v69
    v_cvt_pk_bf16_f32 v64, v68, v69
    v_mfma_f32_32x32x16_bf16 v[160:175], a[148:151], v[180:183], v[160:175]
    v_mul_f32_e64 v11, -v8, v9
    v_fmac_f32 v104, v70, v70
    v_fmac_f32 v105, v71, v71
    v_cvt_pk_bf16_f32 v65, v70, v71
    v_fma_f32 v36, v36, v9, v11
    v_lshlrev_b32_sdwa v144, 1, v144 dst_sel:DWORD dst_unused:UNUSED_PAD src0_sel:DWORD src1_sel:WORD_1
    v_lshlrev_b32_sdwa v145, 1, v145 dst_sel:DWORD dst_unused:UNUSED_PAD src0_sel:DWORD src1_sel:WORD_1
    v_mfma_f32_32x32x16_bf16 v[160:175], a[152:155], v[184:187], v[160:175]
    ds_read_u16_d16_hi v76, v144 offset:65152
    ds_read_u16_d16_hi v77, v145 offset:65152
    v_fma_f32 v37, v37, v9, v11
    v_fma_f32 v38, v38, v9, v11
    v_fma_f32 v39, v39, v9, v11
    v_lshlrev_b32_sdwa v146, 1, v146 dst_sel:DWORD dst_unused:UNUSED_PAD src0_sel:DWORD src1_sel:WORD_1
    v_lshlrev_b32_sdwa v147, 1, v147 dst_sel:DWORD dst_unused:UNUSED_PAD src0_sel:DWORD src1_sel:WORD_1
    v_mfma_f32_32x32x16_bf16 v[160:175], a[156:159], v[188:191], v[160:175]
    s_waitcnt lgkmcnt(2)
    ds_read_u16_d16_hi v7, v146 offset:65152
    ds_read_u16_d16_hi v0, v147 offset:65152
    v_fma_f32 v40, v40, v9, v11
    v_fmac_f32 v106, v72, v72
    v_fmac_f32 v107, v73, v73
    v_cvt_pk_bf16_f32 v66, v72, v73
    v_lshlrev_b32_sdwa v148, 1, v148 dst_sel:DWORD dst_unused:UNUSED_PAD src0_sel:DWORD src1_sel:WORD_1
    v_mfma_f32_32x32x16_bf16 v[160:175], a[160:163], v[192:195], v[160:175]
    ds_read_u16_d16_hi v68, v148 offset:65152
    v_fma_f32 v41, v41, v9, v11
    v_fmac_f32 v108, v74, v74
    v_fmac_f32 v109, v75, v75
    v_cvt_pk_bf16_f32 v67, v74, v75
    v_fma_f32 v42, v42, v9, v11
    v_lshlrev_b32_sdwa v149, 1, v149 dst_sel:DWORD dst_unused:UNUSED_PAD src0_sel:DWORD src1_sel:WORD_1
    v_lshlrev_b32_sdwa v150, 1, v150 dst_sel:DWORD dst_unused:UNUSED_PAD src0_sel:DWORD src1_sel:WORD_1
    v_mfma_f32_32x32x16_bf16 v[160:175], a[164:167], v[196:199], v[160:175]
    buffer_store_dwordx4 v[64:67], v5, s[28:31], s41 offen offset:1536
    ds_read_u16_d16_hi v69, v149 offset:65152
    ds_read_u16_d16_hi v70, v150 offset:65152
    v_fma_f32 v43, v43, v9, v11
    v_cvt_pk_bf16_f32 v36, v36, v37
    v_lshlrev_b32_sdwa v151, 1, v151 dst_sel:DWORD dst_unused:UNUSED_PAD src0_sel:DWORD src1_sel:WORD_1
    v_mfma_f32_32x32x16_bf16 v[160:175], a[168:171], v[200:203], v[160:175]
    ds_read_u16_d16_hi v71, v151 offset:65152
    v_cvt_pk_bf16_f32 v37, v38, v39
    v_cvt_pk_bf16_f32 v38, v40, v41
    v_cvt_pk_bf16_f32 v39, v42, v43
    v_lshlrev_b32_sdwa v152, 1, v152 dst_sel:DWORD dst_unused:UNUSED_PAD src0_sel:DWORD src1_sel:WORD_1
    v_lshlrev_b32_sdwa v153, 1, v153 dst_sel:DWORD dst_unused:UNUSED_PAD src0_sel:DWORD src1_sel:WORD_1
    v_mfma_f32_32x32x16_bf16 v[160:175], a[172:175], v[204:207], v[160:175]
    ds_write_b128 v2, v[36:39] offset:0
    ds_read_u16_d16_hi v72, v152 offset:65152
    ds_read_u16_d16_hi v73, v153 offset:65152
    v_lshlrev_b32_sdwa v154, 1, v154 dst_sel:DWORD dst_unused:UNUSED_PAD src0_sel:DWORD src1_sel:WORD_1
    v_lshlrev_b32_sdwa v155, 1, v155 dst_sel:DWORD dst_unused:UNUSED_PAD src0_sel:DWORD src1_sel:WORD_1
    v_mfma_f32_32x32x16_bf16 v[160:175], a[176:179], v[208:211], v[160:175]
    s_waitcnt lgkmcnt(7)
    ds_read_u16_d16_hi v74, v154 offset:65152
    ds_read_u16_d16_hi v75, v155 offset:65152
    v_fmac_f32 v110, v76, v76
    v_fmac_f32 v111, v77, v77
    v_cvt_pk_bf16_f32 v60, v76, v77
    v_fma_f32 v44, v44, v9, v11
    v_fmac_f32 v112, v7, v7
    v_fmac_f32 v113, v0, v0
    v_cvt_pk_bf16_f32 v61, v7, v0
    v_fma_f32 v45, v45, v9, v11
    v_lshlrev_b32_sdwa v156, 1, v156 dst_sel:DWORD dst_unused:UNUSED_PAD src0_sel:DWORD src1_sel:WORD_1
    v_mfma_f32_32x32x16_bf16 v[160:175], a[180:183], v[212:215], v[160:175]
    ds_read_u16_d16_hi v76, v156 offset:65152
    v_fma_f32 v46, v46, v9, v11
    v_fma_f32 v47, v47, v9, v11
    v_fma_f32 v48, v48, v9, v11
    v_lshlrev_b32_sdwa v157, 1, v157 dst_sel:DWORD dst_unused:UNUSED_PAD src0_sel:DWORD src1_sel:WORD_1
    v_lshlrev_b32_sdwa v158, 1, v158 dst_sel:DWORD dst_unused:UNUSED_PAD src0_sel:DWORD src1_sel:WORD_1
    v_fma_f32 v49, v49, v9, v11
    v_mfma_f32_32x32x16_bf16 v[160:175], a[184:187], v[216:219], v[160:175]
    s_waitcnt lgkmcnt(6)
    ds_read_u16_d16_hi v77, v157 offset:65152
    ds_read_u16_d16_hi v7, v158 offset:65152
    v_fmac_f32 v114, v68, v68
    v_fmac_f32 v115, v69, v69
    v_cvt_pk_bf16_f32 v62, v68, v69
    v_fma_f32 v50, v50, v9, v11
    v_lshlrev_b32_sdwa v159, 1, v159 dst_sel:DWORD dst_unused:UNUSED_PAD src0_sel:DWORD src1_sel:WORD_1
    v_mfma_f32_32x32x16_bf16 v[160:175], a[188:191], v[220:223], v[160:175]
    ds_read_u16_d16_hi v0, v159 offset:65152
    v_fmac_f32 v116, v70, v70
    v_fmac_f32 v117, v71, v71
    v_cvt_pk_bf16_f32 v63, v70, v71
    v_fma_f32 v51, v51, v9, v11
    v_cvt_pk_bf16_f32 v44, v44, v45
    v_cvt_pk_bf16_f32 v45, v46, v47
    v_mfma_f32_32x32x16_bf16 v[144:159], v[176:179], a[192:195], 0
    s_waitcnt lgkmcnt(4)
    buffer_store_dwordx4 v[60:63], v5, s[28:31], s41 offen offset:2048
    v_fmac_f32 v118, v72, v72
    v_fmac_f32 v119, v73, v73
    v_cvt_pk_bf16_f32 v64, v72, v73
    v_cvt_pk_bf16_f32 v46, v48, v49
    v_fmac_f32 v120, v74, v74
    v_mfma_f32_32x32x16_bf16 v[144:159], v[180:183], a[196:199], v[144:159]
    v_fmac_f32 v121, v75, v75
    v_cvt_pk_bf16_f32 v65, v74, v75
    v_cvt_pk_bf16_f32 v47, v50, v51
    v_lshlrev_b32_sdwa v160, 1, v160 dst_sel:DWORD dst_unused:UNUSED_PAD src0_sel:DWORD src1_sel:WORD_1
    v_lshlrev_b32_sdwa v161, 1, v161 dst_sel:DWORD dst_unused:UNUSED_PAD src0_sel:DWORD src1_sel:WORD_1
    v_mfma_f32_32x32x16_bf16 v[144:159], v[184:187], a[200:203], v[144:159]
    ds_write_b128 v2, v[44:47] offset:4224
    ds_read_u16_d16_hi v68, v160 offset:65152
    ds_read_u16_d16_hi v69, v161 offset:65152
    v_fma_f32 v52, v52, v9, v11
    v_lshlrev_b32_sdwa v162, 1, v162 dst_sel:DWORD dst_unused:UNUSED_PAD src0_sel:DWORD src1_sel:WORD_1
    v_lshlrev_b32_sdwa v163, 1, v163 dst_sel:DWORD dst_unused:UNUSED_PAD src0_sel:DWORD src1_sel:WORD_1
    v_mfma_f32_32x32x16_bf16 v[144:159], v[188:191], a[204:207], v[144:159]
    s_waitcnt lgkmcnt(3)
    ds_read_u16_d16_hi v70, v162 offset:65152
    ds_read_u16_d16_hi v71, v163 offset:65152
    v_fma_f32 v53, v53, v9, v11
    v_fma_f32 v54, v54, v9, v11
    v_fmac_f32 v122, v76, v76
    v_fmac_f32 v123, v77, v77
    v_lshlrev_b32_sdwa v164, 1, v164 dst_sel:DWORD dst_unused:UNUSED_PAD src0_sel:DWORD src1_sel:WORD_1
    v_mfma_f32_32x32x16_bf16 v[144:159], v[192:195], a[208:211], v[144:159]
    ds_read_u16_d16_hi v72, v164 offset:65152
    v_cvt_pk_bf16_f32 v66, v76, v77
    v_fma_f32 v55, v55, v9, v11
    v_fmac_f32 v124, v7, v7
    v_fmac_f32 v125, v0, v0
    v_cvt_pk_bf16_f32 v67, v7, v0
    v_fma_f32 v56, v56, v9, v11
    v_lshlrev_b32_sdwa v165, 1, v165 dst_sel:DWORD dst_unused:UNUSED_PAD src0_sel:DWORD src1_sel:WORD_1
    v_lshlrev_b32_sdwa v166, 1, v166 dst_sel:DWORD dst_unused:UNUSED_PAD src0_sel:DWORD src1_sel:WORD_1
    v_mfma_f32_32x32x16_bf16 v[144:159], v[196:199], a[212:215], v[144:159]
    buffer_store_dwordx4 v[64:67], v5, s[28:31], s41 offen offset:2560
    ds_read_u16_d16_hi v73, v165 offset:65152
    ds_read_u16_d16_hi v74, v166 offset:65152
    v_fma_f32 v57, v57, v9, v11
    v_fma_f32 v58, v58, v9, v11
    v_lshlrev_b32_sdwa v167, 1, v167 dst_sel:DWORD dst_unused:UNUSED_PAD src0_sel:DWORD src1_sel:WORD_1
    v_mfma_f32_32x32x16_bf16 v[144:159], v[200:203], a[216:219], v[144:159]
    ds_read_u16_d16_hi v75, v167 offset:65152
    v_fma_f32 v59, v59, v9, v11
    v_cvt_pk_bf16_f32 v52, v52, v53
    v_cvt_pk_bf16_f32 v53, v54, v55
    v_lshlrev_b32_sdwa v168, 1, v168 dst_sel:DWORD dst_unused:UNUSED_PAD src0_sel:DWORD src1_sel:WORD_1
    v_lshlrev_b32_sdwa v169, 1, v169 dst_sel:DWORD dst_unused:UNUSED_PAD src0_sel:DWORD src1_sel:WORD_1
    v_cvt_pk_bf16_f32 v54, v56, v57
    v_mfma_f32_32x32x16_bf16 v[144:159], v[204:207], a[220:223], v[144:159]
    s_waitcnt lgkmcnt(4)
    ds_read_u16_d16_hi v76, v168 offset:65152
    ds_read_u16_d16_hi v77, v169 offset:65152
    v_cvt_pk_bf16_f32 v55, v58, v59
    v_fmac_f32 v126, v68, v68
    v_fmac_f32 v127, v69, v69
    v_lshlrev_b32_sdwa v170, 1, v170 dst_sel:DWORD dst_unused:UNUSED_PAD src0_sel:DWORD src1_sel:WORD_1
    v_lshlrev_b32_sdwa v171, 1, v171 dst_sel:DWORD dst_unused:UNUSED_PAD src0_sel:DWORD src1_sel:WORD_1
    v_mfma_f32_32x32x16_bf16 v[144:159], v[208:211], a[224:227], v[144:159]
    ds_write_b128 v2, v[52:55] offset:8448
    ds_read_u16_d16_hi v7, v170 offset:65152
    ds_read_u16_d16_hi v0, v171 offset:65152
    v_cvt_pk_bf16_f32 v60, v68, v69
    v_fmac_f32 v128, v70, v70
    v_fmac_f32 v129, v71, v71
    v_cvt_pk_bf16_f32 v61, v70, v71
    v_lshlrev_b32_sdwa v172, 1, v172 dst_sel:DWORD dst_unused:UNUSED_PAD src0_sel:DWORD src1_sel:WORD_1
    v_mfma_f32_32x32x16_bf16 v[144:159], v[212:215], a[228:231], v[144:159]
    ds_read_u16_d16_hi v68, v172 offset:65152
    v_xor_b32 v2, 16384, v2
    v_xor_b32 v3, 16384, v3
    v_lshlrev_b32_sdwa v173, 1, v173 dst_sel:DWORD dst_unused:UNUSED_PAD src0_sel:DWORD src1_sel:WORD_1
    v_lshlrev_b32_sdwa v174, 1, v174 dst_sel:DWORD dst_unused:UNUSED_PAD src0_sel:DWORD src1_sel:WORD_1
    v_mfma_f32_32x32x16_bf16 v[144:159], v[216:219], a[232:235], v[144:159]
    s_waitcnt vmcnt(14) lgkmcnt(6)
    ds_read_u16_d16_hi v69, v173 offset:65152
    ds_read_u16_d16_hi v70, v174 offset:65152
    ds_read_b128 v[40:43], v3 offset:0
    v_fmac_f32 v130, v72, v72
    v_fmac_f32 v131, v73, v73
    v_cvt_pk_bf16_f32 v62, v72, v73
    v_lshlrev_b32_sdwa v175, 1, v175 dst_sel:DWORD dst_unused:UNUSED_PAD src0_sel:DWORD src1_sel:WORD_1
    v_mfma_f32_32x32x16_bf16 v[144:159], v[220:223], a[236:239], v[144:159]
    s_waitcnt lgkmcnt(6)
    s_barrier
    ds_read_u16_d16_hi v71, v175 offset:65152
    ds_read_b128 v[48:51], v3 offset:128
    v_fmac_f32 v132, v74, v74
    v_fmac_f32 v133, v75, v75
    v_cvt_pk_bf16_f32 v63, v74, v75
    v_mfma_f32_32x32x16_bf16 v[160:175], v[176:179], a[240:243], 0
    s_waitcnt lgkmcnt(6)
    buffer_store_dwordx4 v[60:63], v5, s[28:31], s41 offen offset:3072
    ds_read_b128 v[176:179], v1 offset:0
    ds_read_b128 v[56:59], v3 offset:256
    v_fmac_f32 v134, v76, v76
    v_fmac_f32 v135, v77, v77
    v_cvt_pk_bf16_f32 v64, v76, v77
    v_mfma_f32_32x32x16_bf16 v[160:175], v[180:183], a[244:247], v[160:175]
    s_add_u32 s40, s40, 12288
    ds_read_b128 v[180:183], v1 offset:1056
    v_fmac_f32 v136, v7, v7
    v_fmac_f32 v137, v0, v0
    v_cvt_pk_bf16_f32 v65, v7, v0
    v_lshlrev_b32_sdwa v144, 1, v144 dst_sel:DWORD dst_unused:UNUSED_PAD src0_sel:DWORD src1_sel:WORD_1
    v_lshlrev_b32_sdwa v145, 1, v145 dst_sel:DWORD dst_unused:UNUSED_PAD src0_sel:DWORD src1_sel:WORD_1
    v_mfma_f32_32x32x16_bf16 v[160:175], v[184:187], a[248:251], v[160:175]
    s_waitcnt lgkmcnt(5)
    ds_read_u16_d16_hi v72, v144 offset:65152
    ds_read_u16_d16_hi v73, v145 offset:65152
    ds_read_b128 v[184:187], v1 offset:2112
    v_lshlrev_b32 v36, 16, v40
    v_lshlrev_b32_sdwa v146, 1, v146 dst_sel:DWORD dst_unused:UNUSED_PAD src0_sel:DWORD src1_sel:WORD_1
    v_lshlrev_b32_sdwa v147, 1, v147 dst_sel:DWORD dst_unused:UNUSED_PAD src0_sel:DWORD src1_sel:WORD_1
    v_and_b32 v37, 0xffff0000, v40
    v_mfma_f32_32x32x16_bf16 v[160:175], v[188:191], a[252:255], v[160:175]
    s_waitcnt lgkmcnt(7)
    s_xor_b32 m0, m0, 16384
    ds_read_u16_d16_hi v74, v146 offset:65152
    ds_read_u16_d16_hi v75, v147 offset:65152
    ds_read_b128 v[188:191], v1 offset:3168
    v_lshlrev_b32 v38, 16, v41
    v_fmac_f32 v138, v68, v68
    v_fmac_f32 v139, v69, v69
    v_lshlrev_b32_sdwa v148, 1, v148 dst_sel:DWORD dst_unused:UNUSED_PAD src0_sel:DWORD src1_sel:WORD_1
    v_mfma_f32_32x32x16_bf16 v[160:175], v[192:195], v[224:227], v[160:175]
    ds_read_u16_d16_hi v76, v148 offset:65152
    v_cvt_pk_bf16_f32 v66, v68, v69
    v_and_b32 v39, 0xffff0000, v41
    v_fmac_f32 v140, v70, v70
    v_fmac_f32 v141, v71, v71
    v_cvt_pk_bf16_f32 v67, v70, v71
    v_lshlrev_b32 v40, 16, v42
    v_lshlrev_b32_sdwa v149, 1, v149 dst_sel:DWORD dst_unused:UNUSED_PAD src0_sel:DWORD src1_sel:WORD_1
    v_lshlrev_b32_sdwa v150, 1, v150 dst_sel:DWORD dst_unused:UNUSED_PAD src0_sel:DWORD src1_sel:WORD_1
    v_mfma_f32_32x32x16_bf16 v[160:175], v[196:199], v[228:231], v[160:175]
    s_add_u32 s42, s42, 128
    ds_read_b128 v[192:195], v1 offset:4224
    ds_read_u16_d16_hi v77, v149 offset:65152
    ds_read_u16_d16_hi v7, v150 offset:65152
    ds_read_b128 v[196:199], v1 offset:5280
    v_and_b32 v41, 0xffff0000, v42
    v_lshlrev_b32 v42, 16, v43
    v_lshlrev_b32_sdwa v151, 1, v151 dst_sel:DWORD dst_unused:UNUSED_PAD src0_sel:DWORD src1_sel:WORD_1
    v_mfma_f32_32x32x16_bf16 v[160:175], v[200:203], v[232:235], v[160:175]
    s_waitcnt lgkmcnt(14)
    buffer_store_dwordx4 v[64:67], v5, s[28:31], s41 offen offset:3584
    ds_read_u16_d16_hi v0, v151 offset:65152
    v_and_b32 v43, 0xffff0000, v43
    v_mul_f32 v36, v36, v12
    v_lshlrev_b32_sdwa v152, 1, v152 dst_sel:DWORD dst_unused:UNUSED_PAD src0_sel:DWORD src1_sel:WORD_1
    v_lshlrev_b32_sdwa v153, 1, v153 dst_sel:DWORD dst_unused:UNUSED_PAD src0_sel:DWORD src1_sel:WORD_1
    v_mfma_f32_32x32x16_bf16 v[160:175], v[204:207], v[236:239], v[160:175]
    s_waitcnt lgkmcnt(12)
    ds_read_b128 v[200:203], v1 offset:6336
    ds_read_u16_d16_hi v68, v152 offset:65152
    ds_read_u16_d16_hi v69, v153 offset:65152
    v_mul_f32 v37, v37, v13
    v_mul_f32 v38, v38, v14
    v_lshlrev_b32_sdwa v154, 1, v154 dst_sel:DWORD dst_unused:UNUSED_PAD src0_sel:DWORD src1_sel:WORD_1
    v_lshlrev_b32_sdwa v155, 1, v155 dst_sel:DWORD dst_unused:UNUSED_PAD src0_sel:DWORD src1_sel:WORD_1
    v_mfma_f32_32x32x16_bf16 v[160:175], v[208:211], v[240:243], v[160:175]
    s_waitcnt lgkmcnt(10)
    ds_read_b128 v[204:207], v1 offset:7392
    ds_read_u16_d16_hi v70, v154 offset:65152
    ds_read_u16_d16_hi v71, v155 offset:65152
    v_fmac_f32 v142, v72, v72
    v_fmac_f32 v142, v73, v73
    v_mul_f32 v39, v39, v15
    v_fmac_f32 v142, v74, v74
    v_fmac_f32 v142, v75, v75
    v_mul_f32 v40, v40, v16
    v_lshlrev_b32_sdwa v156, 1, v156 dst_sel:DWORD dst_unused:UNUSED_PAD src0_sel:DWORD src1_sel:WORD_1
    v_mfma_f32_32x32x16_bf16 v[160:175], v[212:215], v[244:247], v[160:175]
    s_waitcnt lgkmcnt(12)
    ds_read_b128 v[208:211], v1 offset:8448
    ds_read_u16_d16_hi v72, v156 offset:65152
    ds_read_b128 v[212:215], v1 offset:9504
    v_mul_f32 v41, v41, v17
    v_mul_f32 v42, v42, v18
    v_lshlrev_b32_sdwa v157, 1, v157 dst_sel:DWORD dst_unused:UNUSED_PAD src0_sel:DWORD src1_sel:WORD_1
    v_lshlrev_b32_sdwa v158, 1, v158 dst_sel:DWORD dst_unused:UNUSED_PAD src0_sel:DWORD src1_sel:WORD_1
    v_mfma_f32_32x32x16_bf16 v[160:175], v[216:219], v[248:251], v[160:175]
    s_waitcnt lgkmcnt(9)
    s_add_u32 s41, s41, 32768
    ds_read_u16_d16_hi v73, v157 offset:65152
    ds_read_u16_d16_hi v74, v158 offset:65152
    ds_read_b128 v[216:219], v1 offset:10560
    v_mul_f32 v43, v43, v19
    v_mul_f32 v9, v36, v36
    v_fmac_f32 v142, v76, v76
    v_lshlrev_b32_sdwa v159, 1, v159 dst_sel:DWORD dst_unused:UNUSED_PAD src0_sel:DWORD src1_sel:WORD_1
    v_mfma_f32_32x32x16_bf16 v[160:175], v[220:223], v[252:255], v[160:175]
    s_cmp_eq_u32 s41, s78
    s_cbranch_scc1 L1_sig
L1_back:
    s_cmp_lg_u32 s41, 589824
    ds_read_u16_d16_hi v75, v159 offset:65152
    ds_read_b128 v[220:223], v1 offset:11616
    v_fmac_f32 v142, v77, v77
    v_add_f32 v8, v36, v37
    v_fmac_f32 v142, v7, v7
    v_fmac_f32 v142, v0, v0
    v_fmac_f32 v9, v37, v37
    v_add_f32 v8, v8, v38
    v_xor_b32 v1, 16384, v1
    v_fmac_f32 v9, v38, v38
    s_cbranch_scc1 L1_loop
    v_mbcnt_lo_u32_b32 v28, -1, 0
    v_mbcnt_hi_u32_b32 v28, -1, v28
    v_lshlrev_b32 v1, 4, v28
    s_waitcnt lgkmcnt(0)
    s_add_u32 s7, s8, s9
    s_add_u32 s10, s10, s11
    s_add_u32 s12, s12, s13
    s_add_u32 s14, s14, s15
    s_add_u32 s7, s7, s10
    s_add_u32 s12, s12, s14
    s_add_u32 s7, s7, s12
    s_cmp_eq_u32 s7, 288
    s_cbranch_scc1 L2j_ok
    v_lshlrev_b32 v2, 2, v28
    buffer_load_dword v12, v2, s[56:59], 0 offen offset:128 sc1
    s_waitcnt vmcnt(0)
    v_cmp_eq_u32 vcc, 36, v12
    s_nop 3
    s_cmp_eq_u32 vcc_lo, 255
    s_cbranch_scc1 L2j_ok
    s_mov_b32 s7, 20000
L2j_spin:
    s_sleep 2
    buffer_load_dword v12, v2, s[56:59], 0 offen offset:128 sc1
    s_waitcnt vmcnt(0)
    v_cmp_eq_u32 vcc, 36, v12
    s_nop 4
    s_cmp_eq_u32 vcc_lo, 255
    s_cbranch_scc1 L2j_ok
    s_sub_u32 s7, s7, 1
    s_cmp_lg_u32 s7, 0
    s_cbranch_scc1 L2j_spin
L2j_ok:
    s_add_u32 s64, s16, 255098880
    s_addc_u32 s65, s17, 0
    s_mov_b32 s66, 98304
    s_mov_b32 s67, 0x20000
    s_mul_i32 s23, s20, 24576
    buffer_load_dwordx4 a[0:3], v1, s[64:67], s23 offen offset:0 sc1
    buffer_load_dwordx4 a[4:7], v1, s[64:67], s23 offen offset:1024 sc1
    buffer_load_dwordx4 a[8:11], v1, s[64:67], s23 offen offset:2048 sc1
    buffer_load_dwordx4 a[12:15], v1, s[64:67], s23 offen offset:3072 sc1
    s_add_u32 s23, s23, 4096
    buffer_load_dwordx4 a[16:19], v1, s[64:67], s23 offen offset:0 sc1
    buffer_load_dwordx4 a[20:23], v1, s[64:67], s23 offen offset:1024 sc1
    v_fmac_f32 v142, v68, v68
    s_lshl_b32 s4, s20, 9
    s_add_u32 s4, s4, s53
    v_fmac_f32 v142, v69, v69
    s_lshl_b32 s5, s20, 8
    s_add_u32 s5, s5, s53
    s_add_u32 s5, s5, 2048
    v_fmac_f32 v142, v70, v70
    v_lshlrev_b32 v2, 2, v28
    v_bfe_u32 v3, v28, 2, 1
    v_fmac_f32 v142, v71, v71
    v_lshlrev_b32 v3, 5, v3
    v_bfe_u32 v4, v28, 5, 1
    v_lshl_add_u32 v3, v4, 4, v3
    v_lshlrev_b32_sdwa v160, 1, v160 dst_sel:DWORD dst_unused:UNUSED_PAD src0_sel:DWORD src1_sel:WORD_1
    v_bfe_u32 v4, v28, 3, 1
    v_lshl_add_u32 v3, v4, 3, v3
    v_lshlrev_b32_sdwa v161, 1, v161 dst_sel:DWORD dst_unused:UNUSED_PAD src0_sel:DWORD src1_sel:WORD_1
    v_bfe_u32 v4, v28, 4, 1
    v_lshl_add_u32 v3, v4, 2, v3
    v_and_b32 v4, 3, v28
    ds_read_u16_d16_hi v76, v160 offset:65152
    v_lshl_add_u32 v3, v4, 28, v3
    v_permlane16_swap_b32 v78, v79
    v_permlane16_swap_b32 v80, v81
    ds_read_u16_d16_hi v77, v161 offset:65152
    v_permlane16_swap_b32 v82, v83
    v_permlane16_swap_b32 v84, v85
    v_lshlrev_b32_sdwa v162, 1, v162 dst_sel:DWORD dst_unused:UNUSED_PAD src0_sel:DWORD src1_sel:WORD_1
    v_permlane16_swap_b32 v86, v87
    v_permlane16_swap_b32 v88, v89
    v_permlane16_swap_b32 v90, v91
    v_lshlrev_b32_sdwa v163, 1, v163 dst_sel:DWORD dst_unused:UNUSED_PAD src0_sel:DWORD src1_sel:WORD_1
    v_permlane16_swap_b32 v92, v93
    v_add_f32 v78, v78, v79
    ds_read_u16_d16_hi v7, v162 offset:65152
    v_add_f32 v80, v80, v81
    v_add_f32 v82, v82, v83
    v_add_f32 v84, v84, v85
    ds_read_u16_d16_hi v0, v163 offset:65152
    v_add_f32 v86, v86, v87
    v_add_f32 v88, v88, v89
    v_fmac_f32 v142, v72, v72
    v_add_f32 v90, v90, v91
    v_add_f32 v92, v92, v93
    v_permlane16_swap_b32 v94, v95
    v_fmac_f32 v142, v73, v73
    v_permlane16_swap_b32 v96, v97
    v_permlane16_swap_b32 v98, v99
    v_permlane16_swap_b32 v100, v101
    v_lshlrev_b32_sdwa v164, 1, v164 dst_sel:DWORD dst_unused:UNUSED_PAD src0_sel:DWORD src1_sel:WORD_1
    v_permlane16_swap_b32 v102, v103
    v_permlane16_swap_b32 v104, v105
    ds_read_u16_d16_hi v68, v164 offset:65152
    v_permlane16_swap_b32 v106, v107
    v_permlane16_swap_b32 v108, v109
    v_add_f32 v94, v94, v95
    v_fmac_f32 v142, v74, v74
    v_add_f32 v96, v96, v97
    v_add_f32 v98, v98, v99
    v_fmac_f32 v142, v75, v75
    v_add_f32 v100, v100, v101
    v_add_f32 v102, v102, v103
    v_add_f32 v104, v104, v105
    v_lshlrev_b32_sdwa v165, 1, v165 dst_sel:DWORD dst_unused:UNUSED_PAD src0_sel:DWORD src1_sel:WORD_1
    v_add_f32 v106, v106, v107
    v_add_f32 v108, v108, v109
    v_lshlrev_b32_sdwa v166, 1, v166 dst_sel:DWORD dst_unused:UNUSED_PAD src0_sel:DWORD src1_sel:WORD_1
    v_permlane16_swap_b32 v110, v111
    v_permlane16_swap_b32 v112, v113
    v_permlane16_swap_b32 v114, v115
    ds_read_u16_d16_hi v69, v165 offset:65152
    v_permlane16_swap_b32 v116, v117
    v_permlane16_swap_b32 v118, v119
    v_permlane16_swap_b32 v120, v121
    ds_read_u16_d16_hi v70, v166 offset:65152
    v_permlane16_swap_b32 v122, v123
    v_permlane16_swap_b32 v124, v125
    v_lshlrev_b32_sdwa v167, 1, v167 dst_sel:DWORD dst_unused:UNUSED_PAD src0_sel:DWORD src1_sel:WORD_1
    v_add_f32 v110, v110, v111
    v_add_f32 v112, v112, v113
    v_add_f32 v114, v114, v115
    ds_read_u16_d16_hi v71, v167 offset:65152
    v_add_f32 v116, v116, v117
    v_add_f32 v118, v118, v119
    v_lshlrev_b32_sdwa v168, 1, v168 dst_sel:DWORD dst_unused:UNUSED_PAD src0_sel:DWORD src1_sel:WORD_1
    v_add_f32 v120, v120, v121
    v_add_f32 v122, v122, v123
    v_add_f32 v124, v124, v125
    v_lshlrev_b32_sdwa v169, 1, v169 dst_sel:DWORD dst_unused:UNUSED_PAD src0_sel:DWORD src1_sel:WORD_1
    v_permlane16_swap_b32 v126, v127
    v_permlane16_swap_b32 v128, v129
    ds_read_u16_d16_hi v72, v168 offset:65152
    v_permlane16_swap_b32 v130, v131
    v_permlane16_swap_b32 v132, v133
    v_permlane16_swap_b32 v134, v135
    ds_read_u16_d16_hi v73, v169 offset:65152
    v_permlane16_swap_b32 v136, v137
    v_permlane16_swap_b32 v138, v139
    v_permlane16_swap_b32 v140, v141
    s_waitcnt lgkmcnt(6)
    v_fmac_f32 v143, v76, v76
    v_add_f32 v126, v126, v127
    v_add_f32 v128, v128, v129
    v_lshlrev_b32_sdwa v170, 1, v170 dst_sel:DWORD dst_unused:UNUSED_PAD src0_sel:DWORD src1_sel:WORD_1
    v_add_f32 v130, v130, v131
    v_add_f32 v132, v132, v133
    v_add_f32 v134, v134, v135
    v_lshlrev_b32_sdwa v171, 1, v171 dst_sel:DWORD dst_unused:UNUSED_PAD src0_sel:DWORD src1_sel:WORD_1
    v_add_f32 v136, v136, v137
    v_add_f32 v138, v138, v139
    ds_read_u16_d16_hi v74, v170 offset:65152
    v_add_f32 v140, v140, v141
    v_add_f32_dpp v78, v78, v78 row_ror:8 row_mask:0xf bank_mask:0x3
    v_add_f32_dpp v82, v82, v82 row_ror:8 row_mask:0xf bank_mask:0x3
    ds_read_u16_d16_hi v75, v171 offset:65152
    v_add_f32_dpp v86, v86, v86 row_ror:8 row_mask:0xf bank_mask:0x3
    v_add_f32_dpp v90, v90, v90 row_ror:8 row_mask:0xf bank_mask:0x3
    v_fmac_f32 v143, v77, v77
    v_add_f32_dpp v78, v80, v80 row_ror:8 row_mask:0xf bank_mask:0xc
    v_add_f32_dpp v82, v84, v84 row_ror:8 row_mask:0xf bank_mask:0xc
    v_add_f32_dpp v86, v88, v88 row_ror:8 row_mask:0xf bank_mask:0xc
    v_fmac_f32 v143, v7, v7
    v_add_f32_dpp v90, v92, v92 row_ror:8 row_mask:0xf bank_mask:0xc
    v_add_f32_dpp v94, v94, v94 row_ror:8 row_mask:0xf bank_mask:0x3
    v_add_f32_dpp v98, v98, v98 row_ror:8 row_mask:0xf bank_mask:0x3
    v_fmac_f32 v143, v0, v0
    v_add_f32_dpp v102, v102, v102 row_ror:8 row_mask:0xf bank_mask:0x3
    v_add_f32_dpp v106, v106, v106 row_ror:8 row_mask:0xf bank_mask:0x3
    v_lshlrev_b32_sdwa v172, 1, v172 dst_sel:DWORD dst_unused:UNUSED_PAD src0_sel:DWORD src1_sel:WORD_1
    v_add_f32_dpp v94, v96, v96 row_ror:8 row_mask:0xf bank_mask:0xc
    v_add_f32_dpp v98, v100, v100 row_ror:8 row_mask:0xf bank_mask:0xc
    v_add_f32_dpp v102, v104, v104 row_ror:8 row_mask:0xf bank_mask:0xc
    ds_read_u16_d16_hi v76, v172 offset:65152
    v_add_f32_dpp v106, v108, v108 row_ror:8 row_mask:0xf bank_mask:0xc
    v_add_f32_dpp v110, v110, v110 row_ror:8 row_mask:0xf bank_mask:0x3
    v_lshlrev_b32_sdwa v173, 1, v173 dst_sel:DWORD dst_unused:UNUSED_PAD src0_sel:DWORD src1_sel:WORD_1
    v_add_f32_dpp v114, v114, v114 row_ror:8 row_mask:0xf bank_mask:0x3
    v_add_f32_dpp v118, v118, v118 row_ror:8 row_mask:0xf bank_mask:0x3
    v_add_f32_dpp v122, v122, v122 row_ror:8 row_mask:0xf bank_mask:0x3
    v_lshlrev_b32_sdwa v174, 1, v174 dst_sel:DWORD dst_unused:UNUSED_PAD src0_sel:DWORD src1_sel:WORD_1
    v_add_f32_dpp v110, v112, v112 row_ror:8 row_mask:0xf bank_mask:0xc
    v_add_f32_dpp v114, v116, v116 row_ror:8 row_mask:0xf bank_mask:0xc
    ds_read_u16_d16_hi v77, v173 offset:65152
    v_add_f32_dpp v118, v120, v120 row_ror:8 row_mask:0xf bank_mask:0xc
    v_add_f32_dpp v122, v124, v124 row_ror:8 row_mask:0xf bank_mask:0xc
    v_add_f32_dpp v126, v126, v126 row_ror:8 row_mask:0xf bank_mask:0x3
    ds_read_u16_d16_hi v7, v174 offset:65152
    v_add_f32_dpp v130, v130, v130 row_ror:8 row_mask:0xf bank_mask:0x3
    v_add_f32_dpp v134, v134, v134 row_ror:8 row_mask:0xf bank_mask:0x3
    v_add_f32_dpp v138, v138, v138 row_ror:8 row_mask:0xf bank_mask:0x3
    s_waitcnt lgkmcnt(7)
    v_fmac_f32 v143, v68, v68
    v_add_f32_dpp v126, v128, v128 row_ror:8 row_mask:0xf bank_mask:0xc
    v_add_f32_dpp v130, v132, v132 row_ror:8 row_mask:0xf bank_mask:0xc
    v_fmac_f32 v143, v69, v69
    v_add_f32_dpp v134, v136, v136 row_ror:8 row_mask:0xf bank_mask:0xc
    v_add_f32_dpp v138, v140, v140 row_ror:8 row_mask:0xf bank_mask:0xc
    v_add_f32_dpp v78, v78, v78 row_half_mirror row_mask:0xf bank_mask:0x5
    v_lshlrev_b32_sdwa v175, 1, v175 dst_sel:DWORD dst_unused:UNUSED_PAD src0_sel:DWORD src1_sel:WORD_1
    v_add_f32_dpp v86, v86, v86 row_half_mirror row_mask:0xf bank_mask:0x5
    v_add_f32_dpp v94, v94, v94 row_half_mirror row_mask:0xf bank_mask:0x5
    ds_read_u16_d16_hi v0, v175 offset:65152
    v_add_f32_dpp v102, v102, v102 row_half_mirror row_mask:0xf bank_mask:0x5
    v_add_f32_dpp v110, v110, v110 row_half_mirror row_mask:0xf bank_mask:0x5
    v_add_f32_dpp v118, v118, v118 row_half_mirror row_mask:0xf bank_mask:0x5
    v_fmac_f32 v143, v70, v70
    v_add_f32_dpp v126, v126, v126 row_half_mirror row_mask:0xf bank_mask:0x5
    v_add_f32_dpp v134, v134, v134 row_half_mirror row_mask:0xf bank_mask:0x5
    v_fmac_f32 v143, v71, v71
    v_add_f32_dpp v78, v82, v82 row_half_mirror row_mask:0xf bank_mask:0xa
    v_add_f32_dpp v86, v90, v90 row_half_mirror row_mask:0xf bank_mask:0xa
    v_add_f32_dpp v94, v98, v98 row_half_mirror row_mask:0xf bank_mask:0xa
    s_waitcnt lgkmcnt(4)
    v_fmac_f32 v143, v72, v72
    v_add_f32_dpp v102, v106, v106 row_half_mirror row_mask:0xf bank_mask:0xa
    v_add_f32_dpp v110, v114, v114 row_half_mirror row_mask:0xf bank_mask:0xa
    v_add_f32_dpp v118, v122, v122 row_half_mirror row_mask:0xf bank_mask:0xa
    v_fmac_f32 v143, v73, v73
    v_add_f32_dpp v126, v130, v130 row_half_mirror row_mask:0xf bank_mask:0xa
    v_add_f32_dpp v134, v138, v138 row_half_mirror row_mask:0xf bank_mask:0xa
    v_fmac_f32 v143, v74, v74
    v_add_f32_dpp v78, v78, v78 quad_perm:[1,0,3,2] row_mask:0xf bank_mask:0xf
    v_add_f32_dpp v86, v86, v86 quad_perm:[1,0,3,2] row_mask:0xf bank_mask:0xf
    v_add_f32_dpp v94, v94, v94 quad_perm:[1,0,3,2] row_mask:0xf bank_mask:0xf
    v_fmac_f32 v143, v75, v75
    v_add_f32_dpp v102, v102, v102 quad_perm:[1,0,3,2] row_mask:0xf bank_mask:0xf
    v_add_f32_dpp v110, v110, v110 quad_perm:[1,0,3,2] row_mask:0xf bank_mask:0xf
    s_waitcnt lgkmcnt(0)
    v_fmac_f32 v143, v76, v76
    v_add_f32_dpp v118, v118, v118 quad_perm:[1,0,3,2] row_mask:0xf bank_mask:0xf
    v_add_f32_dpp v126, v126, v126 quad_perm:[1,0,3,2] row_mask:0xf bank_mask:0xf
    v_add_f32_dpp v134, v134, v134 quad_perm:[1,0,3,2] row_mask:0xf bank_mask:0xf
    v_fmac_f32 v143, v77, v77
    v_add_f32_dpp v78, v78, v78 quad_perm:[2,3,0,1] row_mask:0xf bank_mask:0xf
    v_add_f32_dpp v86, v86, v86 quad_perm:[2,3,0,1] row_mask:0xf bank_mask:0xf
    v_fmac_f32 v143, v7, v7
    v_add_f32_dpp v94, v94, v94 quad_perm:[2,3,0,1] row_mask:0xf bank_mask:0xf
    v_add_f32_dpp v102, v102, v102 quad_perm:[2,3,0,1] row_mask:0xf bank_mask:0xf
    v_add_f32_dpp v110, v110, v110 quad_perm:[2,3,0,1] row_mask:0xf bank_mask:0xf
    v_fmac_f32 v143, v0, v0
    v_add_f32_dpp v118, v118, v118 quad_perm:[2,3,0,1] row_mask:0xf bank_mask:0xf
    v_add_f32_dpp v126, v126, v126 quad_perm:[2,3,0,1] row_mask:0xf bank_mask:0xf
    v_add_f32_dpp v134, v134, v134 quad_perm:[2,3,0,1] row_mask:0xf bank_mask:0xf
    s_cmp_lg_u32 s85, 0
    s_cbranch_scc1 L1_go
    v_lshlrev_b32 v5, 20, v28
    v_mov_b32 v6, 1
    s_sub_u32 s7, s6, 64
    buffer_atomic_add v6, v5, s[56:59], s7 offen sc0
    v_mov_b32 v36, 0
    v_mov_b32 v37, 0
    v_mov_b32 v38, 0
    v_mov_b32 v39, 0
    v_mov_b32 v5, 0
    s_waitcnt vmcnt(0)
    v_readfirstlane_b32 s7, v6
    s_nop 3
    s_cmp_lg_u32 s7, 0
    s_cbranch_scc1 L1_poll
    buffer_store_dwordx4 v[36:39], v1, s[36:39], s53 offen sc1
    buffer_store_dwordx4 v[36:39], v1, s[36:39], s53 offen offset:1024 sc1
    buffer_store_dwordx4 v[36:39], v1, s[36:39], s53 offen offset:2048 sc1
    buffer_store_dwordx4 v[36:39], v1, s[36:39], s53 offen offset:3072 sc1
    v_mov_b32 v6, 1
    s_waitcnt vmcnt(0)
    buffer_store_dword v6, v5, s[56:59], s6 offen sc1
    s_branch L1_go
L1_poll:
    s_mov_b32 s8, 20000
L1_poll2:
    buffer_load_dword v6, v5, s[56:59], s6 offen sc1
    s_waitcnt vmcnt(0)
    v_readfirstlane_b32 s7, v6
    s_nop 3
    s_cmp_lg_u32 s7, 0
    s_cbranch_scc1 L1_go
    s_sleep 8
    s_sub_u32 s8, s8, 1
    s_cmp_lg_u32 s8, 0
    s_cbranch_scc1 L1_poll2
L1_go:
    buffer_atomic_add_f32 v78, v3, s[36:39], s4 offen offset:0
    buffer_atomic_add_f32 v86, v3, s[36:39], s4 offen offset:64
    buffer_atomic_add_f32 v94, v3, s[36:39], s4 offen offset:128
    buffer_atomic_add_f32 v102, v3, s[36:39], s4 offen offset:192
    buffer_atomic_add_f32 v110, v3, s[36:39], s4 offen offset:256
    buffer_atomic_add_f32 v118, v3, s[36:39], s4 offen offset:320
    buffer_atomic_add_f32 v126, v3, s[36:39], s4 offen offset:384
    buffer_atomic_add_f32 v134, v3, s[36:39], s4 offen offset:448
    v_permlane32_swap_b32 v142, v143
    v_add_f32 v142, v142, v143
    buffer_atomic_add_f32 v142, v2, s[36:39], s5 offen
    v_mov_b32 v0, v28
    v_mov_b32 v23, s20
    s_lshr_b32 s22, s20, 1
    s_lshl_b32 s22, s22, 7
    s_add_u32 s49, s21, s22
    s_add_u32 s49, s49, 98304
    s_lshl_b32 s48, s20, 12
    v_add_u32 v48, 0, v0
    v_mul_u32_u24 v48, 2731, v48
    v_lshrrev_b32 v48, 17, v48
    v_lshl_add_u32 v48, v23, 2, v48
    v_and_b32 v48, 7, v48
    v_xor_b32 v48, v48, v0
    v_lshl_add_u32 v10, v48, 4, s21
    v_add_u32 v48, 64, v0
    v_mul_u32_u24 v48, 2731, v48
    v_lshrrev_b32 v48, 17, v48
    v_lshl_add_u32 v48, v23, 2, v48
    v_and_b32 v48, 7, v48
    v_xor_b32 v48, v48, v0
    v_lshl_add_u32 v11, v48, 4, s21
    v_add_u32 v48, 128, v0
    v_mul_u32_u24 v48, 2731, v48
    v_lshrrev_b32 v48, 17, v48
    v_lshl_add_u32 v48, v23, 2, v48
    v_and_b32 v48, 7, v48
    v_xor_b32 v48, v48, v0
    v_lshl_add_u32 v12, v48, 4, s21
    s_mov_b32 s44, 208896
    s_barrier
    s_mov_b32 m0, s49
    s_nop 0
    buffer_load_dwordx4 v10, s[24:27], s44 offen offset:0 lds
    buffer_load_dwordx4 v11, s[24:27], s44 offen offset:1024 lds
    buffer_load_dwordx4 v12, s[24:27], s44 offen offset:2048 lds
    s_mov_b32 s44, 196608
    s_add_u32 s49, s49, 12544
    v_and_b32 v48, 31, v0
    v_lshlrev_b32 v20, 2, v48
    buffer_load_dword v26, v20, s[32:35], 0 offen offset:2176
    buffer_load_dword v27, v20, s[32:35], 0 offen offset:2048
    s_mov_b32 s47, 1792
    v_and_b32 v49, 15, v0
    buffer_load_dwordx4 a[24:27], v1, s[64:67], s23 offen offset:2048 sc1
    buffer_load_dwordx4 a[28:31], v1, s[64:67], s23 offen offset:3072 sc1
    s_add_u32 s23, s23, 4096
    buffer_load_dwordx4 a[32:35], v1, s[64:67], s23 offen offset:0 sc1
    buffer_load_dwordx4 a[36:39], v1, s[64:67], s23 offen offset:1024 sc1
    buffer_load_dwordx4 a[40:43], v1, s[64:67], s23 offen offset:2048 sc1
    buffer_load_dwordx4 a[44:47], v1, s[64:67], s23 offen offset:3072 sc1
    s_add_u32 s23, s23, 4096
    s_mov_b32 m0, s49
    s_nop 0
    buffer_load_dwordx4 v10, s[24:27], s44 offen offset:0 lds
    buffer_load_dwordx4 v11, s[24:27], s44 offen offset:1024 lds
    buffer_load_dwordx4 v12, s[24:27], s44 offen offset:2048 lds
    s_mov_b32 s44, 184320
    s_add_u32 s49, s49, 12544
    v_lshlrev_b32 v50, 7, v0
    s_lshl_b32 s7, s20, 13
    s_add_u32 s7, s7, L2a_ok-L1_pc
    s_mov_b32 m0, 161280
    s_nop 0
    buffer_load_dword v50, s[80:83], s7 offen lds
    s_add_u32 s60, s16, 254803968
    s_addc_u32 s61, s17, 0
    s_mov_b32 s62, 294912
    s_mov_b32 s63, 0x20000
    v_add_u32 v13, s48, v1
    s_mov_b32 s45, 557056
    s_mul_i32 s22, s20, 73728
    s_mul_i32 s3, s2, 221184
    s_add_u32 s40, s76, s3
    s_addc_u32 s41, s77, 0
    s_mov_b32 s42, 0
    s_mov_b32 s43, 0x20000
    s_mov_b32 s46, 221184
    s_mov_b32 s50, 25088
    s_mov_b32 s52, 4294929664
    s_mov_b32 s53, 4294942208
    s_mov_b32 s51, 9
    s_mov_b32 s10, 0x409d30fc
    s_mov_b32 s11, 0x409d30fc
    v_add_u32 v2, 65536, v1
    v_lshrrev_b32 v24, 5, v0
    v_bfe_u32 v25, v0, 1, 3
    v_xor_b32 v3, v24, v25
    v_lshlrev_b32 v3, 4, v3
    v_mul_u32_u24 v32, 384, v48
    v_add_u32 v3, v3, v32
    v_bfe_u32 v32, v0, 4, 1
    v_lshl_add_u32 v3, v32, 7, v3
    v_add_u32 v3, 98304, v3
    v_xor_b32 v4, 32, v3
    v_xor_b32 v5, 64, v3
    v_xor_b32 v6, 0x60, v3
    v_lshlrev_b32 v14, 13, v32
    v_lshl_add_u32 v14, v24, 8, v14
    v_lshl_add_u32 v14, v49, 4, v14
    v_lshl_add_u32 v14, v23, 11, v14
    v_add_u32 v14, 65536, v14
    v_and_b32 v116, 15, v0
    v_lshrrev_b32 v117, 5, v0
    v_bfe_u32 v118, v0, 1, 3
    v_lshrrev_b32 v33, 4, v0
    v_mul_u32_u24 v15, 400, v116
    v_lshl_add_u32 v15, v33, 3, v15
    v_mul_u32_u24 v32, 96, v23
    v_add_u32 v15, v15, v32
    v_add_u32 v15, 148480, v15
    v_add_u32 v32, 0, v0
    v_mul_u32_u24 v34, 2731, v32
    v_lshrrev_b32 v34, 16, v34
    v_lshlrev_b32 v32, 4, v32
    v_lshl_add_u32 v16, v34, 4, v32
    v_mul_u32_u24 v34, 1600, v23
    v_add_u32 v16, v16, v34
    v_add_u32 v16, 148480, v16
    v_mul_u32_u24 v34, 1536, v23
    v_add_u32 v18, v32, v34
    v_add_u32 v32, 64, v0
    v_mul_u32_u24 v34, 2731, v32
    v_lshrrev_b32 v34, 16, v34
    v_lshlrev_b32 v32, 4, v32
    v_lshl_add_u32 v17, v34, 4, v32
    v_mul_u32_u24 v34, 1600, v23
    v_add_u32 v17, v17, v34
    v_add_u32 v17, 148480, v17
    v_mul_u32_u24 v34, 1536, v23
    v_add_u32 v19, v32, v34
    v_lshlrev_b32 v32, 30, v117
    v_add_u32 v19, v19, v32
    s_mul_i32 s6, s20, 3
    s_add_u32 s6, s6, 0
    s_and_b32 s7, s6, 1
    s_lshr_b32 s6, s6, 1
    s_lshl_b32 s6, s6, 2
    v_add_u32 v32, s6, v33
    v_lshrrev_b32 v34, 3, v32
    v_and_b32 v32, 7, v32
    v_xor_b32 v32, v32, v118
    v_lshlrev_b32 v32, 4, v32
    v_lshl_add_u32 v32, v34, 7, v32
    v_mul_u32_u24 v34, 384, v116
    v_add_u32 v32, v32, v34
    v_mov_b32 v34, 6144
    v_cmp_eq_u32 vcc, s7, v117
    s_nop 1
    v_cndmask_b32 v32, v34, v32, vcc
    v_add_u32 v7, 98304, v32
    v_bfe_u32 v32, v0, 4, 1
    v_lshrrev_b32 v34, 3, v116
    v_cmp_eq_u32 s[12:13], v32, v34
    s_nop 3
    s_and_b64 s[12:13], s[12:13], vcc
    v_cmp_eq_u32 s[14:15], 0, v32
    s_nop 3
    s_andn2_b64 s[14:15], s[14:15], vcc
    v_and_b32 v32, 1, v0
    v_lshlrev_b32 v32, 4, v32
    v_mov_b32 v34, 0x3f80
    v_lshlrev_b32 v32, v32, v34
    v_cndmask_b32 v32, 0, v32, s[12:13]
    v_bfe_u32 v34, v0, 1, 2
    v_cmp_eq_u32 vcc, 0, v34
    s_nop 1
    v_cndmask_b32 v36, 0, v32, vcc
    v_cmp_eq_u32 vcc, 1, v34
    s_nop 1
    v_cndmask_b32 v37, 0, v32, vcc
    v_cmp_eq_u32 vcc, 2, v34
    s_nop 1
    v_cndmask_b32 v38, 0, v32, vcc
    v_cmp_eq_u32 vcc, 3, v34
    s_nop 1
    v_cndmask_b32 v39, 0, v32, vcc
    s_mov_b64 s[54:55], s[14:15]
    s_mul_i32 s6, s20, 3
    s_add_u32 s6, s6, 1
    s_and_b32 s7, s6, 1
    s_lshr_b32 s6, s6, 1
    s_lshl_b32 s6, s6, 2
    v_add_u32 v32, s6, v33
    v_lshrrev_b32 v34, 3, v32
    v_and_b32 v32, 7, v32
    v_xor_b32 v32, v32, v118
    v_lshlrev_b32 v32, 4, v32
    v_lshl_add_u32 v32, v34, 7, v32
    v_mul_u32_u24 v34, 384, v116
    v_add_u32 v32, v32, v34
    v_mov_b32 v34, 6144
    v_cmp_eq_u32 vcc, s7, v117
    s_nop 1
    v_cndmask_b32 v32, v34, v32, vcc
    v_add_u32 v8, 98304, v32
    v_bfe_u32 v32, v0, 4, 1
    v_lshrrev_b32 v34, 3, v116
    v_cmp_eq_u32 s[12:13], v32, v34
    s_nop 3
    s_and_b64 s[12:13], s[12:13], vcc
    v_cmp_eq_u32 s[14:15], 0, v32
    s_nop 3
    s_andn2_b64 s[14:15], s[14:15], vcc
    v_and_b32 v32, 1, v0
    v_lshlrev_b32 v32, 4, v32
    v_mov_b32 v34, 0x3f80
    v_lshlrev_b32 v32, v32, v34
    v_cndmask_b32 v32, 0, v32, s[12:13]
    v_bfe_u32 v34, v0, 1, 2
    v_cmp_eq_u32 vcc, 0, v34
    s_nop 1
    v_cndmask_b32 v40, 0, v32, vcc
    v_cmp_eq_u32 vcc, 1, v34
    s_nop 1
    v_cndmask_b32 v41, 0, v32, vcc
    v_cmp_eq_u32 vcc, 2, v34
    s_nop 1
    v_cndmask_b32 v42, 0, v32, vcc
    v_cmp_eq_u32 vcc, 3, v34
    s_nop 1
    v_cndmask_b32 v43, 0, v32, vcc
    s_mov_b64 s[18:19], s[14:15]
    s_mul_i32 s6, s20, 3
    s_add_u32 s6, s6, 2
    s_and_b32 s7, s6, 1
    s_lshr_b32 s6, s6, 1
    s_lshl_b32 s6, s6, 2
    v_add_u32 v32, s6, v33
    v_lshrrev_b32 v34, 3, v32
    v_and_b32 v32, 7, v32
    v_xor_b32 v32, v32, v118
    v_lshlrev_b32 v32, 4, v32
    v_lshl_add_u32 v32, v34, 7, v32
    v_mul_u32_u24 v34, 384, v116
    v_add_u32 v32, v32, v34
    v_mov_b32 v34, 6144
    v_cmp_eq_u32 vcc, s7, v117
    s_nop 1
    v_cndmask_b32 v32, v34, v32, vcc
    v_add_u32 v9, 98304, v32
    v_bfe_u32 v32, v0, 4, 1
    v_lshrrev_b32 v34, 3, v116
    v_cmp_eq_u32 s[12:13], v32, v34
    s_nop 3
    s_and_b64 s[12:13], s[12:13], vcc
    v_cmp_eq_u32 s[14:15], 0, v32
    s_nop 3
    s_andn2_b64 s[14:15], s[14:15], vcc
    v_and_b32 v32, 1, v0
    v_lshlrev_b32 v32, 4, v32
    v_mov_b32 v34, 0x3f80
    v_lshlrev_b32 v32, v32, v34
    v_cndmask_b32 v32, 0, v32, s[12:13]
    v_bfe_u32 v34, v0, 1, 2
    v_cmp_eq_u32 vcc, 0, v34
    s_nop 1
    v_cndmask_b32 v44, 0, v32, vcc
    v_cmp_eq_u32 vcc, 1, v34
    s_nop 1
    v_cndmask_b32 v45, 0, v32, vcc
    v_cmp_eq_u32 vcc, 2, v34
    s_nop 1
    v_cndmask_b32 v46, 0, v32, vcc
    v_cmp_eq_u32 vcc, 3, v34
    s_nop 1
    v_cndmask_b32 v47, 0, v32, vcc
    s_mov_b64 s[14:15], s[14:15]
    s_waitcnt vmcnt(15)
    s_barrier
    s_cmp_eq_u32 s20, 0
    s_cselect_b32 s7, 0, 0x1000
    v_mov_b32 v123, 1
    v_lshlrev_b32 v51, 20, v0
    buffer_atomic_add v123, v51, s[56:59], s7 offen offset:192 sc0
    s_and_b32 s79, s2, 7
    s_lshl_b32 s79, s79, 12
    s_bfe_u32 s7, s2, 0x30003
    s_lshl_b32 s7, s7, 7
    s_add_u32 s79, s79, s7
    v_lshl_add_u32 v124, v23, 6, v0
    v_lshlrev_b32 v124, 20, v124
    buffer_load_dwordx4 a[48:51], v1, s[64:67], s23 offen offset:0 sc1
    buffer_load_dwordx4 a[52:55], v1, s[64:67], s23 offen offset:1024 sc1
    buffer_load_dwordx4 a[56:59], v1, s[64:67], s23 offen offset:2048 sc1
    buffer_load_dwordx4 a[60:63], v1, s[64:67], s23 offen offset:3072 sc1
    s_add_u32 s23, s23, 4096
    buffer_load_dwordx4 a[64:67], v1, s[64:67], s23 offen offset:0 sc1
    buffer_load_dwordx4 a[68:71], v1, s[64:67], s23 offen offset:1024 sc1
    buffer_load_dwordx4 a[72:75], v1, s[64:67], s23 offen offset:2048 sc1
    buffer_load_dwordx4 a[76:79], v1, s[64:67], s23 offen offset:3072 sc1
    s_add_u32 s23, s23, 4096
    buffer_load_dwordx4 a[80:83], v1, s[64:67], s23 offen offset:0 sc1
    buffer_load_dwordx4 a[84:87], v1, s[64:67], s23 offen offset:1024 sc1
    buffer_load_dwordx4 a[88:91], v1, s[64:67], s23 offen offset:2048 sc1
    buffer_load_dwordx4 a[92:95], v1, s[64:67], s23 offen offset:3072 sc1
    s_add_u32 s23, s23, 4096
    s_mov_b32 s68, s72
    s_mov_b32 s69, s73
    s_mov_b32 s70, 1536
    s_mov_b32 s71, 0x20000
    s_mov_b32 s72, s74
    s_mov_b32 s73, s75
    s_mov_b32 s74, 1536
    s_mov_b32 s75, 0x20000
    s_lshl_b32 s7, s20, 10
    s_add_u32 m0, s7, 151552
    s_nop 0
    buffer_load_dwordx4 v1, s[72:75], s7 offen lds
    s_waitcnt vmcnt(15)
    s_barrier
    s_waitcnt vmcnt(13)
    v_readfirstlane_b32 s7, v123
    s_nop 3
    s_cmp_lg_u32 s7, 255
    s_cbranch_scc1 L2_notlast
    v_and_b32 v52, 7, v0
    v_lshlrev_b32 v52, 12, v52
    v_lshrrev_b32 v51, 3, v0
    v_lshl_add_u32 v52, v51, 7, v52
    v_mov_b32 v51, 1
    buffer_store_dword v51, v52, s[36:39], 0 offen offset:3072 sc1
L2_notlast:
    ds_read_b128 v[56:59], v3 offset:0
    ds_read_b128 v[60:63], v4 offset:0
    ds_read_b128 v[64:67], v5 offset:0
    s_waitcnt lgkmcnt(2)
    v_mfma_f32_32x32x16_bf16 v[100:115], a[0:3], v[56:59], 0
    ds_read_b128 v[56:59], v6 offset:0
    buffer_load_dwordx4 a[96:99], v1, s[60:63], s22 offen offset:0 sc1
    s_waitcnt lgkmcnt(2)
    v_mfma_f32_32x32x16_bf16 v[100:115], a[4:7], v[60:63], v[100:115]
    ds_read_b128 v[60:63], v3 offset:128
    buffer_load_dwordx4 a[100:103], v1, s[60:63], s22 offen offset:1024 sc1
    s_waitcnt lgkmcnt(2)
    v_mfma_f32_32x32x16_bf16 v[100:115], a[8:11], v[64:67], v[100:115]
    ds_read_b128 v[64:67], v4 offset:128
    buffer_load_dwordx4 a[104:107], v1, s[60:63], s22 offen offset:2048 sc1
    s_waitcnt lgkmcnt(2)
    v_mfma_f32_32x32x16_bf16 v[100:115], a[12:15], v[56:59], v[100:115]
    ds_read_b128 v[56:59], v5 offset:128
    buffer_load_dwordx4 a[108:111], v1, s[60:63], s22 offen offset:3072 sc1
    s_add_u32 s22, s22, 4096
    s_waitcnt lgkmcnt(2)
    v_mfma_f32_32x32x16_bf16 v[100:115], a[16:19], v[60:63], v[100:115]
    ds_read_b128 v[60:63], v6 offset:128
    buffer_load_dwordx4 a[112:115], v1, s[60:63], s22 offen offset:0 sc1
    s_waitcnt lgkmcnt(2)
    v_mfma_f32_32x32x16_bf16 v[100:115], a[20:23], v[64:67], v[100:115]
    ds_read_b128 v[64:67], v3 offset:256
    buffer_load_dwordx4 a[116:119], v1, s[60:63], s22 offen offset:1024 sc1
    s_waitcnt lgkmcnt(2)
    v_mfma_f32_32x32x16_bf16 v[100:115], a[24:27], v[56:59], v[100:115]
    ds_read_b128 v[56:59], v4 offset:256
    buffer_load_dwordx4 a[120:123], v1, s[60:63], s22 offen offset:2048 sc1
    s_waitcnt lgkmcnt(2)
    v_mfma_f32_32x32x16_bf16 v[100:115], a[28:31], v[60:63], v[100:115]
    ds_read_b128 v[60:63], v5 offset:256
    buffer_load_dwordx4 a[124:127], v1, s[60:63], s22 offen offset:3072 sc1
    s_add_u32 s22, s22, 4096
    s_waitcnt lgkmcnt(2)
    v_mfma_f32_32x32x16_bf16 v[100:115], a[32:35], v[64:67], v[100:115]
    ds_read_b128 v[64:67], v6 offset:256
    buffer_load_dwordx4 a[128:131], v1, s[60:63], s22 offen offset:0 sc1
    s_waitcnt lgkmcnt(2)
    v_mfma_f32_32x32x16_bf16 v[100:115], a[36:39], v[56:59], v[100:115]
    buffer_load_dwordx4 a[132:135], v1, s[60:63], s22 offen offset:1024 sc1
    s_waitcnt lgkmcnt(1)
    v_mfma_f32_32x32x16_bf16 v[100:115], a[40:43], v[60:63], v[100:115]
    buffer_load_dwordx4 a[136:139], v1, s[60:63], s22 offen offset:2048 sc1
    s_waitcnt lgkmcnt(0)
    v_mfma_f32_32x32x16_bf16 v[100:115], a[44:47], v[64:67], v[100:115]
    buffer_load_dwordx4 a[140:143], v1, s[60:63], s22 offen offset:3072 sc1
    s_add_u32 s22, s22, 4096
    s_nop 9
    v_pk_mul_f32 v[100:101], v[100:101], v[26:27] op_sel:[0,0] op_sel_hi:[1,0]
    buffer_load_dwordx4 a[144:147], v1, s[60:63], s22 offen offset:0 sc1
    v_pk_mul_f32 v[102:103], v[102:103], v[26:27] op_sel:[0,0] op_sel_hi:[1,0]
    v_pk_mul_f32 v[104:105], v[104:105], v[26:27] op_sel:[0,0] op_sel_hi:[1,0]
    v_pk_mul_f32 v[106:107], v[106:107], v[26:27] op_sel:[0,0] op_sel_hi:[1,0]
    buffer_load_dwordx4 a[148:151], v1, s[60:63], s22 offen offset:1024 sc1
    v_pk_fma_f32 v[68:69], v[100:101], v[100:101], s[10:11]
    v_pk_fma_f32 v[70:71], v[102:103], v[102:103], s[10:11]
    v_pk_fma_f32 v[72:73], v[104:105], v[104:105], s[10:11]
    buffer_load_dwordx4 a[152:155], v1, s[60:63], s22 offen offset:2048 sc1
    v_pk_fma_f32 v[74:75], v[106:107], v[106:107], s[10:11]
    v_pk_mul_f32 v[68:69], v[68:69], v[100:101]
    v_pk_mul_f32 v[70:71], v[70:71], v[102:103]
    buffer_load_dwordx4 a[156:159], v1, s[60:63], s22 offen offset:3072 sc1
    s_add_u32 s22, s22, 4096
    v_pk_mul_f32 v[72:73], v[72:73], v[104:105]
    v_pk_mul_f32 v[74:75], v[74:75], v[106:107]
    v_exp_f32_e64 v68, -v68
    buffer_load_dwordx4 a[160:163], v1, s[60:63], s22 offen offset:0 sc1
    v_exp_f32_e64 v69, -v69
    v_exp_f32_e64 v70, -v70
    v_exp_f32_e64 v71, -v71
    buffer_load_dwordx4 a[164:167], v1, s[60:63], s22 offen offset:1024 sc1
    v_exp_f32_e64 v72, -v72
    v_exp_f32_e64 v73, -v73
    v_exp_f32_e64 v74, -v74
    buffer_load_dwordx4 a[168:171], v1, s[60:63], s22 offen offset:2048 sc1
    v_exp_f32_e64 v75, -v75
    v_pk_add_f32 v[68:69], v[68:69], 1.0 op_sel_hi:[1,0]
    v_pk_add_f32 v[70:71], v[70:71], 1.0 op_sel_hi:[1,0]
    buffer_load_dwordx4 a[172:175], v1, s[60:63], s22 offen offset:3072 sc1
    s_add_u32 s22, s22, 4096
    v_pk_add_f32 v[72:73], v[72:73], 1.0 op_sel_hi:[1,0]
    v_pk_add_f32 v[74:75], v[74:75], 1.0 op_sel_hi:[1,0]
    v_rcp_f32 v68, v68
    buffer_load_dwordx4 a[176:179], v1, s[60:63], s22 offen offset:0 sc1
    v_rcp_f32 v69, v69
    v_rcp_f32 v70, v70
    v_rcp_f32 v71, v71
    buffer_load_dwordx4 a[180:183], v1, s[60:63], s22 offen offset:1024 sc1
    v_rcp_f32 v72, v72
    v_rcp_f32 v73, v73
    v_rcp_f32 v74, v74
    buffer_load_dwordx4 a[184:187], v1, s[60:63], s22 offen offset:2048 sc1
    v_rcp_f32 v75, v75
    v_pk_mul_f32 v[100:101], v[100:101], v[68:69]
    v_pk_mul_f32 v[102:103], v[102:103], v[70:71]
    buffer_load_dwordx4 a[188:191], v1, s[60:63], s22 offen offset:3072 sc1
    s_add_u32 s22, s22, 4096
    v_pk_mul_f32 v[104:105], v[104:105], v[72:73]
    v_pk_mul_f32 v[106:107], v[106:107], v[74:75]
    v_cvt_pk_bf16_f32 v48, v100, v101
    buffer_load_dwordx4 a[192:195], v1, s[60:63], s22 offen offset:0 sc1
    v_cvt_pk_bf16_f32 v49, v102, v103
    v_cvt_pk_bf16_f32 v50, v104, v105
    v_cvt_pk_bf16_f32 v51, v106, v107
    buffer_load_dwordx4 a[196:199], v1, s[60:63], s22 offen offset:1024 sc1
    v_pk_mul_f32 v[108:109], v[108:109], v[26:27] op_sel:[0,0] op_sel_hi:[1,0]
    v_pk_mul_f32 v[110:111], v[110:111], v[26:27] op_sel:[0,0] op_sel_hi:[1,0]
    v_pk_mul_f32 v[112:113], v[112:113], v[26:27] op_sel:[0,0] op_sel_hi:[1,0]
    buffer_load_dwordx4 a[200:203], v1, s[60:63], s22 offen offset:2048 sc1
    v_pk_mul_f32 v[114:115], v[114:115], v[26:27] op_sel:[0,0] op_sel_hi:[1,0]
    v_pk_fma_f32 v[68:69], v[108:109], v[108:109], s[10:11]
    v_pk_fma_f32 v[70:71], v[110:111], v[110:111], s[10:11]
    buffer_load_dwordx4 a[204:207], v1, s[60:63], s22 offen offset:3072 sc1
    s_add_u32 s22, s22, 4096
    v_pk_fma_f32 v[72:73], v[112:113], v[112:113], s[10:11]
    v_pk_fma_f32 v[74:75], v[114:115], v[114:115], s[10:11]
    v_pk_mul_f32 v[68:69], v[68:69], v[108:109]
    buffer_load_dwordx4 a[208:211], v1, s[60:63], s22 offen offset:0 sc1
    v_pk_mul_f32 v[70:71], v[70:71], v[110:111]
    v_pk_mul_f32 v[72:73], v[72:73], v[112:113]
    v_pk_mul_f32 v[74:75], v[74:75], v[114:115]
    buffer_load_dwordx4 a[212:215], v1, s[60:63], s22 offen offset:1024 sc1
    v_exp_f32_e64 v68, -v68
    v_exp_f32_e64 v69, -v69
    v_exp_f32_e64 v70, -v70
    buffer_load_dwordx4 a[216:219], v1, s[60:63], s22 offen offset:2048 sc1
    v_exp_f32_e64 v71, -v71
    v_exp_f32_e64 v72, -v72
    v_exp_f32_e64 v73, -v73
    buffer_load_dwordx4 a[220:223], v1, s[60:63], s22 offen offset:3072 sc1
    s_add_u32 s22, s22, 4096
    v_exp_f32_e64 v74, -v74
    v_exp_f32_e64 v75, -v75
    v_pk_add_f32 v[68:69], v[68:69], 1.0 op_sel_hi:[1,0]
    buffer_load_dwordx4 a[224:227], v1, s[60:63], s22 offen offset:0 sc1
    v_pk_add_f32 v[70:71], v[70:71], 1.0 op_sel_hi:[1,0]
    v_pk_add_f32 v[72:73], v[72:73], 1.0 op_sel_hi:[1,0]
    v_pk_add_f32 v[74:75], v[74:75], 1.0 op_sel_hi:[1,0]
    buffer_load_dwordx4 a[228:231], v1, s[60:63], s22 offen offset:1024 sc1
    v_rcp_f32 v68, v68
    v_rcp_f32 v69, v69
    v_rcp_f32 v70, v70
    buffer_load_dwordx4 a[232:235], v1, s[60:63], s22 offen offset:2048 sc1
    v_rcp_f32 v71, v71
    v_rcp_f32 v72, v72
    v_rcp_f32 v73, v73
    buffer_load_dwordx4 a[236:239], v1, s[60:63], s22 offen offset:3072 sc1
    s_add_u32 s22, s22, 4096
    v_rcp_f32 v74, v74
    v_rcp_f32 v75, v75
    v_pk_mul_f32 v[108:109], v[108:109], v[68:69]
    buffer_load_dwordx4 a[240:243], v1, s[60:63], s22 offen offset:0 sc1
    v_pk_mul_f32 v[110:111], v[110:111], v[70:71]
    v_pk_mul_f32 v[112:113], v[112:113], v[72:73]
    v_pk_mul_f32 v[114:115], v[114:115], v[74:75]
    buffer_load_dwordx4 a[244:247], v1, s[60:63], s22 offen offset:1024 sc1
    v_cvt_pk_bf16_f32 v52, v108, v109
    v_cvt_pk_bf16_f32 v53, v110, v111
    v_cvt_pk_bf16_f32 v54, v112, v113
    buffer_load_dwordx4 a[248:251], v1, s[60:63], s22 offen offset:2048 sc1
    v_cvt_pk_bf16_f32 v55, v114, v115
    ds_write_b128 v14, v[48:51] offset:0
    ds_write_b128 v14, v[52:55] offset:512
    buffer_load_dwordx4 a[252:255], v1, s[60:63], s22 offen offset:3072 sc1
    s_add_u32 s22, s22, 4096
    ds_read_b128 v[56:59], v3 offset:0
    ds_read_b128 v[60:63], v4 offset:0
    ds_read_b128 v[64:67], v5 offset:0
    s_waitcnt vmcnt(52) lgkmcnt(2)
    v_mfma_f32_32x32x16_bf16 v[84:99], a[48:51], v[56:59], 0
    ds_read_b128 v[56:59], v6 offset:0
    buffer_load_dwordx4 v[160:163], v1, s[60:63], s22 offen offset:0 sc1
    s_waitcnt vmcnt(52) lgkmcnt(2)
    v_mfma_f32_32x32x16_bf16 v[84:99], a[52:55], v[60:63], v[84:99]
    ds_read_b128 v[60:63], v3 offset:128
    buffer_load_dwordx4 v[164:167], v1, s[60:63], s22 offen offset:1024 sc1
    s_waitcnt vmcnt(52) lgkmcnt(2)
    v_mfma_f32_32x32x16_bf16 v[84:99], a[56:59], v[64:67], v[84:99]
    ds_read_b128 v[64:67], v4 offset:128
    buffer_load_dwordx4 v[168:171], v1, s[60:63], s22 offen offset:2048 sc1
    s_waitcnt vmcnt(52) lgkmcnt(2)
    v_mfma_f32_32x32x16_bf16 v[84:99], a[60:63], v[56:59], v[84:99]
    ds_read_b128 v[56:59], v5 offset:128
    buffer_load_dwordx4 v[172:175], v1, s[60:63], s22 offen offset:3072 sc1
    s_add_u32 s22, s22, 4096
    s_waitcnt vmcnt(52) lgkmcnt(2)
    v_mfma_f32_32x32x16_bf16 v[84:99], a[64:67], v[60:63], v[84:99]
    ds_read_b128 v[60:63], v6 offset:128
    buffer_load_dwordx4 v[176:179], v1, s[60:63], s22 offen offset:0 sc1
    s_waitcnt vmcnt(52) lgkmcnt(2)
    v_mfma_f32_32x32x16_bf16 v[84:99], a[68:71], v[64:67], v[84:99]
    ds_read_b128 v[64:67], v3 offset:256
    buffer_load_dwordx4 v[180:183], v1, s[60:63], s22 offen offset:1024 sc1
    s_waitcnt vmcnt(52) lgkmcnt(2)
    v_mfma_f32_32x32x16_bf16 v[84:99], a[72:75], v[56:59], v[84:99]
    ds_read_b128 v[56:59], v4 offset:256
    buffer_load_dwordx4 v[184:187], v1, s[60:63], s22 offen offset:2048 sc1
    s_waitcnt vmcnt(52) lgkmcnt(2)
    v_mfma_f32_32x32x16_bf16 v[84:99], a[76:79], v[60:63], v[84:99]
    ds_read_b128 v[60:63], v5 offset:256
    buffer_load_dwordx4 v[188:191], v1, s[60:63], s22 offen offset:3072 sc1
    s_add_u32 s22, s22, 4096
    s_waitcnt vmcnt(52) lgkmcnt(2)
    v_mfma_f32_32x32x16_bf16 v[84:99], a[80:83], v[64:67], v[84:99]
    ds_read_b128 v[64:67], v6 offset:256
    s_waitcnt vmcnt(51) lgkmcnt(2)
    v_mfma_f32_32x32x16_bf16 v[84:99], a[84:87], v[56:59], v[84:99]
    s_waitcnt vmcnt(50) lgkmcnt(1)
    v_mfma_f32_32x32x16_bf16 v[84:99], a[88:91], v[60:63], v[84:99]
    s_waitcnt vmcnt(49) lgkmcnt(0)
    v_mfma_f32_32x32x16_bf16 v[84:99], a[92:95], v[64:67], v[84:99]
    s_nop 11
    v_pk_mul_f32 v[84:85], v[84:85], v[26:27] op_sel:[0,0] op_sel_hi:[1,0]
    v_pk_mul_f32 v[86:87], v[86:87], v[26:27] op_sel:[0,0] op_sel_hi:[1,0]
    v_pk_mul_f32 v[88:89], v[88:89], v[26:27] op_sel:[0,0] op_sel_hi:[1,0]
    v_pk_mul_f32 v[90:91], v[90:91], v[26:27] op_sel:[0,0] op_sel_hi:[1,0]
    v_pk_fma_f32 v[68:69], v[84:85], v[84:85], s[10:11]
    v_pk_fma_f32 v[70:71], v[86:87], v[86:87], s[10:11]
    v_pk_fma_f32 v[72:73], v[88:89], v[88:89], s[10:11]
    v_pk_fma_f32 v[74:75], v[90:91], v[90:91], s[10:11]
    v_pk_mul_f32 v[68:69], v[68:69], v[84:85]
    v_pk_mul_f32 v[70:71], v[70:71], v[86:87]
    v_pk_mul_f32 v[72:73], v[72:73], v[88:89]
    v_pk_mul_f32 v[74:75], v[74:75], v[90:91]
    v_exp_f32_e64 v68, -v68
    v_exp_f32_e64 v69, -v69
    v_exp_f32_e64 v70, -v70
    v_exp_f32_e64 v71, -v71
    v_exp_f32_e64 v72, -v72
    v_exp_f32_e64 v73, -v73
    v_exp_f32_e64 v74, -v74
    v_exp_f32_e64 v75, -v75
    v_pk_add_f32 v[68:69], v[68:69], 1.0 op_sel_hi:[1,0]
    v_pk_add_f32 v[70:71], v[70:71], 1.0 op_sel_hi:[1,0]
    v_pk_add_f32 v[72:73], v[72:73], 1.0 op_sel_hi:[1,0]
    v_pk_add_f32 v[74:75], v[74:75], 1.0 op_sel_hi:[1,0]
    v_rcp_f32 v68, v68
    v_rcp_f32 v69, v69
    v_rcp_f32 v70, v70
    v_rcp_f32 v71, v71
    v_rcp_f32 v72, v72
    v_rcp_f32 v73, v73
    v_rcp_f32 v74, v74
    v_rcp_f32 v75, v75
    v_pk_mul_f32 v[84:85], v[84:85], v[68:69]
    v_pk_mul_f32 v[86:87], v[86:87], v[70:71]
    v_pk_mul_f32 v[88:89], v[88:89], v[72:73]
    v_pk_mul_f32 v[90:91], v[90:91], v[74:75]
    v_cvt_pk_bf16_f32 v48, v84, v85
    v_cvt_pk_bf16_f32 v49, v86, v87
    v_cvt_pk_bf16_f32 v50, v88, v89
    v_cvt_pk_bf16_f32 v51, v90, v91
    v_pk_mul_f32 v[92:93], v[92:93], v[26:27] op_sel:[0,0] op_sel_hi:[1,0]
    v_pk_mul_f32 v[94:95], v[94:95], v[26:27] op_sel:[0,0] op_sel_hi:[1,0]
    v_pk_mul_f32 v[96:97], v[96:97], v[26:27] op_sel:[0,0] op_sel_hi:[1,0]
    v_pk_mul_f32 v[98:99], v[98:99], v[26:27] op_sel:[0,0] op_sel_hi:[1,0]
    v_pk_fma_f32 v[68:69], v[92:93], v[92:93], s[10:11]
    v_pk_fma_f32 v[70:71], v[94:95], v[94:95], s[10:11]
    v_pk_fma_f32 v[72:73], v[96:97], v[96:97], s[10:11]
    v_pk_fma_f32 v[74:75], v[98:99], v[98:99], s[10:11]
    v_pk_mul_f32 v[68:69], v[68:69], v[92:93]
    v_pk_mul_f32 v[70:71], v[70:71], v[94:95]
    v_pk_mul_f32 v[72:73], v[72:73], v[96:97]
    v_pk_mul_f32 v[74:75], v[74:75], v[98:99]
    v_exp_f32_e64 v68, -v68
    v_exp_f32_e64 v69, -v69
    v_exp_f32_e64 v70, -v70
    v_exp_f32_e64 v71, -v71
    v_exp_f32_e64 v72, -v72
    v_exp_f32_e64 v73, -v73
    v_exp_f32_e64 v74, -v74
    v_exp_f32_e64 v75, -v75
    v_pk_add_f32 v[68:69], v[68:69], 1.0 op_sel_hi:[1,0]
    v_pk_add_f32 v[70:71], v[70:71], 1.0 op_sel_hi:[1,0]
    v_pk_add_f32 v[72:73], v[72:73], 1.0 op_sel_hi:[1,0]
    v_pk_add_f32 v[74:75], v[74:75], 1.0 op_sel_hi:[1,0]
    v_rcp_f32 v68, v68
    v_rcp_f32 v69, v69
    v_rcp_f32 v70, v70
    v_rcp_f32 v71, v71
    v_rcp_f32 v72, v72
    v_rcp_f32 v73, v73
    v_rcp_f32 v74, v74
    v_rcp_f32 v75, v75
    v_pk_mul_f32 v[92:93], v[92:93], v[68:69]
    v_pk_mul_f32 v[94:95], v[94:95], v[70:71]
    v_pk_mul_f32 v[96:97], v[96:97], v[72:73]
    v_pk_mul_f32 v[98:99], v[98:99], v[74:75]
    v_cvt_pk_bf16_f32 v52, v92, v93
    v_cvt_pk_bf16_f32 v53, v94, v95
    v_cvt_pk_bf16_f32 v54, v96, v97
    v_cvt_pk_bf16_f32 v55, v98, v99
    ds_write_b128 v14, v[48:51] offset:1024
    ds_write_b128 v14, v[52:55] offset:1536
    v_mov_b32 v28, 0x3f803f80
    v_mov_b32 v29, 0x3f80
    v_mov_b32 v30, 0
    v_mov_b32 v31, 0
    v_and_b32 v32, 7, v0
    v_mul_u32_u24 v32, 6272, v32
    v_add_u32 v32, 104448, v32
    ds_write_b128 v32, v[28:31] offset:0
    v_lshl_add_u32 v31, v23, 6, v0
    v_mul_u32_u24 v31, 12, v31
    v_lshrrev_b32 v32, 1, v31
    buffer_load_short_d16_hi v28, v32, s[68:71], 0 offen offset:0
    buffer_load_short_d16_hi v29, v32, s[68:71], 0 offen offset:2
    buffer_load_short_d16_hi v30, v32, s[68:71], 0 offen offset:4
    v_lshlrev_b32 v33, 4, v117
    v_bfe_u32 v34, v0, 4, 1
    v_lshl_add_u32 v33, v34, 2, v33
    v_lshlrev_b32 v32, 1, v33
    v_add_u32 v32, 151552, v32
    buffer_load_dword v125, v124, s[36:39], s79 offen offset:3072 sc1
    s_cmp_lg_u32 s20, 0
    s_cbranch_scc1 L2a_ok
    s_waitcnt vmcnt(0)
    v_cmp_eq_u32 vcc, 1, v125
    s_nop 3
    s_cmp_eq_u32 vcc_lo, 1
    s_cbranch_scc1 L2a_ok
    s_mov_b32 s7, 20000
L2a_spin:
    s_sleep 8
    buffer_load_dword v125, v124, s[36:39], s79 offen offset:3072 sc1
    s_waitcnt vmcnt(0)
    v_cmp_eq_u32 vcc, 1, v125
    s_nop 4
    s_cmp_eq_u32 vcc_lo, 1
    s_cbranch_scc1 L2a_ok
    s_sub_u32 s7, s7, 1
    s_cmp_lg_u32 s7, 0
    s_cbranch_scc1 L2a_spin
L2a_ok:
    s_waitcnt vmcnt(52)
    s_barrier
    s_mov_b32 s7, 0
    buffer_load_dwordx3 v[68:70], v31, s[36:39], s7 offen sc1
    s_mov_b32 s7, 4096
    buffer_load_dwordx3 v[72:74], v31, s[36:39], s7 offen sc1
    s_mov_b32 s7, 8192
    buffer_load_dwordx3 v[76:78], v31, s[36:39], s7 offen sc1
    s_mov_b32 s7, 12288
    buffer_load_dwordx3 v[80:82], v31, s[36:39], s7 offen sc1
    s_mov_b32 s7, 16384
    buffer_load_dwordx3 v[84:86], v31, s[36:39], s7 offen sc1
    s_mov_b32 s7, 20480
    buffer_load_dwordx3 v[88:90], v31, s[36:39], s7 offen sc1
    s_mov_b32 s7, 24576
    buffer_load_dwordx3 v[92:94], v31, s[36:39], s7 offen sc1
    s_mov_b32 s7, 28672
    buffer_load_dwordx3 v[96:98], v31, s[36:39], s7 offen sc1
    buffer_load_dword v26, v20, s[32:35], 0 offen offset:1920
    ds_read_b128 v[56:59], v3 offset:12544
    ds_read_b128 v[60:63], v4 offset:12544
    ds_read_b128 v[64:67], v5 offset:12544
    s_waitcnt lgkmcnt(2)
    v_mfma_f32_32x32x16_bf16 v[100:115], a[0:3], v[56:59], 0
    ds_read_b128 v[56:59], v6 offset:12544
    buffer_load_dwordx4 v[192:195], v1, s[60:63], s22 offen offset:0 sc1
    s_waitcnt lgkmcnt(2)
    v_mfma_f32_32x32x16_bf16 v[100:115], a[4:7], v[60:63], v[100:115]
    ds_read_b128 v[60:63], v3 offset:12672
    buffer_load_dwordx4 v[196:199], v1, s[60:63], s22 offen offset:1024 sc1
    s_waitcnt lgkmcnt(2)
    v_mfma_f32_32x32x16_bf16 v[100:115], a[8:11], v[64:67], v[100:115]
    ds_read_b128 v[64:67], v4 offset:12672
    s_waitcnt vmcnt(62)
    buffer_load_dwordx4 v[200:203], v1, s[60:63], s22 offen offset:2048 sc1
    s_waitcnt lgkmcnt(2)
    v_mfma_f32_32x32x16_bf16 v[100:115], a[12:15], v[56:59], v[100:115]
    ds_read_b128 v[56:59], v5 offset:12672
    s_waitcnt vmcnt(62)
    buffer_load_dwordx4 v[204:207], v1, s[60:63], s22 offen offset:3072 sc1
    s_add_u32 s22, s22, 4096
    s_waitcnt lgkmcnt(2)
    v_mfma_f32_32x32x16_bf16 v[100:115], a[16:19], v[60:63], v[100:115]
    ds_read_b128 v[60:63], v6 offset:12672
    s_waitcnt vmcnt(62)
    buffer_load_dwordx4 v[208:211], v1, s[60:63], s22 offen offset:0 sc1
    s_waitcnt lgkmcnt(2)
    v_mfma_f32_32x32x16_bf16 v[100:115], a[20:23], v[64:67], v[100:115]
    ds_read_b128 v[64:67], v3 offset:12800
    s_waitcnt vmcnt(62)
    buffer_load_dwordx4 v[212:215], v1, s[60:63], s22 offen offset:1024 sc1
    s_waitcnt lgkmcnt(2)
    v_mfma_f32_32x32x16_bf16 v[100:115], a[24:27], v[56:59], v[100:115]
    ds_read_b128 v[56:59], v4 offset:12800
    s_waitcnt vmcnt(62)
    buffer_load_dwordx4 v[216:219], v1, s[60:63], s22 offen offset:2048 sc1
    s_waitcnt lgkmcnt(2)
    v_mfma_f32_32x32x16_bf16 v[100:115], a[28:31], v[60:63], v[100:115]
    ds_read_b128 v[60:63], v5 offset:12800
    s_waitcnt vmcnt(62)
    buffer_load_dwordx4 v[220:223], v1, s[60:63], s22 offen offset:3072 sc1
    s_add_u32 s22, s22, 4096
    s_waitcnt lgkmcnt(2)
    v_mfma_f32_32x32x16_bf16 v[100:115], a[32:35], v[64:67], v[100:115]
    ds_read_b128 v[64:67], v6 offset:12800
    s_waitcnt vmcnt(62)
    buffer_load_dwordx4 v[224:227], v1, s[60:63], s22 offen offset:0 sc1
    s_waitcnt lgkmcnt(2)
    v_mfma_f32_32x32x16_bf16 v[100:115], a[36:39], v[56:59], v[100:115]
    s_waitcnt vmcnt(62)
    buffer_load_dwordx4 v[228:231], v1, s[60:63], s22 offen offset:1024 sc1
    s_waitcnt lgkmcnt(1)
    v_mfma_f32_32x32x16_bf16 v[100:115], a[40:43], v[60:63], v[100:115]
    s_waitcnt vmcnt(62)
    buffer_load_dwordx4 v[232:235], v1, s[60:63], s22 offen offset:2048 sc1
    s_waitcnt lgkmcnt(0)
    v_mfma_f32_32x32x16_bf16 v[100:115], a[44:47], v[64:67], v[100:115]
    s_waitcnt vmcnt(62)
    buffer_load_dwordx4 v[236:239], v1, s[60:63], s22 offen offset:3072 sc1
    s_add_u32 s22, s22, 4096
    ds_read_b64 v[56:57], v32 offset:0
    ds_read_b64 v[58:59], v32 offset:16
    ds_read_b64 v[60:61], v32 offset:64
    ds_read_b64 v[62:63], v32 offset:80
    s_waitcnt lgkmcnt(2)
    v_mfma_f32_16x16x32_bf16 v[116:119], v[56:59], a[96:99], 0
    ds_read_b64 v[64:65], v32 offset:128
    ds_read_b64 v[66:67], v32 offset:144
    v_mfma_f32_16x16x32_bf16 v[120:123], v[56:59], a[100:103], 0
    s_waitcnt vmcnt(21)
    v_mfma_f32_16x16x32_bf16 v[124:127], v[56:59], a[104:107], 0
    s_waitcnt lgkmcnt(2)
    v_mfma_f32_16x16x32_bf16 v[116:119], v[60:63], a[108:111], v[116:119]
    ds_read_b64 v[56:57], v32 offset:192
    ds_read_b64 v[58:59], v32 offset:208
    v_mfma_f32_16x16x32_bf16 v[120:123], v[60:63], a[112:115], v[120:123]
    v_mfma_f32_16x16x32_bf16 v[124:127], v[60:63], a[116:119], v[124:127]
    s_waitcnt lgkmcnt(2)
    v_mfma_f32_16x16x32_bf16 v[116:119], v[64:67], a[120:123], v[116:119]
    ds_read_b64 v[60:61], v32 offset:256
    ds_read_b64 v[62:63], v32 offset:272
    v_mul_f32 v100, v100, v27
    v_fmaak_f32 v24, v100, v100, 0x409d30fc
    v_mul_f32 v24, v24, v100
    v_mul_f32 v101, v101, v27
    v_fmaak_f32 v25, v101, v101, 0x409d30fc
    v_mul_f32 v25, v25, v101
    v_mul_f32 v102, v102, v27
    v_fmaak_f32 v21, v102, v102, 0x409d30fc
    v_mul_f32 v21, v21, v102
    v_mul_f32 v103, v103, v27
    v_fmaak_f32 v22, v103, v103, 0x409d30fc
    v_mfma_f32_16x16x32_bf16 v[120:123], v[64:67], a[124:127], v[120:123]
    v_mul_f32 v22, v22, v103
    v_exp_f32_e64 v24, -v24
    v_mfma_f32_16x16x32_bf16 v[124:127], v[64:67], a[128:131], v[124:127]
    v_exp_f32_e64 v25, -v25
    v_exp_f32_e64 v21, -v21
    s_waitcnt lgkmcnt(2)
    v_mfma_f32_16x16x32_bf16 v[116:119], v[56:59], a[132:135], v[116:119]
    ds_read_b64 v[64:65], v32 offset:320
    ds_read_b64 v[66:67], v32 offset:336
    v_add_f32 v24, 1.0, v24
    v_add_f32 v25, 1.0, v25
    v_mfma_f32_16x16x32_bf16 v[120:123], v[56:59], a[136:139], v[120:123]
    v_rcp_f32 v24, v24
    v_mfma_f32_16x16x32_bf16 v[124:127], v[56:59], a[140:143], v[124:127]
    v_rcp_f32 v25, v25
    v_mul_f32 v100, v100, v24
    s_waitcnt lgkmcnt(2)
    v_mfma_f32_16x16x32_bf16 v[116:119], v[60:63], a[144:147], v[116:119]
    ds_read_b64 v[56:57], v32 offset:384
    ds_read_b64 v[58:59], v32 offset:400
    v_mul_f32 v101, v101, v25
    v_exp_f32_e64 v22, -v22
    v_mfma_f32_16x16x32_bf16 v[120:123], v[60:63], a[148:151], v[120:123]
    v_cvt_pk_bf16_f32 v48, v100, v101
    v_mfma_f32_16x16x32_bf16 v[124:127], v[60:63], a[152:155], v[124:127]
    v_add_f32 v21, 1.0, v21
    v_rcp_f32 v21, v21
    s_waitcnt lgkmcnt(2)
    v_mfma_f32_16x16x32_bf16 v[116:119], v[64:67], a[156:159], v[116:119]
    ds_read_b64 v[60:61], v32 offset:448
    ds_read_b64 v[62:63], v32 offset:464
    v_mul_f32 v102, v102, v21
    v_add_f32 v22, 1.0, v22
    v_mfma_f32_16x16x32_bf16 v[120:123], v[64:67], a[160:163], v[120:123]
    v_rcp_f32 v22, v22
    s_nop 0
    v_mul_f32 v103, v103, v22
    v_mfma_f32_16x16x32_bf16 v[124:127], v[64:67], a[164:167], v[124:127]
    v_cvt_pk_bf16_f32 v49, v102, v103
    s_waitcnt lgkmcnt(2)
    v_mfma_f32_16x16x32_bf16 v[116:119], v[56:59], a[168:171], v[116:119]
    ds_read_b64 v[64:65], v32 offset:512
    ds_read_b64 v[66:67], v32 offset:528
    v_mul_f32 v104, v104, v27
    v_fmaak_f32 v24, v104, v104, 0x409d30fc
    v_mfma_f32_16x16x32_bf16 v[120:123], v[56:59], a[172:175], v[120:123]
    v_mul_f32 v24, v24, v104
    v_mul_f32 v105, v105, v27
    v_mfma_f32_16x16x32_bf16 v[124:127], v[56:59], a[176:179], v[124:127]
    v_exp_f32_e64 v24, -v24
    s_waitcnt lgkmcnt(2)
    v_mfma_f32_16x16x32_bf16 v[116:119], v[60:63], a[180:183], v[116:119]
    ds_read_b64 v[56:57], v32 offset:576
    ds_read_b64 v[58:59], v32 offset:592
    v_add_f32 v24, 1.0, v24
    v_fmaak_f32 v25, v105, v105, 0x409d30fc
    v_mfma_f32_16x16x32_bf16 v[120:123], v[60:63], a[184:187], v[120:123]
    v_rcp_f32 v24, v24
    s_nop 0
    v_mul_f32 v104, v104, v24
    v_mfma_f32_16x16x32_bf16 v[124:127], v[60:63], a[188:191], v[124:127]
    v_mul_f32 v25, v25, v105
    s_waitcnt lgkmcnt(2)
    v_mfma_f32_16x16x32_bf16 v[116:119], v[64:67], a[192:195], v[116:119]
    ds_read_b64 v[60:61], v32 offset:640
    ds_read_b64 v[62:63], v32 offset:656
    v_exp_f32_e64 v25, -v25
    s_nop 0
    v_add_f32 v25, 1.0, v25
    v_mfma_f32_16x16x32_bf16 v[120:123], v[64:67], a[196:199], v[120:123]
    v_mul_f32 v106, v106, v27
    v_rcp_f32 v25, v25
    v_mfma_f32_16x16x32_bf16 v[124:127], v[64:67], a[200:203], v[124:127]
    v_mul_f32 v105, v105, v25
    v_cvt_pk_bf16_f32 v50, v104, v105
    s_waitcnt lgkmcnt(2)
    v_mfma_f32_16x16x32_bf16 v[116:119], v[56:59], a[204:207], v[116:119]
    ds_read_b64 v[64:65], v32 offset:704
    ds_read_b64 v[66:67], v32 offset:720
    v_fmaak_f32 v21, v106, v106, 0x409d30fc
    v_mfma_f32_16x16x32_bf16 v[120:123], v[56:59], a[208:211], v[120:123]
    v_mul_f32 v21, v21, v106
    v_exp_f32_e64 v21, -v21
    v_mfma_f32_16x16x32_bf16 v[124:127], v[56:59], a[212:215], v[124:127]
    v_add_f32 v21, 1.0, v21
    v_mul_f32 v107, v107, v27
    s_waitcnt lgkmcnt(2)
    v_mfma_f32_16x16x32_bf16 v[116:119], v[60:63], a[216:219], v[116:119]
    ds_read_b64 v[56:57], v32 offset:768
    ds_read_b64 v[58:59], v32 offset:784
    v_fmaak_f32 v22, v107, v107, 0x409d30fc
    v_mfma_f32_16x16x32_bf16 v[120:123], v[60:63], a[220:223], v[120:123]
    v_mul_f32 v22, v22, v107
    v_rcp_f32 v21, v21
    v_mfma_f32_16x16x32_bf16 v[124:127], v[60:63], a[224:227], v[124:127]
    v_exp_f32_e64 v22, -v22
    v_mul_f32 v106, v106, v21
    s_waitcnt lgkmcnt(2)
    v_mfma_f32_16x16x32_bf16 v[116:119], v[64:67], a[228:231], v[116:119]
    ds_read_b64 v[60:61], v32 offset:832
    ds_read_b64 v[62:63], v32 offset:848
    v_add_f32 v22, 1.0, v22
    v_mul_f32 v108, v108, v27
    v_mfma_f32_16x16x32_bf16 v[120:123], v[64:67], a[232:235], v[120:123]
    v_fmaak_f32 v24, v108, v108, 0x409d30fc
    v_mfma_f32_16x16x32_bf16 v[124:127], v[64:67], a[236:239], v[124:127]
    v_rcp_f32 v22, v22
    s_nop 0
    v_mul_f32 v107, v107, v22
    s_waitcnt lgkmcnt(2)
    v_mfma_f32_16x16x32_bf16 v[116:119], v[56:59], a[240:243], v[116:119]
    ds_read_b64 v[64:65], v32 offset:896
    ds_read_b64 v[66:67], v32 offset:912
    v_cvt_pk_bf16_f32 v51, v106, v107
    v_mul_f32 v24, v24, v108
    v_mfma_f32_16x16x32_bf16 v[120:123], v[56:59], a[244:247], v[120:123]
    v_mul_f32 v109, v109, v27
    v_mfma_f32_16x16x32_bf16 v[124:127], v[56:59], a[248:251], v[124:127]
    v_fmaak_f32 v25, v109, v109, 0x409d30fc
    v_mul_f32 v25, v25, v109
    s_waitcnt lgkmcnt(2)
    v_mfma_f32_16x16x32_bf16 v[116:119], v[60:63], a[252:255], v[116:119]
    ds_read_b64 v[56:57], v32 offset:960
    ds_read_b64 v[58:59], v32 offset:976
    v_exp_f32_e64 v24, -v24
    v_exp_f32_e64 v25, -v25
    v_mfma_f32_16x16x32_bf16 v[120:123], v[60:63], v[160:163], v[120:123]
    v_add_f32 v24, 1.0, v24
    v_add_f32 v25, 1.0, v25
    v_mfma_f32_16x16x32_bf16 v[124:127], v[60:63], v[164:167], v[124:127]
    v_rcp_f32 v24, v24
    s_waitcnt lgkmcnt(2)
    v_mfma_f32_16x16x32_bf16 v[116:119], v[64:67], v[168:171], v[116:119]
    v_mul_f32 v108, v108, v24
    v_rcp_f32 v25, v25
    v_mfma_f32_16x16x32_bf16 v[120:123], v[64:67], v[172:175], v[120:123]
    v_mul_f32 v109, v109, v25
    v_cvt_pk_bf16_f32 v52, v108, v109
    v_mfma_f32_16x16x32_bf16 v[124:127], v[64:67], v[176:179], v[124:127]
    v_mul_f32 v110, v110, v27
    s_waitcnt lgkmcnt(0)
    v_mfma_f32_16x16x32_bf16 v[116:119], v[56:59], v[180:183], v[116:119]
    v_fmaak_f32 v21, v110, v110, 0x409d30fc
    v_mul_f32 v21, v21, v110
    v_mfma_f32_16x16x32_bf16 v[120:123], v[56:59], v[184:187], v[120:123]
    v_mul_f32 v111, v111, v27
    v_exp_f32_e64 v21, -v21
    v_mfma_f32_16x16x32_bf16 v[124:127], v[56:59], v[188:191], v[124:127]
    v_add_f32 v21, 1.0, v21
    v_fmaak_f32 v22, v111, v111, 0x409d30fc
    s_waitcnt vmcnt(19)
    v_add_f32 v68, v68, v72
    s_waitcnt vmcnt(18)
    v_add_f32 v68, v68, v76
    s_waitcnt vmcnt(17)
    v_add_f32 v68, v68, v80
    s_waitcnt vmcnt(16)
    v_add_f32 v68, v68, v84
    s_waitcnt vmcnt(15)
    v_add_f32 v68, v68, v88
    s_waitcnt vmcnt(14)
    v_add_f32 v68, v68, v92
    s_waitcnt vmcnt(13)
    v_add_f32 v68, v68, v96
    v_add_f32 v69, v69, v73
    v_add_f32 v69, v69, v77
    v_add_f32 v69, v69, v81
    v_add_f32 v69, v69, v85
    v_add_f32 v69, v69, v89
    v_add_f32 v69, v69, v93
    v_add_f32 v69, v69, v97
    v_add_f32 v70, v70, v74
    v_add_f32 v70, v70, v78
    v_add_f32 v70, v70, v82
    v_add_f32 v70, v70, v86
    v_add_f32 v70, v70, v90
    v_add_f32 v70, v70, v94
    v_add_f32 v70, v70, v98
    v_mul_f32 v68, 0x4091afa4, v68
    v_add_f32 v68, 0x358637bd, v68
    v_mul_f32 v69, 0x4091afa4, v69
    v_add_f32 v69, 0x358637bd, v69
    v_mul_f32 v70, 0x4091afa4, v70
    v_add_f32 v70, 0x358637bd, v70
    v_sqrt_f32 v68, v68
    v_sqrt_f32 v69, v69
    v_sqrt_f32 v70, v70
    v_add_f32 v72, v68, v69
    v_add_f32 v72, v72, v70
    s_nop 1
    v_add_f32_dpp v72, v72, v72 quad_perm:[1,0,3,2] row_mask:0xf bank_mask:0xf
    s_nop 1
    v_add_f32_dpp v72, v72, v72 quad_perm:[2,3,0,1] row_mask:0xf bank_mask:0xf
    s_nop 1
    v_add_f32_dpp v72, v72, v72 row_half_mirror row_mask:0xf bank_mask:0xf
    s_nop 1
    v_add_f32_dpp v72, v72, v72 row_ror:8 row_mask:0xf bank_mask:0xf
    v_mov_b32 v73, v72
    s_nop 1
    v_permlane16_swap_b32 v72, v73
    v_add_f32 v72, v72, v73
    v_mov_b32 v73, v72
    s_nop 1
    v_permlane32_swap_b32 v72, v73
    v_add_f32 v72, v72, v73
    v_lshlrev_b32 v73, 2, v23
    v_add_u32 v73, 155648, v73
    ds_write_b32 v73, v72
    v_mov_b32 v73, 155648
    v_add_u32 v31, 148480, v31
    s_waitcnt lgkmcnt(0)
    s_barrier
    ds_read_b128 v[76:79], v73
    s_waitcnt lgkmcnt(0)
    v_add_f32 v76, v76, v77
    v_add_f32 v78, v78, v79
    v_add_f32 v76, v76, v78
    v_mul_f32 v76, 0x3aaaaaab, v76
    v_add_f32 v76, 0x358637bd, v76
    v_rcp_f32 v76, v76
    s_nop 0
    v_mul_f32 v68, v68, v76
    v_fma_f32 v68, v68, v28, 1.0
    v_mul_f32 v68, 0x40088e99, v68
    ds_write_b32 v31, v68 offset:0
    v_mul_f32 v69, v69, v76
    v_fma_f32 v69, v69, v29, 1.0
    v_mul_f32 v69, 0x40088e99, v69
    ds_write_b32 v31, v69 offset:4
    v_mul_f32 v70, v70, v76
    v_fma_f32 v70, v70, v30, 1.0
    v_mul_f32 v70, 0x40088e99, v70
    ds_write_b32 v31, v70 offset:8
    s_waitcnt lgkmcnt(0)
    s_barrier
    v_mov_b32 v0, v32
    v_lshlrev_b32 v23, 2, v33
    v_add_u32 v23, 148480, v23
    s_mov_b32 s23, 0xffff0000
    ds_read_b128 v[68:71], v23 offset:0
    ds_read_b128 v[72:75], v23 offset:32
    ds_read_b128 v[76:79], v23 offset:128
    ds_read_b128 v[80:83], v23 offset:160
    buffer_load_dwordx4 v[240:243], v1, s[60:63], s22 offen offset:0 sc1
    buffer_load_dwordx4 v[244:247], v1, s[60:63], s22 offen offset:1024 sc1
    buffer_load_dwordx4 v[248:251], v1, s[60:63], s22 offen offset:2048 sc1
    v_accvgpr_read_b32 v85, a96
    v_accvgpr_read_b32 v87, a97
    v_accvgpr_read_b32 v89, a98
    v_accvgpr_read_b32 v91, a99
    v_accvgpr_read_b32 v93, a100
    v_accvgpr_read_b32 v95, a101
    v_accvgpr_read_b32 v97, a102
    v_accvgpr_read_b32 v99, a103
    v_accvgpr_read_b32 v29, a104
    v_accvgpr_read_b32 v31, a105
    v_accvgpr_read_b32 v33, a106
    v_accvgpr_read_b32 v35, a107
    v_lshlrev_b32 v84, 16, v85
    v_and_b32 v85, s23, v85
    v_lshlrev_b32 v86, 16, v87
    v_and_b32 v87, s23, v87
    v_lshlrev_b32 v88, 16, v89
    v_and_b32 v89, s23, v89
    v_lshlrev_b32 v90, 16, v91
    v_and_b32 v91, s23, v91
    v_lshlrev_b32 v92, 16, v93
    v_and_b32 v93, s23, v93
    v_lshlrev_b32 v94, 16, v95
    v_and_b32 v95, s23, v95
    v_lshlrev_b32 v96, 16, v97
    v_and_b32 v97, s23, v97
    v_lshlrev_b32 v98, 16, v99
    v_and_b32 v99, s23, v99
    v_lshlrev_b32 v28, 16, v29
    v_and_b32 v29, s23, v29
    v_lshlrev_b32 v30, 16, v31
    v_and_b32 v31, s23, v31
    v_lshlrev_b32 v32, 16, v33
    v_and_b32 v33, s23, v33
    v_lshlrev_b32 v34, 16, v35
    v_and_b32 v35, s23, v35
    s_waitcnt lgkmcnt(3)
    v_pk_mul_f32 v[84:85], v[84:85], v[68:69]
    v_pk_mul_f32 v[86:87], v[86:87], v[70:71]
    s_waitcnt lgkmcnt(2)
    v_pk_mul_f32 v[88:89], v[88:89], v[72:73]
    v_pk_mul_f32 v[90:91], v[90:91], v[74:75]
    v_pk_mul_f32 v[92:93], v[92:93], v[68:69]
    v_pk_mul_f32 v[94:95], v[94:95], v[70:71]
    v_pk_mul_f32 v[96:97], v[96:97], v[72:73]
    v_pk_mul_f32 v[98:99], v[98:99], v[74:75]
    v_pk_mul_f32 v[28:29], v[28:29], v[68:69]
    v_pk_mul_f32 v[30:31], v[30:31], v[70:71]
    v_pk_mul_f32 v[32:33], v[32:33], v[72:73]
    v_pk_mul_f32 v[34:35], v[34:35], v[74:75]
    v_cvt_pk_bf16_f32 v84, v84, v85
    v_cvt_pk_bf16_f32 v86, v86, v87
    v_cvt_pk_bf16_f32 v88, v88, v89
    v_cvt_pk_bf16_f32 v90, v90, v91
    v_cvt_pk_bf16_f32 v92, v92, v93
    v_cvt_pk_bf16_f32 v94, v94, v95
    v_cvt_pk_bf16_f32 v96, v96, v97
    v_cvt_pk_bf16_f32 v98, v98, v99
    v_cvt_pk_bf16_f32 v28, v28, v29
    v_cvt_pk_bf16_f32 v30, v30, v31
    v_cvt_pk_bf16_f32 v32, v32, v33
    v_cvt_pk_bf16_f32 v34, v34, v35
    v_accvgpr_write_b32 a96, v84
    v_accvgpr_write_b32 a97, v86
    v_accvgpr_write_b32 a98, v88
    v_accvgpr_write_b32 a99, v90
    v_accvgpr_write_b32 a100, v92
    v_accvgpr_write_b32 a101, v94
    v_accvgpr_write_b32 a102, v96
    v_accvgpr_write_b32 a103, v98
    v_accvgpr_write_b32 a104, v28
    v_accvgpr_write_b32 a105, v30
    v_accvgpr_write_b32 a106, v32
    v_accvgpr_write_b32 a107, v34
    ds_read_b128 v[68:71], v23 offset:256
    ds_read_b128 v[72:75], v23 offset:288
    buffer_load_dwordx4 v[252:255], v1, s[60:63], s22 offen offset:3072 sc1
    s_add_u32 s22, s22, 4096
    buffer_load_dwordx4 v[128:131], v1, s[60:63], s22 offen offset:0 sc1
    buffer_load_dwordx4 v[132:135], v1, s[60:63], s22 offen offset:1024 sc1
    v_accvgpr_read_b32 v85, a108
    v_accvgpr_read_b32 v87, a109
    v_accvgpr_read_b32 v89, a110
    v_accvgpr_read_b32 v91, a111
    v_accvgpr_read_b32 v93, a112
    v_accvgpr_read_b32 v95, a113
    v_accvgpr_read_b32 v97, a114
    v_accvgpr_read_b32 v99, a115
    v_accvgpr_read_b32 v29, a116
    v_accvgpr_read_b32 v31, a117
    v_accvgpr_read_b32 v33, a118
    v_accvgpr_read_b32 v35, a119
    v_lshlrev_b32 v84, 16, v85
    v_and_b32 v85, s23, v85
    v_lshlrev_b32 v86, 16, v87
    v_and_b32 v87, s23, v87
    v_lshlrev_b32 v88, 16, v89
    v_and_b32 v89, s23, v89
    v_lshlrev_b32 v90, 16, v91
    v_and_b32 v91, s23, v91
    v_lshlrev_b32 v92, 16, v93
    v_and_b32 v93, s23, v93
    v_lshlrev_b32 v94, 16, v95
    v_and_b32 v95, s23, v95
    v_lshlrev_b32 v96, 16, v97
    v_and_b32 v97, s23, v97
    v_lshlrev_b32 v98, 16, v99
    v_and_b32 v99, s23, v99
    v_lshlrev_b32 v28, 16, v29
    v_and_b32 v29, s23, v29
    v_lshlrev_b32 v30, 16, v31
    v_and_b32 v31, s23, v31
    v_lshlrev_b32 v32, 16, v33
    v_and_b32 v33, s23, v33
    v_lshlrev_b32 v34, 16, v35
    v_and_b32 v35, s23, v35
    s_waitcnt lgkmcnt(3)
    v_pk_mul_f32 v[84:85], v[84:85], v[76:77]
    v_pk_mul_f32 v[86:87], v[86:87], v[78:79]
    s_waitcnt lgkmcnt(2)
    v_pk_mul_f32 v[88:89], v[88:89], v[80:81]
    v_pk_mul_f32 v[90:91], v[90:91], v[82:83]
    v_pk_mul_f32 v[92:93], v[92:93], v[76:77]
    v_pk_mul_f32 v[94:95], v[94:95], v[78:79]
    v_pk_mul_f32 v[96:97], v[96:97], v[80:81]
    v_pk_mul_f32 v[98:99], v[98:99], v[82:83]
    v_pk_mul_f32 v[28:29], v[28:29], v[76:77]
    v_pk_mul_f32 v[30:31], v[30:31], v[78:79]
    v_pk_mul_f32 v[32:33], v[32:33], v[80:81]
    v_pk_mul_f32 v[34:35], v[34:35], v[82:83]
    v_cvt_pk_bf16_f32 v84, v84, v85
    v_cvt_pk_bf16_f32 v86, v86, v87
    v_cvt_pk_bf16_f32 v88, v88, v89
    v_cvt_pk_bf16_f32 v90, v90, v91
    v_cvt_pk_bf16_f32 v92, v92, v93
    v_cvt_pk_bf16_f32 v94, v94, v95
    v_cvt_pk_bf16_f32 v96, v96, v97
    v_cvt_pk_bf16_f32 v98, v98, v99
    v_cvt_pk_bf16_f32 v28, v28, v29
    v_cvt_pk_bf16_f32 v30, v30, v31
    v_cvt_pk_bf16_f32 v32, v32, v33
    v_cvt_pk_bf16_f32 v34, v34, v35
    v_accvgpr_write_b32 a108, v84
    v_accvgpr_write_b32 a109, v86
    v_accvgpr_write_b32 a110, v88
    v_accvgpr_write_b32 a111, v90
    v_accvgpr_write_b32 a112, v92
    v_accvgpr_write_b32 a113, v94
    v_accvgpr_write_b32 a114, v96
    v_accvgpr_write_b32 a115, v98
    v_accvgpr_write_b32 a116, v28
    v_accvgpr_write_b32 a117, v30
    v_accvgpr_write_b32 a118, v32
    v_accvgpr_write_b32 a119, v34
    ds_read_b128 v[76:79], v23 offset:384
    ds_read_b128 v[80:83], v23 offset:416
    buffer_load_dwordx4 v[136:139], v1, s[60:63], s22 offen offset:2048 sc1
    buffer_load_dwordx4 v[140:143], v1, s[60:63], s22 offen offset:3072 sc1
    s_add_u32 s22, s22, 4096
    buffer_load_dwordx4 v[144:147], v1, s[60:63], s22 offen offset:0 sc1
    v_accvgpr_read_b32 v85, a120
    v_accvgpr_read_b32 v87, a121
    v_accvgpr_read_b32 v89, a122
    v_accvgpr_read_b32 v91, a123
    v_accvgpr_read_b32 v93, a124
    v_accvgpr_read_b32 v95, a125
    v_accvgpr_read_b32 v97, a126
    v_accvgpr_read_b32 v99, a127
    v_accvgpr_read_b32 v29, a128
    v_accvgpr_read_b32 v31, a129
    v_accvgpr_read_b32 v33, a130
    v_accvgpr_read_b32 v35, a131
    v_lshlrev_b32 v84, 16, v85
    v_and_b32 v85, s23, v85
    v_lshlrev_b32 v86, 16, v87
    v_and_b32 v87, s23, v87
    v_lshlrev_b32 v88, 16, v89
    v_and_b32 v89, s23, v89
    v_lshlrev_b32 v90, 16, v91
    v_and_b32 v91, s23, v91
    v_lshlrev_b32 v92, 16, v93
    v_and_b32 v93, s23, v93
    v_lshlrev_b32 v94, 16, v95
    v_and_b32 v95, s23, v95
    v_lshlrev_b32 v96, 16, v97
    v_and_b32 v97, s23, v97
    v_lshlrev_b32 v98, 16, v99
    v_and_b32 v99, s23, v99
    v_lshlrev_b32 v28, 16, v29
    v_and_b32 v29, s23, v29
    v_lshlrev_b32 v30, 16, v31
    v_and_b32 v31, s23, v31
    v_lshlrev_b32 v32, 16, v33
    v_and_b32 v33, s23, v33
    v_lshlrev_b32 v34, 16, v35
    v_and_b32 v35, s23, v35
    s_waitcnt lgkmcnt(3)
    v_pk_mul_f32 v[84:85], v[84:85], v[68:69]
    v_pk_mul_f32 v[86:87], v[86:87], v[70:71]
    s_waitcnt lgkmcnt(2)
    v_pk_mul_f32 v[88:89], v[88:89], v[72:73]
    v_pk_mul_f32 v[90:91], v[90:91], v[74:75]
    v_pk_mul_f32 v[92:93], v[92:93], v[68:69]
    v_pk_mul_f32 v[94:95], v[94:95], v[70:71]
    v_pk_mul_f32 v[96:97], v[96:97], v[72:73]
    v_pk_mul_f32 v[98:99], v[98:99], v[74:75]
    v_pk_mul_f32 v[28:29], v[28:29], v[68:69]
    v_pk_mul_f32 v[30:31], v[30:31], v[70:71]
    v_pk_mul_f32 v[32:33], v[32:33], v[72:73]
    v_pk_mul_f32 v[34:35], v[34:35], v[74:75]
    v_cvt_pk_bf16_f32 v84, v84, v85
    v_cvt_pk_bf16_f32 v86, v86, v87
    v_cvt_pk_bf16_f32 v88, v88, v89
    v_cvt_pk_bf16_f32 v90, v90, v91
    v_cvt_pk_bf16_f32 v92, v92, v93
    v_cvt_pk_bf16_f32 v94, v94, v95
    v_cvt_pk_bf16_f32 v96, v96, v97
    v_cvt_pk_bf16_f32 v98, v98, v99
    v_cvt_pk_bf16_f32 v28, v28, v29
    v_cvt_pk_bf16_f32 v30, v30, v31
    v_cvt_pk_bf16_f32 v32, v32, v33
    v_cvt_pk_bf16_f32 v34, v34, v35
    v_accvgpr_write_b32 a120, v84
    v_accvgpr_write_b32 a121, v86
    v_accvgpr_write_b32 a122, v88
    v_accvgpr_write_b32 a123, v90
    v_accvgpr_write_b32 a124, v92
    v_accvgpr_write_b32 a125, v94
    v_accvgpr_write_b32 a126, v96
    v_accvgpr_write_b32 a127, v98
    v_accvgpr_write_b32 a128, v28
    v_accvgpr_write_b32 a129, v30
    v_accvgpr_write_b32 a130, v32
    v_accvgpr_write_b32 a131, v34
    ds_read_b128 v[68:71], v23 offset:512
    ds_read_b128 v[72:75], v23 offset:544
    buffer_load_dwordx4 v[148:151], v1, s[60:63], s22 offen offset:1024 sc1
    buffer_load_dwordx4 v[152:155], v1, s[60:63], s22 offen offset:2048 sc1
    buffer_load_dwordx4 v[156:159], v1, s[60:63], s22 offen offset:3072 sc1
    s_add_u32 s22, s22, 4096
    v_accvgpr_read_b32 v85, a132
    v_accvgpr_read_b32 v87, a133
    v_accvgpr_read_b32 v89, a134
    v_accvgpr_read_b32 v91, a135
    v_accvgpr_read_b32 v93, a136
    v_accvgpr_read_b32 v95, a137
    v_accvgpr_read_b32 v97, a138
    v_accvgpr_read_b32 v99, a139
    v_accvgpr_read_b32 v29, a140
    v_accvgpr_read_b32 v31, a141
    v_accvgpr_read_b32 v33, a142
    v_accvgpr_read_b32 v35, a143
    v_lshlrev_b32 v84, 16, v85
    v_and_b32 v85, s23, v85
    v_lshlrev_b32 v86, 16, v87
    v_and_b32 v87, s23, v87
    v_lshlrev_b32 v88, 16, v89
    v_and_b32 v89, s23, v89
    v_lshlrev_b32 v90, 16, v91
    v_and_b32 v91, s23, v91
    v_lshlrev_b32 v92, 16, v93
    v_and_b32 v93, s23, v93
    v_lshlrev_b32 v94, 16, v95
    v_and_b32 v95, s23, v95
    v_lshlrev_b32 v96, 16, v97
    v_and_b32 v97, s23, v97
    v_lshlrev_b32 v98, 16, v99
    v_and_b32 v99, s23, v99
    v_lshlrev_b32 v28, 16, v29
    v_and_b32 v29, s23, v29
    v_lshlrev_b32 v30, 16, v31
    v_and_b32 v31, s23, v31
    v_lshlrev_b32 v32, 16, v33
    v_and_b32 v33, s23, v33
    v_lshlrev_b32 v34, 16, v35
    v_and_b32 v35, s23, v35
    s_waitcnt lgkmcnt(3)
    v_pk_mul_f32 v[84:85], v[84:85], v[76:77]
    v_pk_mul_f32 v[86:87], v[86:87], v[78:79]
    s_waitcnt lgkmcnt(2)
    v_pk_mul_f32 v[88:89], v[88:89], v[80:81]
    v_pk_mul_f32 v[90:91], v[90:91], v[82:83]
    v_pk_mul_f32 v[92:93], v[92:93], v[76:77]
    v_pk_mul_f32 v[94:95], v[94:95], v[78:79]
    v_pk_mul_f32 v[96:97], v[96:97], v[80:81]
    v_pk_mul_f32 v[98:99], v[98:99], v[82:83]
    v_pk_mul_f32 v[28:29], v[28:29], v[76:77]
    v_pk_mul_f32 v[30:31], v[30:31], v[78:79]
    v_pk_mul_f32 v[32:33], v[32:33], v[80:81]
    v_pk_mul_f32 v[34:35], v[34:35], v[82:83]
    v_cvt_pk_bf16_f32 v84, v84, v85
    v_cvt_pk_bf16_f32 v86, v86, v87
    v_cvt_pk_bf16_f32 v88, v88, v89
    v_cvt_pk_bf16_f32 v90, v90, v91
    v_cvt_pk_bf16_f32 v92, v92, v93
    v_cvt_pk_bf16_f32 v94, v94, v95
    v_cvt_pk_bf16_f32 v96, v96, v97
    v_cvt_pk_bf16_f32 v98, v98, v99
    v_cvt_pk_bf16_f32 v28, v28, v29
    v_cvt_pk_bf16_f32 v30, v30, v31
    v_cvt_pk_bf16_f32 v32, v32, v33
    v_cvt_pk_bf16_f32 v34, v34, v35
    v_accvgpr_write_b32 a132, v84
    v_accvgpr_write_b32 a133, v86
    v_accvgpr_write_b32 a134, v88
    v_accvgpr_write_b32 a135, v90
    v_accvgpr_write_b32 a136, v92
    v_accvgpr_write_b32 a137, v94
    v_accvgpr_write_b32 a138, v96
    v_accvgpr_write_b32 a139, v98
    v_accvgpr_write_b32 a140, v28
    v_accvgpr_write_b32 a141, v30
    v_accvgpr_write_b32 a142, v32
    v_accvgpr_write_b32 a143, v34
    ds_read_b128 v[76:79], v23 offset:640
    ds_read_b128 v[80:83], v23 offset:672
    s_add_u32 m0, s48, 0
    s_nop 0
    buffer_load_dwordx4 v13, s[28:31], s45 offen offset:0 lds
    buffer_load_dwordx4 v13, s[28:31], s45 offen offset:1024 lds
    buffer_load_dwordx4 v13, s[28:31], s45 offen offset:2048 lds
    v_accvgpr_read_b32 v85, a144
    v_accvgpr_read_b32 v87, a145
    v_accvgpr_read_b32 v89, a146
    v_accvgpr_read_b32 v91, a147
    v_accvgpr_read_b32 v93, a148
    v_accvgpr_read_b32 v95, a149
    v_accvgpr_read_b32 v97, a150
    v_accvgpr_read_b32 v99, a151
    v_accvgpr_read_b32 v29, a152
    v_accvgpr_read_b32 v31, a153
    v_accvgpr_read_b32 v33, a154
    v_accvgpr_read_b32 v35, a155
    v_lshlrev_b32 v84, 16, v85
    v_and_b32 v85, s23, v85
    v_lshlrev_b32 v86, 16, v87
    v_and_b32 v87, s23, v87
    v_lshlrev_b32 v88, 16, v89
    v_and_b32 v89, s23, v89
    v_lshlrev_b32 v90, 16, v91
    v_and_b32 v91, s23, v91
    v_lshlrev_b32 v92, 16, v93
    v_and_b32 v93, s23, v93
    v_lshlrev_b32 v94, 16, v95
    v_and_b32 v95, s23, v95
    v_lshlrev_b32 v96, 16, v97
    v_and_b32 v97, s23, v97
    v_lshlrev_b32 v98, 16, v99
    v_and_b32 v99, s23, v99
    v_lshlrev_b32 v28, 16, v29
    v_and_b32 v29, s23, v29
    v_lshlrev_b32 v30, 16, v31
    v_and_b32 v31, s23, v31
    v_lshlrev_b32 v32, 16, v33
    v_and_b32 v33, s23, v33
    v_lshlrev_b32 v34, 16, v35
    v_and_b32 v35, s23, v35
    s_waitcnt lgkmcnt(3)
    v_pk_mul_f32 v[84:85], v[84:85], v[68:69]
    v_pk_mul_f32 v[86:87], v[86:87], v[70:71]
    s_waitcnt lgkmcnt(2)
    v_pk_mul_f32 v[88:89], v[88:89], v[72:73]
    v_pk_mul_f32 v[90:91], v[90:91], v[74:75]
    v_pk_mul_f32 v[92:93], v[92:93], v[68:69]
    v_pk_mul_f32 v[94:95], v[94:95], v[70:71]
    v_pk_mul_f32 v[96:97], v[96:97], v[72:73]
    v_pk_mul_f32 v[98:99], v[98:99], v[74:75]
    v_pk_mul_f32 v[28:29], v[28:29], v[68:69]
    v_pk_mul_f32 v[30:31], v[30:31], v[70:71]
    v_pk_mul_f32 v[32:33], v[32:33], v[72:73]
    v_pk_mul_f32 v[34:35], v[34:35], v[74:75]
    v_cvt_pk_bf16_f32 v84, v84, v85
    v_cvt_pk_bf16_f32 v86, v86, v87
    v_cvt_pk_bf16_f32 v88, v88, v89
    v_cvt_pk_bf16_f32 v90, v90, v91
    v_cvt_pk_bf16_f32 v92, v92, v93
    v_cvt_pk_bf16_f32 v94, v94, v95
    v_cvt_pk_bf16_f32 v96, v96, v97
    v_cvt_pk_bf16_f32 v98, v98, v99
    v_cvt_pk_bf16_f32 v28, v28, v29
    v_cvt_pk_bf16_f32 v30, v30, v31
    v_cvt_pk_bf16_f32 v32, v32, v33
    v_cvt_pk_bf16_f32 v34, v34, v35
    v_accvgpr_write_b32 a144, v84
    v_accvgpr_write_b32 a145, v86
    v_accvgpr_write_b32 a146, v88
    v_accvgpr_write_b32 a147, v90
    v_accvgpr_write_b32 a148, v92
    v_accvgpr_write_b32 a149, v94
    v_accvgpr_write_b32 a150, v96
    v_accvgpr_write_b32 a151, v98
    v_accvgpr_write_b32 a152, v28
    v_accvgpr_write_b32 a153, v30
    v_accvgpr_write_b32 a154, v32
    v_accvgpr_write_b32 a155, v34
    ds_read_b128 v[68:71], v23 offset:768
    ds_read_b128 v[72:75], v23 offset:800
    buffer_load_dwordx4 v13, s[28:31], s45 offen offset:3072 lds
    s_mov_b32 s45, 573440
    s_mov_b32 m0, s49
    s_nop 0
    buffer_load_dwordx4 v10, s[24:27], s44 offen offset:0 lds
    buffer_load_dwordx4 v11, s[24:27], s44 offen offset:1024 lds
    v_accvgpr_read_b32 v85, a156
    v_accvgpr_read_b32 v87, a157
    v_accvgpr_read_b32 v89, a158
    v_accvgpr_read_b32 v91, a159
    v_accvgpr_read_b32 v93, a160
    v_accvgpr_read_b32 v95, a161
    v_accvgpr_read_b32 v97, a162
    v_accvgpr_read_b32 v99, a163
    v_accvgpr_read_b32 v29, a164
    v_accvgpr_read_b32 v31, a165
    v_accvgpr_read_b32 v33, a166
    v_accvgpr_read_b32 v35, a167
    v_lshlrev_b32 v84, 16, v85
    v_and_b32 v85, s23, v85
    v_lshlrev_b32 v86, 16, v87
    v_and_b32 v87, s23, v87
    v_lshlrev_b32 v88, 16, v89
    v_and_b32 v89, s23, v89
    v_lshlrev_b32 v90, 16, v91
    v_and_b32 v91, s23, v91
    v_lshlrev_b32 v92, 16, v93
    v_and_b32 v93, s23, v93
    v_lshlrev_b32 v94, 16, v95
    v_and_b32 v95, s23, v95
    v_lshlrev_b32 v96, 16, v97
    v_and_b32 v97, s23, v97
    v_lshlrev_b32 v98, 16, v99
    v_and_b32 v99, s23, v99
    v_lshlrev_b32 v28, 16, v29
    v_and_b32 v29, s23, v29
    v_lshlrev_b32 v30, 16, v31
    v_and_b32 v31, s23, v31
    v_lshlrev_b32 v32, 16, v33
    v_and_b32 v33, s23, v33
    v_lshlrev_b32 v34, 16, v35
    v_and_b32 v35, s23, v35
    s_waitcnt lgkmcnt(3)
    v_pk_mul_f32 v[84:85], v[84:85], v[76:77]
    v_pk_mul_f32 v[86:87], v[86:87], v[78:79]
    s_waitcnt lgkmcnt(2)
    v_pk_mul_f32 v[88:89], v[88:89], v[80:81]
    v_pk_mul_f32 v[90:91], v[90:91], v[82:83]
    v_pk_mul_f32 v[92:93], v[92:93], v[76:77]
    v_pk_mul_f32 v[94:95], v[94:95], v[78:79]
    v_pk_mul_f32 v[96:97], v[96:97], v[80:81]
    v_pk_mul_f32 v[98:99], v[98:99], v[82:83]
    v_pk_mul_f32 v[28:29], v[28:29], v[76:77]
    v_pk_mul_f32 v[30:31], v[30:31], v[78:79]
    v_pk_mul_f32 v[32:33], v[32:33], v[80:81]
    v_pk_mul_f32 v[34:35], v[34:35], v[82:83]
    v_cvt_pk_bf16_f32 v84, v84, v85
    v_cvt_pk_bf16_f32 v86, v86, v87
    v_cvt_pk_bf16_f32 v88, v88, v89
    v_cvt_pk_bf16_f32 v90, v90, v91
    v_cvt_pk_bf16_f32 v92, v92, v93
    v_cvt_pk_bf16_f32 v94, v94, v95
    v_cvt_pk_bf16_f32 v96, v96, v97
    v_cvt_pk_bf16_f32 v98, v98, v99
    v_cvt_pk_bf16_f32 v28, v28, v29
    v_cvt_pk_bf16_f32 v30, v30, v31
    v_cvt_pk_bf16_f32 v32, v32, v33
    v_cvt_pk_bf16_f32 v34, v34, v35
    v_accvgpr_write_b32 a156, v84
    v_accvgpr_write_b32 a157, v86
    v_accvgpr_write_b32 a158, v88
    v_accvgpr_write_b32 a159, v90
    v_accvgpr_write_b32 a160, v92
    v_accvgpr_write_b32 a161, v94
    v_accvgpr_write_b32 a162, v96
    v_accvgpr_write_b32 a163, v98
    v_accvgpr_write_b32 a164, v28
    v_accvgpr_write_b32 a165, v30
    v_accvgpr_write_b32 a166, v32
    v_accvgpr_write_b32 a167, v34
    ds_read_b128 v[76:79], v23 offset:896
    ds_read_b128 v[80:83], v23 offset:928
    buffer_load_dwordx4 v12, s[24:27], s44 offen offset:2048 lds
    s_mov_b32 s44, 172032
    s_add_u32 s49, s49, 12544
    s_add_u32 m0, s48, 16384
    s_nop 0
    buffer_load_dwordx4 v13, s[28:31], s45 offen offset:0 lds
    buffer_load_dwordx4 v13, s[28:31], s45 offen offset:1024 lds
    v_accvgpr_read_b32 v85, a168
    v_accvgpr_read_b32 v87, a169
    v_accvgpr_read_b32 v89, a170
    v_accvgpr_read_b32 v91, a171
    v_accvgpr_read_b32 v93, a172
    v_accvgpr_read_b32 v95, a173
    v_accvgpr_read_b32 v97, a174
    v_accvgpr_read_b32 v99, a175
    v_accvgpr_read_b32 v29, a176
    v_accvgpr_read_b32 v31, a177
    v_accvgpr_read_b32 v33, a178
    v_accvgpr_read_b32 v35, a179
    v_lshlrev_b32 v84, 16, v85
    v_and_b32 v85, s23, v85
    v_lshlrev_b32 v86, 16, v87
    v_and_b32 v87, s23, v87
    v_lshlrev_b32 v88, 16, v89
    v_and_b32 v89, s23, v89
    v_lshlrev_b32 v90, 16, v91
    v_and_b32 v91, s23, v91
    v_lshlrev_b32 v92, 16, v93
    v_and_b32 v93, s23, v93
    v_lshlrev_b32 v94, 16, v95
    v_and_b32 v95, s23, v95
    v_lshlrev_b32 v96, 16, v97
    v_and_b32 v97, s23, v97
    v_lshlrev_b32 v98, 16, v99
    v_and_b32 v99, s23, v99
    v_lshlrev_b32 v28, 16, v29
    v_and_b32 v29, s23, v29
    v_lshlrev_b32 v30, 16, v31
    v_and_b32 v31, s23, v31
    v_lshlrev_b32 v32, 16, v33
    v_and_b32 v33, s23, v33
    v_lshlrev_b32 v34, 16, v35
    v_and_b32 v35, s23, v35
    s_waitcnt lgkmcnt(3)
    v_pk_mul_f32 v[84:85], v[84:85], v[68:69]
    v_pk_mul_f32 v[86:87], v[86:87], v[70:71]
    s_waitcnt lgkmcnt(2)
    v_pk_mul_f32 v[88:89], v[88:89], v[72:73]
    v_pk_mul_f32 v[90:91], v[90:91], v[74:75]
    v_pk_mul_f32 v[92:93], v[92:93], v[68:69]
    v_pk_mul_f32 v[94:95], v[94:95], v[70:71]
    v_pk_mul_f32 v[96:97], v[96:97], v[72:73]
    v_pk_mul_f32 v[98:99], v[98:99], v[74:75]
    v_pk_mul_f32 v[28:29], v[28:29], v[68:69]
    v_pk_mul_f32 v[30:31], v[30:31], v[70:71]
    v_pk_mul_f32 v[32:33], v[32:33], v[72:73]
    v_pk_mul_f32 v[34:35], v[34:35], v[74:75]
    v_cvt_pk_bf16_f32 v84, v84, v85
    v_cvt_pk_bf16_f32 v86, v86, v87
    v_cvt_pk_bf16_f32 v88, v88, v89
    v_cvt_pk_bf16_f32 v90, v90, v91
    v_cvt_pk_bf16_f32 v92, v92, v93
    v_cvt_pk_bf16_f32 v94, v94, v95
    v_cvt_pk_bf16_f32 v96, v96, v97
    v_cvt_pk_bf16_f32 v98, v98, v99
    v_cvt_pk_bf16_f32 v28, v28, v29
    v_cvt_pk_bf16_f32 v30, v30, v31
    v_cvt_pk_bf16_f32 v32, v32, v33
    v_cvt_pk_bf16_f32 v34, v34, v35
    v_accvgpr_write_b32 a168, v84
    v_accvgpr_write_b32 a169, v86
    v_accvgpr_write_b32 a170, v88
    v_accvgpr_write_b32 a171, v90
    v_accvgpr_write_b32 a172, v92
    v_accvgpr_write_b32 a173, v94
    v_accvgpr_write_b32 a174, v96
    v_accvgpr_write_b32 a175, v98
    v_accvgpr_write_b32 a176, v28
    v_accvgpr_write_b32 a177, v30
    v_accvgpr_write_b32 a178, v32
    v_accvgpr_write_b32 a179, v34
    ds_read_b128 v[68:71], v23 offset:1024
    ds_read_b128 v[72:75], v23 offset:1056
    buffer_load_dwordx4 v13, s[28:31], s45 offen offset:2048 lds
    buffer_load_dwordx4 v13, s[28:31], s45 offen offset:3072 lds
    s_mov_b32 s45, 524288
    s_add_u32 m0, s48, 32768
    s_nop 0
    buffer_load_dwordx4 v13, s[28:31], s45 offen offset:0 lds
    v_accvgpr_read_b32 v85, a180
    v_accvgpr_read_b32 v87, a181
    v_accvgpr_read_b32 v89, a182
    v_accvgpr_read_b32 v91, a183
    v_accvgpr_read_b32 v93, a184
    v_accvgpr_read_b32 v95, a185
    v_accvgpr_read_b32 v97, a186
    v_accvgpr_read_b32 v99, a187
    v_accvgpr_read_b32 v29, a188
    v_accvgpr_read_b32 v31, a189
    v_accvgpr_read_b32 v33, a190
    v_accvgpr_read_b32 v35, a191
    v_lshlrev_b32 v84, 16, v85
    v_and_b32 v85, s23, v85
    v_lshlrev_b32 v86, 16, v87
    v_and_b32 v87, s23, v87
    v_lshlrev_b32 v88, 16, v89
    v_and_b32 v89, s23, v89
    v_lshlrev_b32 v90, 16, v91
    v_and_b32 v91, s23, v91
    v_lshlrev_b32 v92, 16, v93
    v_and_b32 v93, s23, v93
    v_lshlrev_b32 v94, 16, v95
    v_and_b32 v95, s23, v95
    v_lshlrev_b32 v96, 16, v97
    v_and_b32 v97, s23, v97
    v_lshlrev_b32 v98, 16, v99
    v_and_b32 v99, s23, v99
    v_lshlrev_b32 v28, 16, v29
    v_and_b32 v29, s23, v29
    v_lshlrev_b32 v30, 16, v31
    v_and_b32 v31, s23, v31
    v_lshlrev_b32 v32, 16, v33
    v_and_b32 v33, s23, v33
    v_lshlrev_b32 v34, 16, v35
    v_and_b32 v35, s23, v35
    s_waitcnt lgkmcnt(3)
    v_pk_mul_f32 v[84:85], v[84:85], v[76:77]
    v_pk_mul_f32 v[86:87], v[86:87], v[78:79]
    s_waitcnt lgkmcnt(2)
    v_pk_mul_f32 v[88:89], v[88:89], v[80:81]
    v_pk_mul_f32 v[90:91], v[90:91], v[82:83]
    v_pk_mul_f32 v[92:93], v[92:93], v[76:77]
    v_pk_mul_f32 v[94:95], v[94:95], v[78:79]
    v_pk_mul_f32 v[96:97], v[96:97], v[80:81]
    v_pk_mul_f32 v[98:99], v[98:99], v[82:83]
    v_pk_mul_f32 v[28:29], v[28:29], v[76:77]
    v_pk_mul_f32 v[30:31], v[30:31], v[78:79]
    v_pk_mul_f32 v[32:33], v[32:33], v[80:81]
    v_pk_mul_f32 v[34:35], v[34:35], v[82:83]
    v_cvt_pk_bf16_f32 v84, v84, v85
    v_cvt_pk_bf16_f32 v86, v86, v87
    v_cvt_pk_bf16_f32 v88, v88, v89
    v_cvt_pk_bf16_f32 v90, v90, v91
    v_cvt_pk_bf16_f32 v92, v92, v93
    v_cvt_pk_bf16_f32 v94, v94, v95
    v_cvt_pk_bf16_f32 v96, v96, v97
    v_cvt_pk_bf16_f32 v98, v98, v99
    v_cvt_pk_bf16_f32 v28, v28, v29
    v_cvt_pk_bf16_f32 v30, v30, v31
    v_cvt_pk_bf16_f32 v32, v32, v33
    v_cvt_pk_bf16_f32 v34, v34, v35
    v_accvgpr_write_b32 a180, v84
    v_accvgpr_write_b32 a181, v86
    v_accvgpr_write_b32 a182, v88
    v_accvgpr_write_b32 a183, v90
    v_accvgpr_write_b32 a184, v92
    v_accvgpr_write_b32 a185, v94
    v_accvgpr_write_b32 a186, v96
    v_accvgpr_write_b32 a187, v98
    v_accvgpr_write_b32 a188, v28
    v_accvgpr_write_b32 a189, v30
    v_accvgpr_write_b32 a190, v32
    v_accvgpr_write_b32 a191, v34
    ds_read_b128 v[76:79], v23 offset:1152
    ds_read_b128 v[80:83], v23 offset:1184
    buffer_load_dwordx4 v13, s[28:31], s45 offen offset:1024 lds
    buffer_load_dwordx4 v13, s[28:31], s45 offen offset:2048 lds
    buffer_load_dwordx4 v13, s[28:31], s45 offen offset:3072 lds
    s_mov_b32 s45, 540672
    v_accvgpr_read_b32 v85, a192
    v_accvgpr_read_b32 v87, a193
    v_accvgpr_read_b32 v89, a194
    v_accvgpr_read_b32 v91, a195
    v_accvgpr_read_b32 v93, a196
    v_accvgpr_read_b32 v95, a197
    v_accvgpr_read_b32 v97, a198
    v_accvgpr_read_b32 v99, a199
    v_accvgpr_read_b32 v29, a200
    v_accvgpr_read_b32 v31, a201
    v_accvgpr_read_b32 v33, a202
    v_accvgpr_read_b32 v35, a203
    v_lshlrev_b32 v84, 16, v85
    v_and_b32 v85, s23, v85
    v_lshlrev_b32 v86, 16, v87
    v_and_b32 v87, s23, v87
    v_lshlrev_b32 v88, 16, v89
    v_and_b32 v89, s23, v89
    v_lshlrev_b32 v90, 16, v91
    v_and_b32 v91, s23, v91
    v_lshlrev_b32 v92, 16, v93
    v_and_b32 v93, s23, v93
    v_lshlrev_b32 v94, 16, v95
    v_and_b32 v95, s23, v95
    v_lshlrev_b32 v96, 16, v97
    v_and_b32 v97, s23, v97
    v_lshlrev_b32 v98, 16, v99
    v_and_b32 v99, s23, v99
    v_lshlrev_b32 v28, 16, v29
    v_and_b32 v29, s23, v29
    v_lshlrev_b32 v30, 16, v31
    v_and_b32 v31, s23, v31
    v_lshlrev_b32 v32, 16, v33
    v_and_b32 v33, s23, v33
    v_lshlrev_b32 v34, 16, v35
    v_and_b32 v35, s23, v35
    s_waitcnt lgkmcnt(3)
    v_pk_mul_f32 v[84:85], v[84:85], v[68:69]
    v_pk_mul_f32 v[86:87], v[86:87], v[70:71]
    s_waitcnt lgkmcnt(2)
    v_pk_mul_f32 v[88:89], v[88:89], v[72:73]
    v_pk_mul_f32 v[90:91], v[90:91], v[74:75]
    v_pk_mul_f32 v[92:93], v[92:93], v[68:69]
    v_pk_mul_f32 v[94:95], v[94:95], v[70:71]
    v_pk_mul_f32 v[96:97], v[96:97], v[72:73]
    v_pk_mul_f32 v[98:99], v[98:99], v[74:75]
    v_pk_mul_f32 v[28:29], v[28:29], v[68:69]
    v_pk_mul_f32 v[30:31], v[30:31], v[70:71]
    v_pk_mul_f32 v[32:33], v[32:33], v[72:73]
    v_pk_mul_f32 v[34:35], v[34:35], v[74:75]
    v_cvt_pk_bf16_f32 v84, v84, v85
    v_cvt_pk_bf16_f32 v86, v86, v87
    v_cvt_pk_bf16_f32 v88, v88, v89
    v_cvt_pk_bf16_f32 v90, v90, v91
    v_cvt_pk_bf16_f32 v92, v92, v93
    v_cvt_pk_bf16_f32 v94, v94, v95
    v_cvt_pk_bf16_f32 v96, v96, v97
    v_cvt_pk_bf16_f32 v98, v98, v99
    v_cvt_pk_bf16_f32 v28, v28, v29
    v_cvt_pk_bf16_f32 v30, v30, v31
    v_cvt_pk_bf16_f32 v32, v32, v33
    v_cvt_pk_bf16_f32 v34, v34, v35
    v_accvgpr_write_b32 a192, v84
    v_accvgpr_write_b32 a193, v86
    v_accvgpr_write_b32 a194, v88
    v_accvgpr_write_b32 a195, v90
    v_accvgpr_write_b32 a196, v92
    v_accvgpr_write_b32 a197, v94
    v_accvgpr_write_b32 a198, v96
    v_accvgpr_write_b32 a199, v98
    v_accvgpr_write_b32 a200, v28
    v_accvgpr_write_b32 a201, v30
    v_accvgpr_write_b32 a202, v32
    v_accvgpr_write_b32 a203, v34
    ds_read_b128 v[68:71], v23 offset:1280
    ds_read_b128 v[72:75], v23 offset:1312
    v_accvgpr_read_b32 v85, a204
    v_accvgpr_read_b32 v87, a205
    v_accvgpr_read_b32 v89, a206
    v_accvgpr_read_b32 v91, a207
    v_accvgpr_read_b32 v93, a208
    v_accvgpr_read_b32 v95, a209
    v_accvgpr_read_b32 v97, a210
    v_accvgpr_read_b32 v99, a211
    v_accvgpr_read_b32 v29, a212
    v_accvgpr_read_b32 v31, a213
    v_accvgpr_read_b32 v33, a214
    v_accvgpr_read_b32 v35, a215
    v_lshlrev_b32 v84, 16, v85
    v_and_b32 v85, s23, v85
    v_lshlrev_b32 v86, 16, v87
    v_and_b32 v87, s23, v87
    v_lshlrev_b32 v88, 16, v89
    v_and_b32 v89, s23, v89
    v_lshlrev_b32 v90, 16, v91
    v_and_b32 v91, s23, v91
    v_lshlrev_b32 v92, 16, v93
    v_and_b32 v93, s23, v93
    v_lshlrev_b32 v94, 16, v95
    v_and_b32 v95, s23, v95
    v_lshlrev_b32 v96, 16, v97
    v_and_b32 v97, s23, v97
    v_lshlrev_b32 v98, 16, v99
    v_and_b32 v99, s23, v99
    v_lshlrev_b32 v28, 16, v29
    v_and_b32 v29, s23, v29
    v_lshlrev_b32 v30, 16, v31
    v_and_b32 v31, s23, v31
    v_lshlrev_b32 v32, 16, v33
    v_and_b32 v33, s23, v33
    v_lshlrev_b32 v34, 16, v35
    v_and_b32 v35, s23, v35
    s_waitcnt lgkmcnt(3)
    v_pk_mul_f32 v[84:85], v[84:85], v[76:77]
    v_pk_mul_f32 v[86:87], v[86:87], v[78:79]
    s_waitcnt lgkmcnt(2)
    v_pk_mul_f32 v[88:89], v[88:89], v[80:81]
    v_pk_mul_f32 v[90:91], v[90:91], v[82:83]
    v_pk_mul_f32 v[92:93], v[92:93], v[76:77]
    v_pk_mul_f32 v[94:95], v[94:95], v[78:79]
    v_pk_mul_f32 v[96:97], v[96:97], v[80:81]
    v_pk_mul_f32 v[98:99], v[98:99], v[82:83]
    v_pk_mul_f32 v[28:29], v[28:29], v[76:77]
    v_pk_mul_f32 v[30:31], v[30:31], v[78:79]
    v_pk_mul_f32 v[32:33], v[32:33], v[80:81]
    v_pk_mul_f32 v[34:35], v[34:35], v[82:83]
    v_cvt_pk_bf16_f32 v84, v84, v85
    v_cvt_pk_bf16_f32 v86, v86, v87
    v_cvt_pk_bf16_f32 v88, v88, v89
    v_cvt_pk_bf16_f32 v90, v90, v91
    v_cvt_pk_bf16_f32 v92, v92, v93
    v_cvt_pk_bf16_f32 v94, v94, v95
    v_cvt_pk_bf16_f32 v96, v96, v97
    v_cvt_pk_bf16_f32 v98, v98, v99
    v_cvt_pk_bf16_f32 v28, v28, v29
    v_cvt_pk_bf16_f32 v30, v30, v31
    v_cvt_pk_bf16_f32 v32, v32, v33
    v_cvt_pk_bf16_f32 v34, v34, v35
    v_accvgpr_write_b32 a204, v84
    v_accvgpr_write_b32 a205, v86
    v_accvgpr_write_b32 a206, v88
    v_accvgpr_write_b32 a207, v90
    v_accvgpr_write_b32 a208, v92
    v_accvgpr_write_b32 a209, v94
    v_accvgpr_write_b32 a210, v96
    v_accvgpr_write_b32 a211, v98
    v_accvgpr_write_b32 a212, v28
    v_accvgpr_write_b32 a213, v30
    v_accvgpr_write_b32 a214, v32
    v_accvgpr_write_b32 a215, v34
    ds_read_b128 v[76:79], v23 offset:1408
    ds_read_b128 v[80:83], v23 offset:1440
    v_accvgpr_read_b32 v85, a216
    v_accvgpr_read_b32 v87, a217
    v_accvgpr_read_b32 v89, a218
    v_accvgpr_read_b32 v91, a219
    v_accvgpr_read_b32 v93, a220
    v_accvgpr_read_b32 v95, a221
    v_accvgpr_read_b32 v97, a222
    v_accvgpr_read_b32 v99, a223
    v_accvgpr_read_b32 v29, a224
    v_accvgpr_read_b32 v31, a225
    v_accvgpr_read_b32 v33, a226
    v_accvgpr_read_b32 v35, a227
    v_lshlrev_b32 v84, 16, v85
    v_and_b32 v85, s23, v85
    v_lshlrev_b32 v86, 16, v87
    v_and_b32 v87, s23, v87
    v_lshlrev_b32 v88, 16, v89
    v_and_b32 v89, s23, v89
    v_lshlrev_b32 v90, 16, v91
    v_and_b32 v91, s23, v91
    v_lshlrev_b32 v92, 16, v93
    v_and_b32 v93, s23, v93
    v_lshlrev_b32 v94, 16, v95
    v_and_b32 v95, s23, v95
    v_lshlrev_b32 v96, 16, v97
    v_and_b32 v97, s23, v97
    v_lshlrev_b32 v98, 16, v99
    v_and_b32 v99, s23, v99
    v_lshlrev_b32 v28, 16, v29
    v_and_b32 v29, s23, v29
    v_lshlrev_b32 v30, 16, v31
    v_and_b32 v31, s23, v31
    v_lshlrev_b32 v32, 16, v33
    v_and_b32 v33, s23, v33
    v_lshlrev_b32 v34, 16, v35
    v_and_b32 v35, s23, v35
    s_waitcnt lgkmcnt(3)
    v_pk_mul_f32 v[84:85], v[84:85], v[68:69]
    v_pk_mul_f32 v[86:87], v[86:87], v[70:71]
    s_waitcnt lgkmcnt(2)
    v_pk_mul_f32 v[88:89], v[88:89], v[72:73]
    v_pk_mul_f32 v[90:91], v[90:91], v[74:75]
    v_pk_mul_f32 v[92:93], v[92:93], v[68:69]
    v_pk_mul_f32 v[94:95], v[94:95], v[70:71]
    v_pk_mul_f32 v[96:97], v[96:97], v[72:73]
    v_pk_mul_f32 v[98:99], v[98:99], v[74:75]
    v_pk_mul_f32 v[28:29], v[28:29], v[68:69]
    v_pk_mul_f32 v[30:31], v[30:31], v[70:71]
    v_pk_mul_f32 v[32:33], v[32:33], v[72:73]
    v_pk_mul_f32 v[34:35], v[34:35], v[74:75]
    v_cvt_pk_bf16_f32 v84, v84, v85
    v_cvt_pk_bf16_f32 v86, v86, v87
    v_cvt_pk_bf16_f32 v88, v88, v89
    v_cvt_pk_bf16_f32 v90, v90, v91
    v_cvt_pk_bf16_f32 v92, v92, v93
    v_cvt_pk_bf16_f32 v94, v94, v95
    v_cvt_pk_bf16_f32 v96, v96, v97
    v_cvt_pk_bf16_f32 v98, v98, v99
    v_cvt_pk_bf16_f32 v28, v28, v29
    v_cvt_pk_bf16_f32 v30, v30, v31
    v_cvt_pk_bf16_f32 v32, v32, v33
    v_cvt_pk_bf16_f32 v34, v34, v35
    v_accvgpr_write_b32 a216, v84
    v_accvgpr_write_b32 a217, v86
    v_accvgpr_write_b32 a218, v88
    v_accvgpr_write_b32 a219, v90
    v_accvgpr_write_b32 a220, v92
    v_accvgpr_write_b32 a221, v94
    v_accvgpr_write_b32 a222, v96
    v_accvgpr_write_b32 a223, v98
    v_accvgpr_write_b32 a224, v28
    v_accvgpr_write_b32 a225, v30
    v_accvgpr_write_b32 a226, v32
    v_accvgpr_write_b32 a227, v34
    ds_read_b128 v[68:71], v23 offset:1536
    ds_read_b128 v[72:75], v23 offset:1568
    v_accvgpr_read_b32 v85, a228
    v_accvgpr_read_b32 v87, a229
    v_accvgpr_read_b32 v89, a230
    v_accvgpr_read_b32 v91, a231
    v_accvgpr_read_b32 v93, a232
    v_accvgpr_read_b32 v95, a233
    v_accvgpr_read_b32 v97, a234
    v_accvgpr_read_b32 v99, a235
    v_accvgpr_read_b32 v29, a236
    v_accvgpr_read_b32 v31, a237
    v_accvgpr_read_b32 v33, a238
    v_accvgpr_read_b32 v35, a239
    v_lshlrev_b32 v84, 16, v85
    v_and_b32 v85, s23, v85
    v_lshlrev_b32 v86, 16, v87
    v_and_b32 v87, s23, v87
    v_lshlrev_b32 v88, 16, v89
    v_and_b32 v89, s23, v89
    v_lshlrev_b32 v90, 16, v91
    v_and_b32 v91, s23, v91
    v_lshlrev_b32 v92, 16, v93
    v_and_b32 v93, s23, v93
    v_lshlrev_b32 v94, 16, v95
    v_and_b32 v95, s23, v95
    v_lshlrev_b32 v96, 16, v97
    v_and_b32 v97, s23, v97
    v_lshlrev_b32 v98, 16, v99
    v_and_b32 v99, s23, v99
    v_lshlrev_b32 v28, 16, v29
    v_and_b32 v29, s23, v29
    v_lshlrev_b32 v30, 16, v31
    v_and_b32 v31, s23, v31
    v_lshlrev_b32 v32, 16, v33
    v_and_b32 v33, s23, v33
    v_lshlrev_b32 v34, 16, v35
    v_and_b32 v35, s23, v35
    s_waitcnt lgkmcnt(3)
    v_pk_mul_f32 v[84:85], v[84:85], v[76:77]
    v_pk_mul_f32 v[86:87], v[86:87], v[78:79]
    s_waitcnt lgkmcnt(2)
    v_pk_mul_f32 v[88:89], v[88:89], v[80:81]
    v_pk_mul_f32 v[90:91], v[90:91], v[82:83]
    v_pk_mul_f32 v[92:93], v[92:93], v[76:77]
    v_pk_mul_f32 v[94:95], v[94:95], v[78:79]
    v_pk_mul_f32 v[96:97], v[96:97], v[80:81]
    v_pk_mul_f32 v[98:99], v[98:99], v[82:83]
    v_pk_mul_f32 v[28:29], v[28:29], v[76:77]
    v_pk_mul_f32 v[30:31], v[30:31], v[78:79]
    v_pk_mul_f32 v[32:33], v[32:33], v[80:81]
    v_pk_mul_f32 v[34:35], v[34:35], v[82:83]
    v_cvt_pk_bf16_f32 v84, v84, v85
    v_cvt_pk_bf16_f32 v86, v86, v87
    v_cvt_pk_bf16_f32 v88, v88, v89
    v_cvt_pk_bf16_f32 v90, v90, v91
    v_cvt_pk_bf16_f32 v92, v92, v93
    v_cvt_pk_bf16_f32 v94, v94, v95
    v_cvt_pk_bf16_f32 v96, v96, v97
    v_cvt_pk_bf16_f32 v98, v98, v99
    v_cvt_pk_bf16_f32 v28, v28, v29
    v_cvt_pk_bf16_f32 v30, v30, v31
    v_cvt_pk_bf16_f32 v32, v32, v33
    v_cvt_pk_bf16_f32 v34, v34, v35
    v_accvgpr_write_b32 a228, v84
    v_accvgpr_write_b32 a229, v86
    v_accvgpr_write_b32 a230, v88
    v_accvgpr_write_b32 a231, v90
    v_accvgpr_write_b32 a232, v92
    v_accvgpr_write_b32 a233, v94
    v_accvgpr_write_b32 a234, v96
    v_accvgpr_write_b32 a235, v98
    v_accvgpr_write_b32 a236, v28
    v_accvgpr_write_b32 a237, v30
    v_accvgpr_write_b32 a238, v32
    v_accvgpr_write_b32 a239, v34
    ds_read_b128 v[76:79], v23 offset:1664
    ds_read_b128 v[80:83], v23 offset:1696
    v_accvgpr_read_b32 v85, a240
    v_accvgpr_read_b32 v87, a241
    v_accvgpr_read_b32 v89, a242
    v_accvgpr_read_b32 v91, a243
    v_accvgpr_read_b32 v93, a244
    v_accvgpr_read_b32 v95, a245
    v_accvgpr_read_b32 v97, a246
    v_accvgpr_read_b32 v99, a247
    v_accvgpr_read_b32 v29, a248
    v_accvgpr_read_b32 v31, a249
    v_accvgpr_read_b32 v33, a250
    v_accvgpr_read_b32 v35, a251
    v_lshlrev_b32 v84, 16, v85
    v_and_b32 v85, s23, v85
    v_lshlrev_b32 v86, 16, v87
    v_and_b32 v87, s23, v87
    v_lshlrev_b32 v88, 16, v89
    v_and_b32 v89, s23, v89
    v_lshlrev_b32 v90, 16, v91
    v_and_b32 v91, s23, v91
    v_lshlrev_b32 v92, 16, v93
    v_and_b32 v93, s23, v93
    v_lshlrev_b32 v94, 16, v95
    v_and_b32 v95, s23, v95
    v_lshlrev_b32 v96, 16, v97
    v_and_b32 v97, s23, v97
    v_lshlrev_b32 v98, 16, v99
    v_and_b32 v99, s23, v99
    v_lshlrev_b32 v28, 16, v29
    v_and_b32 v29, s23, v29
    v_lshlrev_b32 v30, 16, v31
    v_and_b32 v31, s23, v31
    v_lshlrev_b32 v32, 16, v33
    v_and_b32 v33, s23, v33
    v_lshlrev_b32 v34, 16, v35
    v_and_b32 v35, s23, v35
    s_waitcnt lgkmcnt(3)
    v_pk_mul_f32 v[84:85], v[84:85], v[68:69]
    v_pk_mul_f32 v[86:87], v[86:87], v[70:71]
    s_waitcnt lgkmcnt(2)
    v_pk_mul_f32 v[88:89], v[88:89], v[72:73]
    v_pk_mul_f32 v[90:91], v[90:91], v[74:75]
    v_pk_mul_f32 v[92:93], v[92:93], v[68:69]
    v_pk_mul_f32 v[94:95], v[94:95], v[70:71]
    v_pk_mul_f32 v[96:97], v[96:97], v[72:73]
    v_pk_mul_f32 v[98:99], v[98:99], v[74:75]
    v_pk_mul_f32 v[28:29], v[28:29], v[68:69]
    v_pk_mul_f32 v[30:31], v[30:31], v[70:71]
    v_pk_mul_f32 v[32:33], v[32:33], v[72:73]
    v_pk_mul_f32 v[34:35], v[34:35], v[74:75]
    v_cvt_pk_bf16_f32 v84, v84, v85
    v_cvt_pk_bf16_f32 v86, v86, v87
    v_cvt_pk_bf16_f32 v88, v88, v89
    v_cvt_pk_bf16_f32 v90, v90, v91
    v_cvt_pk_bf16_f32 v92, v92, v93
    v_cvt_pk_bf16_f32 v94, v94, v95
    v_cvt_pk_bf16_f32 v96, v96, v97
    v_cvt_pk_bf16_f32 v98, v98, v99
    v_cvt_pk_bf16_f32 v28, v28, v29
    v_cvt_pk_bf16_f32 v30, v30, v31
    v_cvt_pk_bf16_f32 v32, v32, v33
    v_cvt_pk_bf16_f32 v34, v34, v35
    v_accvgpr_write_b32 a240, v84
    v_accvgpr_write_b32 a241, v86
    v_accvgpr_write_b32 a242, v88
    v_accvgpr_write_b32 a243, v90
    v_accvgpr_write_b32 a244, v92
    v_accvgpr_write_b32 a245, v94
    v_accvgpr_write_b32 a246, v96
    v_accvgpr_write_b32 a247, v98
    v_accvgpr_write_b32 a248, v28
    v_accvgpr_write_b32 a249, v30
    v_accvgpr_write_b32 a250, v32
    v_accvgpr_write_b32 a251, v34
    ds_read_b128 v[68:71], v23 offset:1792
    ds_read_b128 v[72:75], v23 offset:1824
    v_accvgpr_read_b32 v85, a252
    v_accvgpr_read_b32 v87, a253
    v_accvgpr_read_b32 v89, a254
    v_accvgpr_read_b32 v91, a255
    v_lshlrev_b32 v84, 16, v85
    v_and_b32 v85, s23, v85
    v_lshlrev_b32 v86, 16, v87
    v_and_b32 v87, s23, v87
    v_lshlrev_b32 v88, 16, v89
    v_and_b32 v89, s23, v89
    v_lshlrev_b32 v90, 16, v91
    v_and_b32 v91, s23, v91
    v_lshlrev_b32 v92, 16, v160
    v_and_b32 v93, s23, v160
    v_lshlrev_b32 v94, 16, v161
    v_and_b32 v95, s23, v161
    v_lshlrev_b32 v96, 16, v162
    v_and_b32 v97, s23, v162
    v_lshlrev_b32 v98, 16, v163
    v_and_b32 v99, s23, v163
    v_lshlrev_b32 v28, 16, v164
    v_and_b32 v29, s23, v164
    v_lshlrev_b32 v30, 16, v165
    v_and_b32 v31, s23, v165
    v_lshlrev_b32 v32, 16, v166
    v_and_b32 v33, s23, v166
    v_lshlrev_b32 v34, 16, v167
    v_and_b32 v35, s23, v167
    s_waitcnt lgkmcnt(3)
    v_pk_mul_f32 v[84:85], v[84:85], v[76:77]
    v_pk_mul_f32 v[86:87], v[86:87], v[78:79]
    s_waitcnt lgkmcnt(2)
    v_pk_mul_f32 v[88:89], v[88:89], v[80:81]
    v_pk_mul_f32 v[90:91], v[90:91], v[82:83]
    v_pk_mul_f32 v[92:93], v[92:93], v[76:77]
    v_pk_mul_f32 v[94:95], v[94:95], v[78:79]
    v_pk_mul_f32 v[96:97], v[96:97], v[80:81]
    v_pk_mul_f32 v[98:99], v[98:99], v[82:83]
    v_pk_mul_f32 v[28:29], v[28:29], v[76:77]
    v_pk_mul_f32 v[30:31], v[30:31], v[78:79]
    v_pk_mul_f32 v[32:33], v[32:33], v[80:81]
    v_pk_mul_f32 v[34:35], v[34:35], v[82:83]
    v_cvt_pk_bf16_f32 v84, v84, v85
    v_cvt_pk_bf16_f32 v86, v86, v87
    v_cvt_pk_bf16_f32 v88, v88, v89
    v_cvt_pk_bf16_f32 v90, v90, v91
    v_cvt_pk_bf16_f32 v160, v92, v93
    v_cvt_pk_bf16_f32 v161, v94, v95
    v_cvt_pk_bf16_f32 v162, v96, v97
    v_cvt_pk_bf16_f32 v163, v98, v99
    v_cvt_pk_bf16_f32 v164, v28, v29
    v_cvt_pk_bf16_f32 v165, v30, v31
    v_cvt_pk_bf16_f32 v166, v32, v33
    v_cvt_pk_bf16_f32 v167, v34, v35
    v_accvgpr_write_b32 a252, v84
    v_accvgpr_write_b32 a253, v86
    v_accvgpr_write_b32 a254, v88
    v_accvgpr_write_b32 a255, v90
    ds_read_b128 v[76:79], v23 offset:1920
    ds_read_b128 v[80:83], v23 offset:1952
    v_lshlrev_b32 v84, 16, v168
    v_and_b32 v85, s23, v168
    v_lshlrev_b32 v86, 16, v169
    v_and_b32 v87, s23, v169
    v_lshlrev_b32 v88, 16, v170
    v_and_b32 v89, s23, v170
    v_lshlrev_b32 v90, 16, v171
    v_and_b32 v91, s23, v171
    v_lshlrev_b32 v92, 16, v172
    v_and_b32 v93, s23, v172
    v_lshlrev_b32 v94, 16, v173
    v_and_b32 v95, s23, v173
    v_lshlrev_b32 v96, 16, v174
    v_and_b32 v97, s23, v174
    v_lshlrev_b32 v98, 16, v175
    v_and_b32 v99, s23, v175
    v_lshlrev_b32 v28, 16, v176
    v_and_b32 v29, s23, v176
    v_lshlrev_b32 v30, 16, v177
    v_and_b32 v31, s23, v177
    v_lshlrev_b32 v32, 16, v178
    v_and_b32 v33, s23, v178
    v_lshlrev_b32 v34, 16, v179
    v_and_b32 v35, s23, v179
    s_waitcnt lgkmcnt(3)
    v_pk_mul_f32 v[84:85], v[84:85], v[68:69]
    v_pk_mul_f32 v[86:87], v[86:87], v[70:71]
    s_waitcnt lgkmcnt(2)
    v_pk_mul_f32 v[88:89], v[88:89], v[72:73]
    v_pk_mul_f32 v[90:91], v[90:91], v[74:75]
    v_pk_mul_f32 v[92:93], v[92:93], v[68:69]
    v_pk_mul_f32 v[94:95], v[94:95], v[70:71]
    v_pk_mul_f32 v[96:97], v[96:97], v[72:73]
    v_pk_mul_f32 v[98:99], v[98:99], v[74:75]
    v_pk_mul_f32 v[28:29], v[28:29], v[68:69]
    v_pk_mul_f32 v[30:31], v[30:31], v[70:71]
    v_pk_mul_f32 v[32:33], v[32:33], v[72:73]
    v_pk_mul_f32 v[34:35], v[34:35], v[74:75]
    v_cvt_pk_bf16_f32 v168, v84, v85
    v_cvt_pk_bf16_f32 v169, v86, v87
    v_cvt_pk_bf16_f32 v170, v88, v89
    v_cvt_pk_bf16_f32 v171, v90, v91
    v_cvt_pk_bf16_f32 v172, v92, v93
    v_cvt_pk_bf16_f32 v173, v94, v95
    v_cvt_pk_bf16_f32 v174, v96, v97
    v_cvt_pk_bf16_f32 v175, v98, v99
    v_cvt_pk_bf16_f32 v176, v28, v29
    v_cvt_pk_bf16_f32 v177, v30, v31
    v_cvt_pk_bf16_f32 v178, v32, v33
    v_cvt_pk_bf16_f32 v179, v34, v35
    ds_read_b128 v[68:71], v23 offset:2048
    ds_read_b128 v[72:75], v23 offset:2080
    ds_read_b64 v[60:61], v0 offset:1024
    ds_read_b64 v[62:63], v0 offset:1040
    v_lshlrev_b32 v84, 16, v180
    v_and_b32 v85, s23, v180
    v_lshlrev_b32 v86, 16, v181
    v_and_b32 v87, s23, v181
    v_lshlrev_b32 v88, 16, v182
    v_and_b32 v89, s23, v182
    v_lshlrev_b32 v90, 16, v183
    v_and_b32 v91, s23, v183
    v_lshlrev_b32 v92, 16, v184
    v_and_b32 v93, s23, v184
    v_lshlrev_b32 v94, 16, v185
    v_and_b32 v95, s23, v185
    v_lshlrev_b32 v96, 16, v186
    v_and_b32 v97, s23, v186
    v_lshlrev_b32 v98, 16, v187
    v_and_b32 v99, s23, v187
    v_lshlrev_b32 v28, 16, v188
    v_and_b32 v29, s23, v188
    v_lshlrev_b32 v30, 16, v189
    v_and_b32 v31, s23, v189
    v_lshlrev_b32 v32, 16, v190
    v_and_b32 v33, s23, v190
    v_lshlrev_b32 v34, 16, v191
    v_and_b32 v35, s23, v191
    s_waitcnt lgkmcnt(5)
    v_pk_mul_f32 v[84:85], v[84:85], v[76:77]
    v_pk_mul_f32 v[86:87], v[86:87], v[78:79]
    s_waitcnt lgkmcnt(4)
    v_pk_mul_f32 v[88:89], v[88:89], v[80:81]
    v_pk_mul_f32 v[90:91], v[90:91], v[82:83]
    v_pk_mul_f32 v[92:93], v[92:93], v[76:77]
    v_pk_mul_f32 v[94:95], v[94:95], v[78:79]
    v_pk_mul_f32 v[96:97], v[96:97], v[80:81]
    v_pk_mul_f32 v[98:99], v[98:99], v[82:83]
    v_pk_mul_f32 v[28:29], v[28:29], v[76:77]
    v_pk_mul_f32 v[30:31], v[30:31], v[78:79]
    v_pk_mul_f32 v[32:33], v[32:33], v[80:81]
    v_pk_mul_f32 v[34:35], v[34:35], v[82:83]
    v_cvt_pk_bf16_f32 v180, v84, v85
    v_cvt_pk_bf16_f32 v181, v86, v87
    v_cvt_pk_bf16_f32 v182, v88, v89
    v_cvt_pk_bf16_f32 v183, v90, v91
    v_cvt_pk_bf16_f32 v184, v92, v93
    v_cvt_pk_bf16_f32 v185, v94, v95
    v_cvt_pk_bf16_f32 v186, v96, v97
    v_cvt_pk_bf16_f32 v187, v98, v99
    v_cvt_pk_bf16_f32 v188, v28, v29
    v_cvt_pk_bf16_f32 v189, v30, v31
    v_cvt_pk_bf16_f32 v190, v32, v33
    v_cvt_pk_bf16_f32 v191, v34, v35
    ds_read_b128 v[76:79], v23 offset:2176
    ds_read_b128 v[80:83], v23 offset:2208
    ds_read_b64 v[64:65], v0 offset:1088
    ds_read_b64 v[66:67], v0 offset:1104
    s_waitcnt vmcnt(38) lgkmcnt(4)
    v_mfma_f32_16x16x32_bf16 v[116:119], v[60:63], v[192:195], v[116:119]
    s_waitcnt vmcnt(37)
    v_mfma_f32_16x16x32_bf16 v[120:123], v[60:63], v[196:199], v[120:123]
    s_waitcnt vmcnt(36)
    v_mfma_f32_16x16x32_bf16 v[124:127], v[60:63], v[200:203], v[124:127]
    v_lshlrev_b32 v84, 16, v192
    v_and_b32 v85, s23, v192
    v_lshlrev_b32 v86, 16, v193
    v_and_b32 v87, s23, v193
    v_lshlrev_b32 v88, 16, v194
    v_and_b32 v89, s23, v194
    v_lshlrev_b32 v90, 16, v195
    v_and_b32 v91, s23, v195
    v_lshlrev_b32 v92, 16, v196
    v_and_b32 v93, s23, v196
    v_lshlrev_b32 v94, 16, v197
    v_and_b32 v95, s23, v197
    v_lshlrev_b32 v96, 16, v198
    v_and_b32 v97, s23, v198
    v_lshlrev_b32 v98, 16, v199
    v_and_b32 v99, s23, v199
    v_lshlrev_b32 v28, 16, v200
    v_and_b32 v29, s23, v200
    v_lshlrev_b32 v30, 16, v201
    v_and_b32 v31, s23, v201
    v_lshlrev_b32 v32, 16, v202
    v_and_b32 v33, s23, v202
    v_lshlrev_b32 v34, 16, v203
    v_and_b32 v35, s23, v203
    v_pk_mul_f32 v[84:85], v[84:85], v[68:69]
    v_pk_mul_f32 v[86:87], v[86:87], v[70:71]
    v_pk_mul_f32 v[88:89], v[88:89], v[72:73]
    v_pk_mul_f32 v[90:91], v[90:91], v[74:75]
    v_pk_mul_f32 v[92:93], v[92:93], v[68:69]
    v_pk_mul_f32 v[94:95], v[94:95], v[70:71]
    v_pk_mul_f32 v[96:97], v[96:97], v[72:73]
    v_pk_mul_f32 v[98:99], v[98:99], v[74:75]
    v_pk_mul_f32 v[28:29], v[28:29], v[68:69]
    v_pk_mul_f32 v[30:31], v[30:31], v[70:71]
    v_pk_mul_f32 v[32:33], v[32:33], v[72:73]
    v_pk_mul_f32 v[34:35], v[34:35], v[74:75]
    v_cvt_pk_bf16_f32 v192, v84, v85
    v_cvt_pk_bf16_f32 v193, v86, v87
    v_cvt_pk_bf16_f32 v194, v88, v89
    v_cvt_pk_bf16_f32 v195, v90, v91
    v_cvt_pk_bf16_f32 v196, v92, v93
    v_cvt_pk_bf16_f32 v197, v94, v95
    v_cvt_pk_bf16_f32 v198, v96, v97
    v_cvt_pk_bf16_f32 v199, v98, v99
    v_cvt_pk_bf16_f32 v200, v28, v29
    v_cvt_pk_bf16_f32 v201, v30, v31
    v_cvt_pk_bf16_f32 v202, v32, v33
    v_cvt_pk_bf16_f32 v203, v34, v35
    ds_read_b128 v[68:71], v23 offset:2304
    ds_read_b128 v[72:75], v23 offset:2336
    ds_read_b64 v[56:57], v0 offset:1152
    ds_read_b64 v[58:59], v0 offset:1168
    s_waitcnt vmcnt(35) lgkmcnt(4)
    v_mfma_f32_16x16x32_bf16 v[116:119], v[64:67], v[204:207], v[116:119]
    s_waitcnt vmcnt(34)
    v_mfma_f32_16x16x32_bf16 v[120:123], v[64:67], v[208:211], v[120:123]
    s_waitcnt vmcnt(33)
    v_mfma_f32_16x16x32_bf16 v[124:127], v[64:67], v[212:215], v[124:127]
    v_lshlrev_b32 v84, 16, v204
    v_and_b32 v85, s23, v204
    v_lshlrev_b32 v86, 16, v205
    v_and_b32 v87, s23, v205
    v_lshlrev_b32 v88, 16, v206
    v_and_b32 v89, s23, v206
    v_lshlrev_b32 v90, 16, v207
    v_and_b32 v91, s23, v207
    v_lshlrev_b32 v92, 16, v208
    v_and_b32 v93, s23, v208
    v_lshlrev_b32 v94, 16, v209
    v_and_b32 v95, s23, v209
    v_lshlrev_b32 v96, 16, v210
    v_and_b32 v97, s23, v210
    v_lshlrev_b32 v98, 16, v211
    v_and_b32 v99, s23, v211
    v_lshlrev_b32 v28, 16, v212
    v_and_b32 v29, s23, v212
    v_lshlrev_b32 v30, 16, v213
    v_and_b32 v31, s23, v213
    v_lshlrev_b32 v32, 16, v214
    v_and_b32 v33, s23, v214
    v_lshlrev_b32 v34, 16, v215
    v_and_b32 v35, s23, v215
    v_pk_mul_f32 v[84:85], v[84:85], v[76:77]
    v_pk_mul_f32 v[86:87], v[86:87], v[78:79]
    v_pk_mul_f32 v[88:89], v[88:89], v[80:81]
    v_pk_mul_f32 v[90:91], v[90:91], v[82:83]
    v_pk_mul_f32 v[92:93], v[92:93], v[76:77]
    v_pk_mul_f32 v[94:95], v[94:95], v[78:79]
    v_pk_mul_f32 v[96:97], v[96:97], v[80:81]
    v_pk_mul_f32 v[98:99], v[98:99], v[82:83]
    v_pk_mul_f32 v[28:29], v[28:29], v[76:77]
    v_pk_mul_f32 v[30:31], v[30:31], v[78:79]
    v_pk_mul_f32 v[32:33], v[32:33], v[80:81]
    v_pk_mul_f32 v[34:35], v[34:35], v[82:83]
    v_cvt_pk_bf16_f32 v204, v84, v85
    v_cvt_pk_bf16_f32 v205, v86, v87
    v_cvt_pk_bf16_f32 v206, v88, v89
    v_cvt_pk_bf16_f32 v207, v90, v91
    v_cvt_pk_bf16_f32 v208, v92, v93
    v_cvt_pk_bf16_f32 v209, v94, v95
    v_cvt_pk_bf16_f32 v210, v96, v97
    v_cvt_pk_bf16_f32 v211, v98, v99
    v_cvt_pk_bf16_f32 v212, v28, v29
    v_cvt_pk_bf16_f32 v213, v30, v31
    v_cvt_pk_bf16_f32 v214, v32, v33
    v_cvt_pk_bf16_f32 v215, v34, v35
    ds_read_b128 v[76:79], v23 offset:2432
    ds_read_b128 v[80:83], v23 offset:2464
    ds_read_b64 v[60:61], v0 offset:1216
    ds_read_b64 v[62:63], v0 offset:1232
    s_waitcnt vmcnt(32) lgkmcnt(4)
    v_mfma_f32_16x16x32_bf16 v[116:119], v[56:59], v[216:219], v[116:119]
    s_waitcnt vmcnt(31)
    v_mfma_f32_16x16x32_bf16 v[120:123], v[56:59], v[220:223], v[120:123]
    s_waitcnt vmcnt(30)
    v_mfma_f32_16x16x32_bf16 v[124:127], v[56:59], v[224:227], v[124:127]
    v_lshlrev_b32 v84, 16, v216
    v_and_b32 v85, s23, v216
    v_lshlrev_b32 v86, 16, v217
    v_and_b32 v87, s23, v217
    v_lshlrev_b32 v88, 16, v218
    v_and_b32 v89, s23, v218
    v_lshlrev_b32 v90, 16, v219
    v_and_b32 v91, s23, v219
    v_lshlrev_b32 v92, 16, v220
    v_and_b32 v93, s23, v220
    v_lshlrev_b32 v94, 16, v221
    v_and_b32 v95, s23, v221
    v_lshlrev_b32 v96, 16, v222
    v_and_b32 v97, s23, v222
    v_lshlrev_b32 v98, 16, v223
    v_and_b32 v99, s23, v223
    v_lshlrev_b32 v28, 16, v224
    v_and_b32 v29, s23, v224
    v_lshlrev_b32 v30, 16, v225
    v_and_b32 v31, s23, v225
    v_lshlrev_b32 v32, 16, v226
    v_and_b32 v33, s23, v226
    v_lshlrev_b32 v34, 16, v227
    v_and_b32 v35, s23, v227
    v_pk_mul_f32 v[84:85], v[84:85], v[68:69]
    v_pk_mul_f32 v[86:87], v[86:87], v[70:71]
    v_pk_mul_f32 v[88:89], v[88:89], v[72:73]
    v_pk_mul_f32 v[90:91], v[90:91], v[74:75]
    v_pk_mul_f32 v[92:93], v[92:93], v[68:69]
    v_pk_mul_f32 v[94:95], v[94:95], v[70:71]
    v_pk_mul_f32 v[96:97], v[96:97], v[72:73]
    v_pk_mul_f32 v[98:99], v[98:99], v[74:75]
    v_pk_mul_f32 v[28:29], v[28:29], v[68:69]
    v_pk_mul_f32 v[30:31], v[30:31], v[70:71]
    v_pk_mul_f32 v[32:33], v[32:33], v[72:73]
    v_pk_mul_f32 v[34:35], v[34:35], v[74:75]
    v_cvt_pk_bf16_f32 v216, v84, v85
    v_cvt_pk_bf16_f32 v217, v86, v87
    v_cvt_pk_bf16_f32 v218, v88, v89
    v_cvt_pk_bf16_f32 v219, v90, v91
    v_cvt_pk_bf16_f32 v220, v92, v93
    v_cvt_pk_bf16_f32 v221, v94, v95
    v_cvt_pk_bf16_f32 v222, v96, v97
    v_cvt_pk_bf16_f32 v223, v98, v99
    v_cvt_pk_bf16_f32 v224, v28, v29
    v_cvt_pk_bf16_f32 v225, v30, v31
    v_cvt_pk_bf16_f32 v226, v32, v33
    v_cvt_pk_bf16_f32 v227, v34, v35
    ds_read_b128 v[68:71], v23 offset:2560
    ds_read_b128 v[72:75], v23 offset:2592
    ds_read_b64 v[64:65], v0 offset:1280
    ds_read_b64 v[66:67], v0 offset:1296
    s_waitcnt vmcnt(29) lgkmcnt(4)
    v_mfma_f32_16x16x32_bf16 v[116:119], v[60:63], v[228:231], v[116:119]
    s_waitcnt vmcnt(28)
    v_mfma_f32_16x16x32_bf16 v[120:123], v[60:63], v[232:235], v[120:123]
    s_waitcnt vmcnt(27)
    v_mfma_f32_16x16x32_bf16 v[124:127], v[60:63], v[236:239], v[124:127]
    v_lshlrev_b32 v84, 16, v228
    v_and_b32 v85, s23, v228
    v_lshlrev_b32 v86, 16, v229
    v_and_b32 v87, s23, v229
    v_lshlrev_b32 v88, 16, v230
    v_and_b32 v89, s23, v230
    v_lshlrev_b32 v90, 16, v231
    v_and_b32 v91, s23, v231
    v_lshlrev_b32 v92, 16, v232
    v_and_b32 v93, s23, v232
    v_lshlrev_b32 v94, 16, v233
    v_and_b32 v95, s23, v233
    v_lshlrev_b32 v96, 16, v234
    v_and_b32 v97, s23, v234
    v_lshlrev_b32 v98, 16, v235
    v_and_b32 v99, s23, v235
    v_lshlrev_b32 v28, 16, v236
    v_and_b32 v29, s23, v236
    v_lshlrev_b32 v30, 16, v237
    v_and_b32 v31, s23, v237
    v_lshlrev_b32 v32, 16, v238
    v_and_b32 v33, s23, v238
    v_lshlrev_b32 v34, 16, v239
    v_and_b32 v35, s23, v239
    v_pk_mul_f32 v[84:85], v[84:85], v[76:77]
    v_pk_mul_f32 v[86:87], v[86:87], v[78:79]
    v_pk_mul_f32 v[88:89], v[88:89], v[80:81]
    v_pk_mul_f32 v[90:91], v[90:91], v[82:83]
    v_pk_mul_f32 v[92:93], v[92:93], v[76:77]
    v_pk_mul_f32 v[94:95], v[94:95], v[78:79]
    v_pk_mul_f32 v[96:97], v[96:97], v[80:81]
    v_pk_mul_f32 v[98:99], v[98:99], v[82:83]
    v_pk_mul_f32 v[28:29], v[28:29], v[76:77]
    v_pk_mul_f32 v[30:31], v[30:31], v[78:79]
    v_pk_mul_f32 v[32:33], v[32:33], v[80:81]
    v_pk_mul_f32 v[34:35], v[34:35], v[82:83]
    v_cvt_pk_bf16_f32 v228, v84, v85
    v_cvt_pk_bf16_f32 v229, v86, v87
    v_cvt_pk_bf16_f32 v230, v88, v89
    v_cvt_pk_bf16_f32 v231, v90, v91
    v_cvt_pk_bf16_f32 v232, v92, v93
    v_cvt_pk_bf16_f32 v233, v94, v95
    v_cvt_pk_bf16_f32 v234, v96, v97
    v_cvt_pk_bf16_f32 v235, v98, v99
    v_cvt_pk_bf16_f32 v236, v28, v29
    v_cvt_pk_bf16_f32 v237, v30, v31
    v_cvt_pk_bf16_f32 v238, v32, v33
    v_cvt_pk_bf16_f32 v239, v34, v35
    ds_read_b128 v[76:79], v23 offset:2688
    ds_read_b128 v[80:83], v23 offset:2720
    ds_read_b64 v[56:57], v0 offset:1344
    ds_read_b64 v[58:59], v0 offset:1360
    s_waitcnt vmcnt(26) lgkmcnt(4)
    v_mfma_f32_16x16x32_bf16 v[116:119], v[64:67], v[240:243], v[116:119]
    s_waitcnt vmcnt(25)
    v_mfma_f32_16x16x32_bf16 v[120:123], v[64:67], v[244:247], v[120:123]
    s_waitcnt vmcnt(24)
    v_mfma_f32_16x16x32_bf16 v[124:127], v[64:67], v[248:251], v[124:127]
    v_lshlrev_b32 v84, 16, v240
    v_and_b32 v85, s23, v240
    v_lshlrev_b32 v86, 16, v241
    v_and_b32 v87, s23, v241
    v_lshlrev_b32 v88, 16, v242
    v_and_b32 v89, s23, v242
    v_lshlrev_b32 v90, 16, v243
    v_and_b32 v91, s23, v243
    v_lshlrev_b32 v92, 16, v244
    v_and_b32 v93, s23, v244
    v_lshlrev_b32 v94, 16, v245
    v_and_b32 v95, s23, v245
    v_lshlrev_b32 v96, 16, v246
    v_and_b32 v97, s23, v246
    v_lshlrev_b32 v98, 16, v247
    v_and_b32 v99, s23, v247
    v_lshlrev_b32 v28, 16, v248
    v_and_b32 v29, s23, v248
    v_lshlrev_b32 v30, 16, v249
    v_and_b32 v31, s23, v249
    v_lshlrev_b32 v32, 16, v250
    v_and_b32 v33, s23, v250
    v_lshlrev_b32 v34, 16, v251
    v_and_b32 v35, s23, v251
    v_pk_mul_f32 v[84:85], v[84:85], v[68:69]
    v_pk_mul_f32 v[86:87], v[86:87], v[70:71]
    v_pk_mul_f32 v[88:89], v[88:89], v[72:73]
    v_pk_mul_f32 v[90:91], v[90:91], v[74:75]
    v_pk_mul_f32 v[92:93], v[92:93], v[68:69]
    v_pk_mul_f32 v[94:95], v[94:95], v[70:71]
    v_pk_mul_f32 v[96:97], v[96:97], v[72:73]
    v_pk_mul_f32 v[98:99], v[98:99], v[74:75]
    v_pk_mul_f32 v[28:29], v[28:29], v[68:69]
    v_pk_mul_f32 v[30:31], v[30:31], v[70:71]
    v_pk_mul_f32 v[32:33], v[32:33], v[72:73]
    v_pk_mul_f32 v[34:35], v[34:35], v[74:75]
    v_cvt_pk_bf16_f32 v240, v84, v85
    v_cvt_pk_bf16_f32 v241, v86, v87
    v_cvt_pk_bf16_f32 v242, v88, v89
    v_cvt_pk_bf16_f32 v243, v90, v91
    v_cvt_pk_bf16_f32 v244, v92, v93
    v_cvt_pk_bf16_f32 v245, v94, v95
    v_cvt_pk_bf16_f32 v246, v96, v97
    v_cvt_pk_bf16_f32 v247, v98, v99
    v_cvt_pk_bf16_f32 v248, v28, v29
    v_cvt_pk_bf16_f32 v249, v30, v31
    v_cvt_pk_bf16_f32 v250, v32, v33
    v_cvt_pk_bf16_f32 v251, v34, v35
    ds_read_b128 v[68:71], v23 offset:2816
    ds_read_b128 v[72:75], v23 offset:2848
    ds_read_b64 v[60:61], v0 offset:1408
    ds_read_b64 v[62:63], v0 offset:1424
    s_waitcnt vmcnt(23) lgkmcnt(4)
    v_mfma_f32_16x16x32_bf16 v[116:119], v[56:59], v[252:255], v[116:119]
    s_waitcnt vmcnt(22)
    v_mfma_f32_16x16x32_bf16 v[120:123], v[56:59], v[128:131], v[120:123]
    s_waitcnt vmcnt(21)
    v_mfma_f32_16x16x32_bf16 v[124:127], v[56:59], v[132:135], v[124:127]
    v_lshlrev_b32 v84, 16, v252
    v_and_b32 v85, s23, v252
    v_lshlrev_b32 v86, 16, v253
    v_and_b32 v87, s23, v253
    v_lshlrev_b32 v88, 16, v254
    v_and_b32 v89, s23, v254
    v_lshlrev_b32 v90, 16, v255
    v_and_b32 v91, s23, v255
    v_lshlrev_b32 v92, 16, v128
    v_and_b32 v93, s23, v128
    v_lshlrev_b32 v94, 16, v129
    v_and_b32 v95, s23, v129
    v_lshlrev_b32 v96, 16, v130
    v_and_b32 v97, s23, v130
    v_lshlrev_b32 v98, 16, v131
    v_and_b32 v99, s23, v131
    v_lshlrev_b32 v28, 16, v132
    v_and_b32 v29, s23, v132
    v_lshlrev_b32 v30, 16, v133
    v_and_b32 v31, s23, v133
    v_lshlrev_b32 v32, 16, v134
    v_and_b32 v33, s23, v134
    v_lshlrev_b32 v34, 16, v135
    v_and_b32 v35, s23, v135
    v_pk_mul_f32 v[84:85], v[84:85], v[76:77]
    v_pk_mul_f32 v[86:87], v[86:87], v[78:79]
    v_pk_mul_f32 v[88:89], v[88:89], v[80:81]
    v_pk_mul_f32 v[90:91], v[90:91], v[82:83]
    v_pk_mul_f32 v[92:93], v[92:93], v[76:77]
    v_pk_mul_f32 v[94:95], v[94:95], v[78:79]
    v_pk_mul_f32 v[96:97], v[96:97], v[80:81]
    v_pk_mul_f32 v[98:99], v[98:99], v[82:83]
    v_pk_mul_f32 v[28:29], v[28:29], v[76:77]
    v_pk_mul_f32 v[30:31], v[30:31], v[78:79]
    v_pk_mul_f32 v[32:33], v[32:33], v[80:81]
    v_pk_mul_f32 v[34:35], v[34:35], v[82:83]
    v_cvt_pk_bf16_f32 v252, v84, v85
    v_cvt_pk_bf16_f32 v253, v86, v87
    v_cvt_pk_bf16_f32 v254, v88, v89
    v_cvt_pk_bf16_f32 v255, v90, v91
    v_cvt_pk_bf16_f32 v128, v92, v93
    v_cvt_pk_bf16_f32 v129, v94, v95
    v_cvt_pk_bf16_f32 v130, v96, v97
    v_cvt_pk_bf16_f32 v131, v98, v99
    v_cvt_pk_bf16_f32 v132, v28, v29
    v_cvt_pk_bf16_f32 v133, v30, v31
    v_cvt_pk_bf16_f32 v134, v32, v33
    v_cvt_pk_bf16_f32 v135, v34, v35
    ds_read_b128 v[76:79], v23 offset:2944
    ds_read_b128 v[80:83], v23 offset:2976
    ds_read_b64 v[64:65], v0 offset:1472
    ds_read_b64 v[66:67], v0 offset:1488
    s_waitcnt vmcnt(20) lgkmcnt(4)
    v_mfma_f32_16x16x32_bf16 v[116:119], v[60:63], v[136:139], v[116:119]
    s_waitcnt vmcnt(19)
    v_mfma_f32_16x16x32_bf16 v[120:123], v[60:63], v[140:143], v[120:123]
    s_waitcnt vmcnt(18)
    v_mfma_f32_16x16x32_bf16 v[124:127], v[60:63], v[144:147], v[124:127]
    v_lshlrev_b32 v84, 16, v136
    v_and_b32 v85, s23, v136
    v_lshlrev_b32 v86, 16, v137
    v_and_b32 v87, s23, v137
    v_lshlrev_b32 v88, 16, v138
    v_and_b32 v89, s23, v138
    v_lshlrev_b32 v90, 16, v139
    v_and_b32 v91, s23, v139
    v_lshlrev_b32 v92, 16, v140
    v_and_b32 v93, s23, v140
    v_lshlrev_b32 v94, 16, v141
    v_and_b32 v95, s23, v141
    v_lshlrev_b32 v96, 16, v142
    v_and_b32 v97, s23, v142
    v_lshlrev_b32 v98, 16, v143
    v_and_b32 v99, s23, v143
    v_lshlrev_b32 v28, 16, v144
    v_and_b32 v29, s23, v144
    v_lshlrev_b32 v30, 16, v145
    v_and_b32 v31, s23, v145
    v_lshlrev_b32 v32, 16, v146
    v_and_b32 v33, s23, v146
    v_lshlrev_b32 v34, 16, v147
    v_and_b32 v35, s23, v147
    v_pk_mul_f32 v[84:85], v[84:85], v[68:69]
    v_pk_mul_f32 v[86:87], v[86:87], v[70:71]
    v_pk_mul_f32 v[88:89], v[88:89], v[72:73]
    v_pk_mul_f32 v[90:91], v[90:91], v[74:75]
    v_pk_mul_f32 v[92:93], v[92:93], v[68:69]
    v_pk_mul_f32 v[94:95], v[94:95], v[70:71]
    v_pk_mul_f32 v[96:97], v[96:97], v[72:73]
    v_pk_mul_f32 v[98:99], v[98:99], v[74:75]
    v_pk_mul_f32 v[28:29], v[28:29], v[68:69]
    v_pk_mul_f32 v[30:31], v[30:31], v[70:71]
    v_pk_mul_f32 v[32:33], v[32:33], v[72:73]
    v_pk_mul_f32 v[34:35], v[34:35], v[74:75]
    v_cvt_pk_bf16_f32 v136, v84, v85
    v_cvt_pk_bf16_f32 v137, v86, v87
    v_cvt_pk_bf16_f32 v138, v88, v89
    v_cvt_pk_bf16_f32 v139, v90, v91
    v_cvt_pk_bf16_f32 v140, v92, v93
    v_cvt_pk_bf16_f32 v141, v94, v95
    v_cvt_pk_bf16_f32 v142, v96, v97
    v_cvt_pk_bf16_f32 v143, v98, v99
    v_cvt_pk_bf16_f32 v144, v28, v29
    v_cvt_pk_bf16_f32 v145, v30, v31
    v_cvt_pk_bf16_f32 v146, v32, v33
    v_cvt_pk_bf16_f32 v147, v34, v35
    s_waitcnt vmcnt(17) lgkmcnt(0)
    v_mfma_f32_16x16x32_bf16 v[116:119], v[64:67], v[148:151], v[116:119]
    s_waitcnt vmcnt(16)
    v_mfma_f32_16x16x32_bf16 v[120:123], v[64:67], v[152:155], v[120:123]
    s_waitcnt vmcnt(15)
    v_mfma_f32_16x16x32_bf16 v[124:127], v[64:67], v[156:159], v[124:127]
    v_lshlrev_b32 v84, 16, v148
    v_and_b32 v85, s23, v148
    v_lshlrev_b32 v86, 16, v149
    v_and_b32 v87, s23, v149
    v_lshlrev_b32 v88, 16, v150
    v_and_b32 v89, s23, v150
    v_lshlrev_b32 v90, 16, v151
    v_and_b32 v91, s23, v151
    v_lshlrev_b32 v92, 16, v152
    v_and_b32 v93, s23, v152
    v_lshlrev_b32 v94, 16, v153
    v_and_b32 v95, s23, v153
    v_lshlrev_b32 v96, 16, v154
    v_and_b32 v97, s23, v154
    v_lshlrev_b32 v98, 16, v155
    v_and_b32 v99, s23, v155
    v_lshlrev_b32 v28, 16, v156
    v_and_b32 v29, s23, v156
    v_lshlrev_b32 v30, 16, v157
    v_and_b32 v31, s23, v157
    v_lshlrev_b32 v32, 16, v158
    v_and_b32 v33, s23, v158
    v_lshlrev_b32 v34, 16, v159
    v_and_b32 v35, s23, v159
    v_pk_mul_f32 v[84:85], v[84:85], v[76:77]
    v_pk_mul_f32 v[86:87], v[86:87], v[78:79]
    v_pk_mul_f32 v[88:89], v[88:89], v[80:81]
    v_pk_mul_f32 v[90:91], v[90:91], v[82:83]
    v_pk_mul_f32 v[92:93], v[92:93], v[76:77]
    v_pk_mul_f32 v[94:95], v[94:95], v[78:79]
    v_pk_mul_f32 v[96:97], v[96:97], v[80:81]
    v_pk_mul_f32 v[98:99], v[98:99], v[82:83]
    v_pk_mul_f32 v[28:29], v[28:29], v[76:77]
    v_pk_mul_f32 v[30:31], v[30:31], v[78:79]
    v_pk_mul_f32 v[32:33], v[32:33], v[80:81]
    v_pk_mul_f32 v[34:35], v[34:35], v[82:83]
    v_cvt_pk_bf16_f32 v148, v84, v85
    v_cvt_pk_bf16_f32 v149, v86, v87
    v_cvt_pk_bf16_f32 v150, v88, v89
    v_cvt_pk_bf16_f32 v151, v90, v91
    v_cvt_pk_bf16_f32 v152, v92, v93
    v_cvt_pk_bf16_f32 v153, v94, v95
    v_cvt_pk_bf16_f32 v154, v96, v97
    v_cvt_pk_bf16_f32 v155, v98, v99
    v_cvt_pk_bf16_f32 v156, v28, v29
    v_cvt_pk_bf16_f32 v157, v30, v31
    v_cvt_pk_bf16_f32 v158, v32, v33
    v_cvt_pk_bf16_f32 v159, v34, v35
    v_and_b32 v32, 0xffff0000, v116
    v_sub_f32 v116, v116, v32
    v_and_b32 v34, 0xffff0000, v116
    v_sub_f32 v116, v116, v34
    v_lshrrev_b32 v32, 16, v32
    v_or_b32 v32, v32, v34
    v_lshrrev_b32 v116, 16, v116
    v_cndmask_b32 v36, v36, v32, s[54:55]
    v_cndmask_b32 v37, v37, v116, s[54:55]
    v_and_b32 v32, 0xffff0000, v120
    v_sub_f32 v120, v120, v32
    v_and_b32 v34, 0xffff0000, v120
    v_sub_f32 v120, v120, v34
    v_lshrrev_b32 v32, 16, v32
    v_or_b32 v32, v32, v34
    v_lshrrev_b32 v120, 16, v120
    v_cndmask_b32 v40, v40, v32, s[18:19]
    v_cndmask_b32 v41, v41, v120, s[18:19]
    v_and_b32 v32, 0xffff0000, v124
    v_sub_f32 v124, v124, v32
    v_and_b32 v34, 0xffff0000, v124
    v_sub_f32 v124, v124, v34
    v_lshrrev_b32 v32, 16, v32
    v_or_b32 v32, v32, v34
    v_lshrrev_b32 v124, 16, v124
    v_cndmask_b32 v44, v44, v32, s[14:15]
    v_cndmask_b32 v45, v45, v124, s[14:15]
    s_waitcnt vmcnt(0)
    ds_read_b128 v[56:59], v3 offset:12544
    ds_read_b128 v[60:63], v4 offset:12544
    ds_read_b128 v[64:67], v5 offset:12544
.p2align 6
L3_loop:
    s_waitcnt lgkmcnt(2)
    v_mfma_f32_32x32x16_bf16 v[84:99], a[48:51], v[56:59], 0
    s_waitcnt vmcnt(13)
    s_barrier
    ds_read_b128 v[56:59], v6 offset:12544
    v_rcp_f32 v21, v21
    v_mul_f32 v22, v22, v111
    v_exp_f32_e64 v22, -v22
    s_waitcnt lgkmcnt(2)
    v_mfma_f32_32x32x16_bf16 v[84:99], a[52:55], v[60:63], v[84:99]
    s_waitcnt lgkmcnt(1)
    s_mov_b32 m0, s49
    ds_read_b128 v[60:63], v3 offset:12672
    v_cvt_pk_bf16_f32 v28, v116, v117
    v_cvt_pk_bf16_f32 v29, v118, v119
    v_mul_f32 v110, v110, v21
    v_add_f32 v22, 1.0, v22
    v_mul_f32 v112, v112, v27
    v_mfma_f32_32x32x16_bf16 v[84:99], a[56:59], v[64:67], v[84:99]
    s_waitcnt lgkmcnt(1)
    ds_read_b128 v[64:67], v4 offset:12672
    buffer_load_dwordx4 v10, s[24:27], s44 offen offset:0 lds
    v_cvt_pk_bf16_f32 v30, v120, v121
    v_rcp_f32 v22, v22
    v_mfma_f32_32x32x16_bf16 v[84:99], a[60:63], v[56:59], v[84:99]
    s_waitcnt lgkmcnt(1)
    ds_read_b128 v[68:71], v7 offset:0
    ds_read_b128 v[56:59], v5 offset:12672
    v_cvt_pk_bf16_f32 v31, v122, v123
    v_cvt_pk_bf16_f32 v32, v124, v125
    v_mul_f32 v111, v111, v22
    v_cvt_pk_bf16_f32 v53, v110, v111
    v_mfma_f32_32x32x16_bf16 v[84:99], a[64:67], v[60:63], v[84:99]
    s_waitcnt lgkmcnt(2)
    ds_read_b128 v[72:75], v8 offset:0
    ds_read_b128 v[60:63], v6 offset:12672
    v_cvt_pk_bf16_f32 v33, v126, v127
    v_fmaak_f32 v24, v112, v112, 0x409d30fc
    v_mul_f32 v24, v24, v112
    v_mul_f32 v113, v113, v27
    v_mfma_f32_32x32x16_bf16 v[84:99], a[68:71], v[64:67], v[84:99]
    s_waitcnt lgkmcnt(2)
    ds_read_b128 v[76:79], v9 offset:0
    ds_read_b128 v[64:67], v3 offset:12800
    v_exp_f32_e64 v24, -v24
    v_fmaak_f32 v25, v113, v113, 0x409d30fc
    v_add_f32 v24, 1.0, v24
    v_mfma_f32_32x32x16_bf16 v[84:99], a[72:75], v[56:59], v[84:99]
    s_waitcnt lgkmcnt(2)
    ds_read_b128 v[80:83], v1 offset:0
    ds_read_b128 v[56:59], v4 offset:12800
    v_rcp_f32 v24, v24
    v_mul_f32 v25, v25, v113
    v_mul_f32 v112, v112, v24
    v_mfma_f32_32x32x16_bf16 v[84:99], a[76:79], v[60:63], v[84:99]
    ds_read_b128 v[60:63], v5 offset:12800
    v_exp_f32_e64 v25, -v25
    v_mul_f32 v114, v114, v27
    v_add_f32 v25, 1.0, v25
    v_fmaak_f32 v21, v114, v114, 0x409d30fc
    v_mfma_f32_16x16x32_bf16 v[116:119], v[36:39], v[68:71], 0
    s_waitcnt lgkmcnt(3)
    v_rcp_f32 v25, v25
    v_mfma_f32_32x32x16_bf16 v[84:99], a[80:83], v[64:67], v[84:99]
    ds_read_b128 v[68:71], v1 offset:1024
    ds_read_b128 v[64:67], v6 offset:12800
    buffer_load_dwordx4 v11, s[24:27], s44 offen offset:1024 lds
    v_mul_f32 v113, v113, v25
    v_cvt_pk_bf16_f32 v54, v112, v113
    v_mfma_f32_16x16x32_bf16 v[120:123], v[40:43], v[72:75], 0
    s_waitcnt lgkmcnt(3)
    v_mul_f32 v21, v21, v114
    v_mul_f32 v115, v115, v27
    v_mfma_f32_32x32x16_bf16 v[84:99], a[84:87], v[56:59], v[84:99]
    ds_read_b128 v[72:75], v1 offset:2048
    buffer_load_dwordx4 v12, s[24:27], s44 offen offset:2048 lds
    v_exp_f32_e64 v21, -v21
    v_fmaak_f32 v22, v115, v115, 0x409d30fc
    v_mfma_f32_16x16x32_bf16 v[124:127], v[44:47], v[76:79], 0
    s_waitcnt lgkmcnt(3)
    s_sub_u32 s44, s44, 12288
    v_add_f32 v21, 1.0, v21
    v_mul_f32 v22, v22, v115
    v_mfma_f32_32x32x16_bf16 v[84:99], a[88:91], v[60:63], v[84:99]
    s_waitcnt lgkmcnt(1)
    s_min_u32 s44, s44, 0x40000000
    ds_read_b128 v[76:79], v1 offset:3072
    v_rcp_f32 v21, v21
    v_exp_f32_e64 v22, -v22
    v_mul_f32 v114, v114, v21
    v_mfma_f32_32x32x16_bf16 v[84:99], a[92:95], v[64:67], v[84:99]
    s_add_u32 s49, s49, s52
    ds_write_b128 v14, v[48:51] offset:16384
    v_add_f32 v22, 1.0, v22
    v_mfma_f32_16x16x32_bf16 v[116:119], a[96:99], v[80:83], v[116:119]
    s_add_u32 m0, s48, 49152
    v_add_u32 v3, s50, v3
    v_rcp_f32 v22, v22
    v_mfma_f32_16x16x32_bf16 v[116:119], a[108:111], v[68:71], v[116:119]
    v_add_u32 v4, s50, v4
    v_mul_f32 v115, v115, v22
    v_cvt_pk_bf16_f32 v55, v114, v115
    v_mfma_f32_16x16x32_bf16 v[120:123], a[100:103], v[80:83], v[120:123]
    ds_write_b128 v14, v[52:55] offset:16896
    v_mfma_f32_16x16x32_bf16 v[120:123], a[112:115], v[68:71], v[120:123]
    buffer_load_dwordx4 v13, s[28:31], s45 offen offset:0 lds
    v_mfma_f32_16x16x32_bf16 v[124:127], a[104:107], v[80:83], v[124:127]
    ds_read_b128 v[80:83], v1 offset:4096
    v_add_u32 v5, s50, v5
    v_add_u32 v6, s50, v6
    v_mfma_f32_16x16x32_bf16 v[124:127], a[116:119], v[68:71], v[124:127]
    s_waitcnt lgkmcnt(4)
    ds_read_b128 v[68:71], v1 offset:5120
    v_mul_f32 v84, v84, v27
    v_fmaak_f32 v24, v84, v84, 0x409d30fc
    v_mfma_f32_16x16x32_bf16 v[116:119], a[120:123], v[72:75], v[116:119]
    s_waitcnt lgkmcnt(4)
    v_mul_f32 v24, v24, v84
    v_mul_f32 v85, v85, v27
    v_mfma_f32_16x16x32_bf16 v[116:119], a[132:135], v[76:79], v[116:119]
    ds_write_b64 v15, v[28:29] offset:6400
    v_mfma_f32_16x16x32_bf16 v[120:123], a[124:127], v[72:75], v[120:123]
    v_exp_f32_e64 v24, -v24
    v_mfma_f32_16x16x32_bf16 v[120:123], a[136:139], v[76:79], v[120:123]
    v_add_f32 v24, 1.0, v24
    v_fmaak_f32 v25, v85, v85, 0x409d30fc
    v_mfma_f32_16x16x32_bf16 v[124:127], a[128:131], v[72:75], v[124:127]
    ds_read_b128 v[72:75], v1 offset:6144
    v_mul_f32 v25, v25, v85
    v_mfma_f32_16x16x32_bf16 v[124:127], a[140:143], v[76:79], v[124:127]
    s_waitcnt lgkmcnt(3)
    ds_read_b128 v[76:79], v1 offset:7168
    v_mul_f32 v86, v86, v27
    v_mfma_f32_16x16x32_bf16 v[116:119], a[144:147], v[80:83], v[116:119]
    s_waitcnt lgkmcnt(3)
    v_rcp_f32 v24, v24
    v_mfma_f32_16x16x32_bf16 v[116:119], a[156:159], v[68:71], v[116:119]
    ds_write_b64 v15, v[30:31] offset:6432
    v_mfma_f32_16x16x32_bf16 v[120:123], a[148:151], v[80:83], v[120:123]
    buffer_load_dwordx4 v13, s[28:31], s45 offen offset:1024 lds
    v_mfma_f32_16x16x32_bf16 v[120:123], a[160:163], v[68:71], v[120:123]
    v_exp_f32_e64 v25, -v25
    v_mfma_f32_16x16x32_bf16 v[124:127], a[152:155], v[80:83], v[124:127]
    ds_read_b128 v[80:83], v1 offset:8192
    v_mul_f32 v84, v84, v24
    v_mfma_f32_16x16x32_bf16 v[124:127], a[164:167], v[68:71], v[124:127]
    s_waitcnt lgkmcnt(3)
    ds_read_b128 v[68:71], v1 offset:9216
    v_add_f32 v25, 1.0, v25
    v_mfma_f32_16x16x32_bf16 v[116:119], a[168:171], v[72:75], v[116:119]
    s_waitcnt lgkmcnt(3)
    v_rcp_f32 v25, v25
    v_mfma_f32_16x16x32_bf16 v[116:119], a[180:183], v[76:79], v[116:119]
    ds_write_b64 v15, v[32:33] offset:6464
    v_mfma_f32_16x16x32_bf16 v[120:123], a[172:175], v[72:75], v[120:123]
    v_mul_f32 v85, v85, v25
    v_cvt_pk_bf16_f32 v48, v84, v85
    v_mfma_f32_16x16x32_bf16 v[120:123], a[184:187], v[76:79], v[120:123]
    v_fmaak_f32 v21, v86, v86, 0x409d30fc
    v_mul_f32 v21, v21, v86
    v_mfma_f32_16x16x32_bf16 v[124:127], a[176:179], v[72:75], v[124:127]
    ds_read_b128 v[72:75], v1 offset:10240
    v_mul_f32 v87, v87, v27
    v_mfma_f32_16x16x32_bf16 v[124:127], a[188:191], v[76:79], v[124:127]
    s_waitcnt lgkmcnt(3)
    ds_read_b128 v[76:79], v1 offset:11264
    v_fmaak_f32 v22, v87, v87, 0x409d30fc
    v_mfma_f32_16x16x32_bf16 v[116:119], a[192:195], v[80:83], v[116:119]
    s_waitcnt lgkmcnt(3)
    v_exp_f32_e64 v21, -v21
    v_mfma_f32_16x16x32_bf16 v[116:119], a[204:207], v[68:71], v[116:119]
    ds_read_b128 v[28:31], v16 offset:0
    v_add_f32 v21, 1.0, v21
    v_mfma_f32_16x16x32_bf16 v[120:123], a[196:199], v[80:83], v[120:123]
    buffer_load_dwordx4 v13, s[28:31], s45 offen offset:2048 lds
    v_mfma_f32_16x16x32_bf16 v[120:123], a[208:211], v[68:71], v[120:123]
    v_rcp_f32 v21, v21
    v_mfma_f32_16x16x32_bf16 v[124:127], a[200:203], v[80:83], v[124:127]
    ds_read_b128 v[80:83], v1 offset:12288
    ds_read_b128 v[32:35], v17 offset:0
    v_mfma_f32_16x16x32_bf16 v[124:127], a[212:215], v[68:71], v[124:127]
    s_waitcnt lgkmcnt(4)
    ds_read_b128 v[68:71], v1 offset:13312
    v_mul_f32 v86, v86, v21
    v_mfma_f32_16x16x32_bf16 v[116:119], a[216:219], v[72:75], v[116:119]
    s_waitcnt lgkmcnt(4)
    v_mul_f32 v22, v22, v87
    v_mul_f32 v88, v88, v27
    v_mfma_f32_16x16x32_bf16 v[116:119], a[228:231], v[76:79], v[116:119]
    v_exp_f32_e64 v22, -v22
    v_mfma_f32_16x16x32_bf16 v[120:123], a[220:223], v[72:75], v[120:123]
    v_add_f32 v22, 1.0, v22
    v_fmaak_f32 v24, v88, v88, 0x409d30fc
    v_mfma_f32_16x16x32_bf16 v[120:123], a[232:235], v[76:79], v[120:123]
    v_rcp_f32 v22, v22
    v_mfma_f32_16x16x32_bf16 v[124:127], a[224:227], v[72:75], v[124:127]
    ds_read_b128 v[72:75], v1 offset:14336
    v_mul_f32 v87, v87, v22
    v_mfma_f32_16x16x32_bf16 v[124:127], a[236:239], v[76:79], v[124:127]
    s_waitcnt lgkmcnt(3)
    ds_read_b128 v[76:79], v1 offset:15360
    v_cvt_pk_bf16_f32 v49, v86, v87
    v_mfma_f32_16x16x32_bf16 v[116:119], a[240:243], v[80:83], v[116:119]
    s_waitcnt lgkmcnt(2)
    v_mul_f32 v24, v24, v88
    v_mul_f32 v89, v89, v27
    v_mfma_f32_16x16x32_bf16 v[116:119], a[252:255], v[68:71], v[116:119]
    v_exp_f32_e64 v24, -v24
    v_mfma_f32_16x16x32_bf16 v[120:123], a[244:247], v[80:83], v[120:123]
    buffer_load_dwordx4 v13, s[28:31], s45 offen offset:3072 lds
    v_mfma_f32_16x16x32_bf16 v[120:123], v[160:163], v[68:71], v[120:123]
    v_add_f32 v24, 1.0, v24
    v_fmaak_f32 v25, v89, v89, 0x409d30fc
    v_mfma_f32_16x16x32_bf16 v[124:127], a[248:251], v[80:83], v[124:127]
    ds_read_b128 v[80:83], v2 offset:0
    v_mul_f32 v25, v25, v89
    v_mfma_f32_16x16x32_bf16 v[124:127], v[164:167], v[68:71], v[124:127]
    s_waitcnt lgkmcnt(2)
    ds_read_b128 v[68:71], v2 offset:1024
    v_mul_f32 v90, v90, v27
    v_mfma_f32_16x16x32_bf16 v[116:119], v[168:171], v[72:75], v[116:119]
    s_waitcnt lgkmcnt(2)
    buffer_store_dwordx4 v[28:31], v18, s[40:43], s46 offen nt
    v_mfma_f32_16x16x32_bf16 v[116:119], v[180:183], v[76:79], v[116:119]
    v_rcp_f32 v24, v24
    v_mfma_f32_16x16x32_bf16 v[120:123], v[172:175], v[72:75], v[120:123]
    s_sub_u32 s45, s45, 49152
    v_exp_f32_e64 v25, -v25
    v_mfma_f32_16x16x32_bf16 v[120:123], v[184:187], v[76:79], v[120:123]
    s_min_u32 s45, s45, 0x40000000
    v_mul_f32 v88, v88, v24
    v_add_f32 v25, 1.0, v25
    v_mfma_f32_16x16x32_bf16 v[124:127], v[176:179], v[72:75], v[124:127]
    ds_read_b128 v[72:75], v2 offset:2048
    v_fmaak_f32 v21, v90, v90, 0x409d30fc
    v_mfma_f32_16x16x32_bf16 v[124:127], v[188:191], v[76:79], v[124:127]
    s_waitcnt lgkmcnt(2)
    ds_read_b128 v[76:79], v2 offset:3072
    v_mul_f32 v21, v21, v90
    v_mfma_f32_16x16x32_bf16 v[116:119], v[192:195], v[80:83], v[116:119]
    s_waitcnt lgkmcnt(2)
    v_rcp_f32 v25, v25
    v_mfma_f32_16x16x32_bf16 v[116:119], v[204:207], v[68:71], v[116:119]
    v_exp_f32_e64 v21, -v21
    v_mfma_f32_16x16x32_bf16 v[120:123], v[196:199], v[80:83], v[120:123]
    v_mul_f32 v89, v89, v25
    v_cvt_pk_bf16_f32 v50, v88, v89
    v_mfma_f32_16x16x32_bf16 v[120:123], v[208:211], v[68:71], v[120:123]
    v_add_f32 v21, 1.0, v21
    v_mul_f32 v91, v91, v27
    v_mfma_f32_16x16x32_bf16 v[124:127], v[200:203], v[80:83], v[124:127]
    ds_read_b128 v[80:83], v2 offset:4096
    v_fmaak_f32 v22, v91, v91, 0x409d30fc
    v_mfma_f32_16x16x32_bf16 v[124:127], v[212:215], v[68:71], v[124:127]
    s_waitcnt lgkmcnt(2)
    ds_read_b128 v[68:71], v2 offset:5120
    v_mul_f32 v22, v22, v91
    v_mfma_f32_16x16x32_bf16 v[116:119], v[216:219], v[72:75], v[116:119]
    s_waitcnt lgkmcnt(2)
    buffer_store_dwordx4 v[32:35], v19, s[40:43], s46 offen nt
    v_mfma_f32_16x16x32_bf16 v[116:119], v[228:231], v[76:79], v[116:119]
    v_rcp_f32 v21, v21
    v_mfma_f32_16x16x32_bf16 v[120:123], v[220:223], v[72:75], v[120:123]
    v_exp_f32_e64 v22, -v22
    v_mfma_f32_16x16x32_bf16 v[120:123], v[232:235], v[76:79], v[120:123]
    v_mul_f32 v90, v90, v21
    v_add_f32 v22, 1.0, v22
    v_mfma_f32_16x16x32_bf16 v[124:127], v[224:227], v[72:75], v[124:127]
    ds_read_b128 v[72:75], v2 offset:6144
    v_mul_f32 v92, v92, v27
    v_mfma_f32_16x16x32_bf16 v[124:127], v[236:239], v[76:79], v[124:127]
    s_waitcnt lgkmcnt(2)
    ds_read_b128 v[76:79], v2 offset:7168
    v_fmaak_f32 v24, v92, v92, 0x409d30fc
    v_mfma_f32_16x16x32_bf16 v[116:119], v[240:243], v[80:83], v[116:119]
    s_waitcnt lgkmcnt(2)
    v_rcp_f32 v22, v22
    v_mfma_f32_16x16x32_bf16 v[116:119], v[252:255], v[68:71], v[116:119]
    v_mul_f32 v91, v91, v22
    v_cvt_pk_bf16_f32 v51, v90, v91
    v_mfma_f32_16x16x32_bf16 v[120:123], v[244:247], v[80:83], v[120:123]
    v_mul_f32 v24, v24, v92
    v_mul_f32 v93, v93, v27
    v_mfma_f32_16x16x32_bf16 v[120:123], v[128:131], v[68:71], v[120:123]
    v_exp_f32_e64 v24, -v24
    v_mfma_f32_16x16x32_bf16 v[124:127], v[248:251], v[80:83], v[124:127]
    ds_read_b128 v[56:59], v3 offset:0
    v_add_f32 v24, 1.0, v24
    v_mfma_f32_16x16x32_bf16 v[124:127], v[132:135], v[68:71], v[124:127]
    s_waitcnt lgkmcnt(2)
    s_add_u32 s46, s46, 6144
    v_rcp_f32 v24, v24
    v_mfma_f32_16x16x32_bf16 v[116:119], v[136:139], v[72:75], v[116:119]
    s_waitcnt lgkmcnt(1)
    ds_read_b128 v[60:63], v4 offset:0
    v_mul_f32 v92, v92, v24
    v_mfma_f32_16x16x32_bf16 v[116:119], v[148:151], v[76:79], v[116:119]
    v_fmaak_f32 v25, v93, v93, 0x409d30fc
    v_mul_f32 v25, v25, v93
    v_mfma_f32_16x16x32_bf16 v[120:123], v[140:143], v[72:75], v[120:123]
    ds_read_b128 v[64:67], v5 offset:0
    v_mul_f32 v94, v94, v27
    v_mfma_f32_16x16x32_bf16 v[120:123], v[152:155], v[76:79], v[120:123]
    v_exp_f32_e64 v25, -v25
    v_mfma_f32_16x16x32_bf16 v[124:127], v[144:147], v[72:75], v[124:127]
    v_add_f32 v25, 1.0, v25
    v_fmaak_f32 v21, v94, v94, 0x409d30fc
    v_mfma_f32_16x16x32_bf16 v[124:127], v[156:159], v[76:79], v[124:127]
    s_waitcnt lgkmcnt(2)
    v_rcp_f32 v25, v25
    v_mfma_f32_32x32x16_bf16 v[100:115], a[0:3], v[56:59], 0
    s_waitcnt vmcnt(18)
    s_barrier
    ds_read_b128 v[56:59], v6 offset:0
    v_mul_f32 v93, v93, v25
    v_cvt_pk_bf16_f32 v52, v92, v93
    v_mul_f32 v21, v21, v94
    v_exp_f32_e64 v21, -v21
    s_waitcnt lgkmcnt(2)
    v_mfma_f32_32x32x16_bf16 v[100:115], a[4:7], v[60:63], v[100:115]
    s_waitcnt lgkmcnt(1)
    ds_read_b128 v[60:63], v3 offset:128
    v_cvt_pk_bf16_f32 v28, v116, v117
    v_cvt_pk_bf16_f32 v29, v118, v119
    v_add_f32 v21, 1.0, v21
    v_rcp_f32 v21, v21
    v_mfma_f32_32x32x16_bf16 v[100:115], a[8:11], v[64:67], v[100:115]
    s_waitcnt lgkmcnt(1)
    ds_read_b128 v[64:67], v4 offset:128
    v_cvt_pk_bf16_f32 v30, v120, v121
    v_mul_f32 v94, v94, v21
    v_mul_f32 v95, v95, v27
    v_fmaak_f32 v22, v95, v95, 0x409d30fc
    v_mul_f32 v22, v22, v95
    v_mfma_f32_32x32x16_bf16 v[100:115], a[12:15], v[56:59], v[100:115]
    s_waitcnt lgkmcnt(1)
    ds_read_b128 v[68:71], v7 offset:6272
    ds_read_b128 v[56:59], v5 offset:128
    v_cvt_pk_bf16_f32 v31, v122, v123
    v_cvt_pk_bf16_f32 v32, v124, v125
    v_exp_f32_e64 v22, -v22
    v_mfma_f32_32x32x16_bf16 v[100:115], a[16:19], v[60:63], v[100:115]
    s_waitcnt lgkmcnt(2)
    ds_read_b128 v[72:75], v8 offset:6272
    ds_read_b128 v[60:63], v6 offset:128
    v_cvt_pk_bf16_f32 v33, v126, v127
    v_add_f32 v22, 1.0, v22
    v_rcp_f32 v22, v22
    v_mfma_f32_32x32x16_bf16 v[100:115], a[20:23], v[64:67], v[100:115]
    s_waitcnt lgkmcnt(2)
    ds_read_b128 v[76:79], v9 offset:6272
    ds_read_b128 v[64:67], v3 offset:256
    v_mul_f32 v95, v95, v22
    v_cvt_pk_bf16_f32 v53, v94, v95
    v_mul_f32 v96, v96, v27
    v_fmaak_f32 v24, v96, v96, 0x409d30fc
    v_mfma_f32_32x32x16_bf16 v[100:115], a[24:27], v[56:59], v[100:115]
    s_waitcnt lgkmcnt(2)
    ds_read_b128 v[80:83], v1 offset:16384
    ds_read_b128 v[56:59], v4 offset:256
    v_mul_f32 v24, v24, v96
    v_exp_f32_e64 v24, -v24
    v_mul_f32 v97, v97, v27
    v_mfma_f32_32x32x16_bf16 v[100:115], a[28:31], v[60:63], v[100:115]
    ds_read_b128 v[60:63], v5 offset:256
    v_add_f32 v24, 1.0, v24
    v_rcp_f32 v24, v24
    v_fmaak_f32 v25, v97, v97, 0x409d30fc
    v_mul_f32 v96, v96, v24
    v_mfma_f32_16x16x32_bf16 v[116:119], v[36:39], v[68:71], 0
    s_waitcnt lgkmcnt(3)
    v_mul_f32 v25, v25, v97
    v_mul_f32 v98, v98, v27
    v_mfma_f32_32x32x16_bf16 v[100:115], a[32:35], v[64:67], v[100:115]
    ds_read_b128 v[68:71], v1 offset:17408
    ds_read_b128 v[64:67], v6 offset:256
    v_exp_f32_e64 v25, -v25
    v_fmaak_f32 v21, v98, v98, 0x409d30fc
    v_add_f32 v25, 1.0, v25
    v_mfma_f32_16x16x32_bf16 v[120:123], v[40:43], v[72:75], 0
    s_waitcnt lgkmcnt(3)
    v_rcp_f32 v25, v25
    v_mfma_f32_32x32x16_bf16 v[100:115], a[36:39], v[56:59], v[100:115]
    ds_read_b128 v[72:75], v1 offset:18432
    v_mul_f32 v97, v97, v25
    v_cvt_pk_bf16_f32 v54, v96, v97
    v_mul_f32 v21, v21, v98
    v_exp_f32_e64 v21, -v21
    v_mfma_f32_16x16x32_bf16 v[124:127], v[44:47], v[76:79], 0
    s_waitcnt lgkmcnt(3)
    v_add_f32 v21, 1.0, v21
    v_mul_f32 v99, v99, v27
    v_mfma_f32_32x32x16_bf16 v[100:115], a[40:43], v[60:63], v[100:115]
    s_waitcnt lgkmcnt(1)
    ds_read_b128 v[76:79], v1 offset:19456
    v_rcp_f32 v21, v21
    v_fmaak_f32 v22, v99, v99, 0x409d30fc
    v_mul_f32 v98, v98, v21
    v_mul_f32 v22, v22, v99
    v_mfma_f32_32x32x16_bf16 v[100:115], a[44:47], v[64:67], v[100:115]
    ds_write_b128 v14, v[48:51] offset:17408
    v_exp_f32_e64 v22, -v22
    v_mfma_f32_16x16x32_bf16 v[116:119], a[96:99], v[80:83], v[116:119]
    s_add_u32 m0, s48, 0
    v_add_f32 v22, 1.0, v22
    v_rcp_f32 v22, v22
    v_mfma_f32_16x16x32_bf16 v[116:119], a[108:111], v[68:71], v[116:119]
    v_mul_f32 v99, v99, v22
    v_cvt_pk_bf16_f32 v55, v98, v99
    v_mfma_f32_16x16x32_bf16 v[120:123], a[100:103], v[80:83], v[120:123]
    ds_write_b128 v14, v[52:55] offset:17920
    v_mfma_f32_16x16x32_bf16 v[120:123], a[112:115], v[68:71], v[120:123]
    buffer_load_dwordx4 v13, s[28:31], s45 offen offset:0 lds
    v_mfma_f32_16x16x32_bf16 v[124:127], a[104:107], v[80:83], v[124:127]
    ds_read_b128 v[80:83], v1 offset:20480
    v_mfma_f32_16x16x32_bf16 v[124:127], a[116:119], v[68:71], v[124:127]
    s_waitcnt vmcnt(11) lgkmcnt(4)
    ds_read_b128 v[68:71], v1 offset:21504
    v_mul_f32 v100, v100, v26
    v_fmaak_f32 v24, v100, v100, 0x409d30fc
    v_mul_f32 v24, v24, v100
    v_mul_f32 v101, v101, v26
    v_fmaak_f32 v25, v101, v101, 0x409d30fc
    v_mul_f32 v25, v25, v101
    v_mul_f32 v102, v102, v26
    v_fmaak_f32 v21, v102, v102, 0x409d30fc
    v_mul_f32 v21, v21, v102
    v_mul_f32 v103, v103, v26
    v_fmaak_f32 v22, v103, v103, 0x409d30fc
    v_mfma_f32_16x16x32_bf16 v[116:119], a[120:123], v[72:75], v[116:119]
    s_waitcnt lgkmcnt(4)
    v_exp_f32_e64 v24, -v24
    v_mfma_f32_16x16x32_bf16 v[116:119], a[132:135], v[76:79], v[116:119]
    ds_write_b64 v15, v[28:29] offset:0
    v_mfma_f32_16x16x32_bf16 v[120:123], a[124:127], v[72:75], v[120:123]
    v_exp_f32_e64 v25, -v25
    v_mfma_f32_16x16x32_bf16 v[120:123], a[136:139], v[76:79], v[120:123]
    v_exp_f32_e64 v21, -v21
    v_mfma_f32_16x16x32_bf16 v[124:127], a[128:131], v[72:75], v[124:127]
    ds_read_b128 v[72:75], v1 offset:22528
    v_add_f32 v24, 1.0, v24
    v_mfma_f32_16x16x32_bf16 v[124:127], a[140:143], v[76:79], v[124:127]
    s_waitcnt lgkmcnt(3)
    ds_read_b128 v[76:79], v1 offset:23552
    v_add_f32 v25, 1.0, v25
    v_mfma_f32_16x16x32_bf16 v[116:119], a[144:147], v[80:83], v[116:119]
    s_waitcnt lgkmcnt(3)
    v_rcp_f32 v24, v24
    v_mfma_f32_16x16x32_bf16 v[116:119], a[156:159], v[68:71], v[116:119]
    ds_write_b64 v15, v[30:31] offset:32
    v_mfma_f32_16x16x32_bf16 v[120:123], a[148:151], v[80:83], v[120:123]
    buffer_load_dwordx4 v13, s[28:31], s45 offen offset:1024 lds
    v_mfma_f32_16x16x32_bf16 v[120:123], a[160:163], v[68:71], v[120:123]
    v_rcp_f32 v25, v25
    v_mfma_f32_16x16x32_bf16 v[124:127], a[152:155], v[80:83], v[124:127]
    ds_read_b128 v[80:83], v1 offset:24576
    v_mul_f32 v100, v100, v24
    v_mfma_f32_16x16x32_bf16 v[124:127], a[164:167], v[68:71], v[124:127]
    s_waitcnt lgkmcnt(3)
    ds_read_b128 v[68:71], v1 offset:25600
    v_mul_f32 v101, v101, v25
    v_mfma_f32_16x16x32_bf16 v[116:119], a[168:171], v[72:75], v[116:119]
    s_waitcnt lgkmcnt(3)
    v_cvt_pk_bf16_f32 v48, v100, v101
    v_add_f32 v21, 1.0, v21
    v_mfma_f32_16x16x32_bf16 v[116:119], a[180:183], v[76:79], v[116:119]
    ds_write_b64 v15, v[32:33] offset:64
    v_mfma_f32_16x16x32_bf16 v[120:123], a[172:175], v[72:75], v[120:123]
    v_rcp_f32 v21, v21
    v_mfma_f32_16x16x32_bf16 v[120:123], a[184:187], v[76:79], v[120:123]
    v_mul_f32 v102, v102, v21
    v_mul_f32 v22, v22, v103
    v_mfma_f32_16x16x32_bf16 v[124:127], a[176:179], v[72:75], v[124:127]
    ds_read_b128 v[72:75], v1 offset:26624
    v_mul_f32 v104, v104, v26
    v_mfma_f32_16x16x32_bf16 v[124:127], a[188:191], v[76:79], v[124:127]
    s_waitcnt lgkmcnt(3)
    ds_read_b128 v[76:79], v1 offset:27648
    v_fmaak_f32 v24, v104, v104, 0x409d30fc
    v_mfma_f32_16x16x32_bf16 v[116:119], a[192:195], v[80:83], v[116:119]
    s_waitcnt lgkmcnt(3)
    v_exp_f32_e64 v22, -v22
    v_mfma_f32_16x16x32_bf16 v[116:119], a[204:207], v[68:71], v[116:119]
    ds_read_b128 v[28:31], v16 offset:6400
    v_add_f32 v22, 1.0, v22
    v_mfma_f32_16x16x32_bf16 v[120:123], a[196:199], v[80:83], v[120:123]
    buffer_load_dwordx4 v13, s[28:31], s45 offen offset:2048 lds
    v_mfma_f32_16x16x32_bf16 v[120:123], a[208:211], v[68:71], v[120:123]
    v_rcp_f32 v22, v22
    v_mfma_f32_16x16x32_bf16 v[124:127], a[200:203], v[80:83], v[124:127]
    ds_read_b128 v[80:83], v1 offset:28672
    ds_read_b128 v[32:35], v17 offset:6400
    v_mfma_f32_16x16x32_bf16 v[124:127], a[212:215], v[68:71], v[124:127]
    s_waitcnt lgkmcnt(4)
    ds_read_b128 v[68:71], v1 offset:29696
    v_mul_f32 v103, v103, v22
    v_mfma_f32_16x16x32_bf16 v[116:119], a[216:219], v[72:75], v[116:119]
    s_waitcnt lgkmcnt(4)
    v_cvt_pk_bf16_f32 v49, v102, v103
    v_mul_f32 v24, v24, v104
    v_mfma_f32_16x16x32_bf16 v[116:119], a[228:231], v[76:79], v[116:119]
    v_exp_f32_e64 v24, -v24
    v_mfma_f32_16x16x32_bf16 v[120:123], a[220:223], v[72:75], v[120:123]
    v_add_f32 v24, 1.0, v24
    v_mul_f32 v105, v105, v26
    v_mfma_f32_16x16x32_bf16 v[120:123], a[232:235], v[76:79], v[120:123]
    v_rcp_f32 v24, v24
    v_mfma_f32_16x16x32_bf16 v[124:127], a[224:227], v[72:75], v[124:127]
    ds_read_b128 v[72:75], v1 offset:30720
    v_mul_f32 v104, v104, v24
    v_mfma_f32_16x16x32_bf16 v[124:127], a[236:239], v[76:79], v[124:127]
    s_waitcnt lgkmcnt(3)
    ds_read_b128 v[76:79], v1 offset:31744
    v_fmaak_f32 v25, v105, v105, 0x409d30fc
    v_mfma_f32_16x16x32_bf16 v[116:119], a[240:243], v[80:83], v[116:119]
    s_waitcnt lgkmcnt(2)
    v_mul_f32 v25, v25, v105
    v_mul_f32 v106, v106, v26
    v_mfma_f32_16x16x32_bf16 v[116:119], a[252:255], v[68:71], v[116:119]
    v_exp_f32_e64 v25, -v25
    v_mfma_f32_16x16x32_bf16 v[120:123], a[244:247], v[80:83], v[120:123]
    buffer_load_dwordx4 v13, s[28:31], s45 offen offset:3072 lds
    v_mfma_f32_16x16x32_bf16 v[120:123], v[160:163], v[68:71], v[120:123]
    v_add_f32 v25, 1.0, v25
    v_fmaak_f32 v21, v106, v106, 0x409d30fc
    v_mfma_f32_16x16x32_bf16 v[124:127], a[248:251], v[80:83], v[124:127]
    ds_read_b128 v[80:83], v2 offset:8192
    v_mul_f32 v21, v21, v106
    v_mfma_f32_16x16x32_bf16 v[124:127], v[164:167], v[68:71], v[124:127]
    s_waitcnt lgkmcnt(2)
    ds_read_b128 v[68:71], v2 offset:9216
    v_mul_f32 v107, v107, v26
    v_mfma_f32_16x16x32_bf16 v[116:119], v[168:171], v[72:75], v[116:119]
    s_waitcnt lgkmcnt(2)
    buffer_store_dwordx4 v[28:31], v18, s[40:43], s46 offen nt
    v_mfma_f32_16x16x32_bf16 v[116:119], v[180:183], v[76:79], v[116:119]
    v_rcp_f32 v25, v25
    v_mfma_f32_16x16x32_bf16 v[120:123], v[172:175], v[72:75], v[120:123]
    s_add_u32 s45, s45, 16384
    v_exp_f32_e64 v21, -v21
    v_mfma_f32_16x16x32_bf16 v[120:123], v[184:187], v[76:79], v[120:123]
    v_mul_f32 v105, v105, v25
    v_cvt_pk_bf16_f32 v50, v104, v105
    v_mfma_f32_16x16x32_bf16 v[124:127], v[176:179], v[72:75], v[124:127]
    ds_read_b128 v[72:75], v2 offset:10240
    v_add_f32 v21, 1.0, v21
    v_mfma_f32_16x16x32_bf16 v[124:127], v[188:191], v[76:79], v[124:127]
    s_waitcnt lgkmcnt(2)
    ds_read_b128 v[76:79], v2 offset:11264
    v_fmaak_f32 v22, v107, v107, 0x409d30fc
    v_mfma_f32_16x16x32_bf16 v[116:119], v[192:195], v[80:83], v[116:119]
    s_waitcnt lgkmcnt(2)
    v_rcp_f32 v21, v21
    v_mfma_f32_16x16x32_bf16 v[116:119], v[204:207], v[68:71], v[116:119]
    v_mul_f32 v106, v106, v21
    v_mul_f32 v22, v22, v107
    v_mfma_f32_16x16x32_bf16 v[120:123], v[196:199], v[80:83], v[120:123]
    buffer_load_dword v27, v20, s[32:35], s47 offen
    v_mfma_f32_16x16x32_bf16 v[120:123], v[208:211], v[68:71], v[120:123]
    v_exp_f32_e64 v22, -v22
    v_mfma_f32_16x16x32_bf16 v[124:127], v[200:203], v[80:83], v[124:127]
    ds_read_b128 v[80:83], v2 offset:12288
    v_add_f32 v22, 1.0, v22
    v_mfma_f32_16x16x32_bf16 v[124:127], v[212:215], v[68:71], v[124:127]
    s_waitcnt lgkmcnt(2)
    s_sub_u32 s47, s47, 128
    ds_read_b128 v[68:71], v2 offset:13312
    v_mul_f32 v108, v108, v26
    v_mfma_f32_16x16x32_bf16 v[116:119], v[216:219], v[72:75], v[116:119]
    s_waitcnt lgkmcnt(2)
    s_min_u32 s47, s47, 0x40000000
    buffer_store_dwordx4 v[32:35], v19, s[40:43], s46 offen nt
    v_mfma_f32_16x16x32_bf16 v[116:119], v[228:231], v[76:79], v[116:119]
    v_rcp_f32 v22, v22
    v_mfma_f32_16x16x32_bf16 v[120:123], v[220:223], v[72:75], v[120:123]
    v_mul_f32 v107, v107, v22
    v_cvt_pk_bf16_f32 v51, v106, v107
    v_mfma_f32_16x16x32_bf16 v[120:123], v[232:235], v[76:79], v[120:123]
    v_fmaak_f32 v24, v108, v108, 0x409d30fc
    v_mul_f32 v24, v24, v108
    v_mfma_f32_16x16x32_bf16 v[124:127], v[224:227], v[72:75], v[124:127]
    ds_read_b128 v[72:75], v2 offset:14336
    v_mul_f32 v109, v109, v26
    v_mfma_f32_16x16x32_bf16 v[124:127], v[236:239], v[76:79], v[124:127]
    s_waitcnt lgkmcnt(2)
    ds_read_b128 v[76:79], v2 offset:15360
    v_fmaak_f32 v25, v109, v109, 0x409d30fc
    v_mfma_f32_16x16x32_bf16 v[116:119], v[240:243], v[80:83], v[116:119]
    s_waitcnt lgkmcnt(2)
    v_exp_f32_e64 v24, -v24
    v_mfma_f32_16x16x32_bf16 v[116:119], v[252:255], v[68:71], v[116:119]
    v_add_f32 v24, 1.0, v24
    v_mul_f32 v25, v25, v109
    v_mfma_f32_16x16x32_bf16 v[120:123], v[244:247], v[80:83], v[120:123]
    v_rcp_f32 v24, v24
    v_mfma_f32_16x16x32_bf16 v[120:123], v[128:131], v[68:71], v[120:123]
    v_exp_f32_e64 v25, -v25
    v_mfma_f32_16x16x32_bf16 v[124:127], v[248:251], v[80:83], v[124:127]
    ds_read_b128 v[56:59], v3 offset:0
    v_mul_f32 v108, v108, v24
    v_mfma_f32_16x16x32_bf16 v[124:127], v[132:135], v[68:71], v[124:127]
    s_waitcnt lgkmcnt(2)
    s_sub_u32 s46, s46, 18432
    v_add_f32 v25, 1.0, v25
    v_mul_f32 v110, v110, v26
    v_mfma_f32_16x16x32_bf16 v[116:119], v[136:139], v[72:75], v[116:119]
    s_waitcnt lgkmcnt(1)
    ds_read_b128 v[60:63], v4 offset:0
    v_fmaak_f32 v21, v110, v110, 0x409d30fc
    v_mfma_f32_16x16x32_bf16 v[116:119], v[148:151], v[76:79], v[116:119]
    v_rcp_f32 v25, v25
    v_mfma_f32_16x16x32_bf16 v[120:123], v[140:143], v[72:75], v[120:123]
    ds_read_b128 v[64:67], v5 offset:0
    v_mul_f32 v109, v109, v25
    v_mfma_f32_16x16x32_bf16 v[120:123], v[152:155], v[76:79], v[120:123]
    v_cvt_pk_bf16_f32 v52, v108, v109
    v_mul_f32 v21, v21, v110
    v_mfma_f32_16x16x32_bf16 v[124:127], v[144:147], v[72:75], v[124:127]
    v_exp_f32_e64 v21, -v21
    v_mfma_f32_16x16x32_bf16 v[124:127], v[156:159], v[76:79], v[124:127]
    s_waitcnt lgkmcnt(2)
    v_add_f32 v21, 1.0, v21
    v_mul_f32 v111, v111, v26
    v_mfma_f32_32x32x16_bf16 v[84:99], a[48:51], v[56:59], 0
    s_waitcnt vmcnt(13)
    s_barrier
    ds_read_b128 v[56:59], v6 offset:0
    v_rcp_f32 v21, v21
    v_fmaak_f32 v22, v111, v111, 0x409d30fc
    v_mul_f32 v110, v110, v21
    v_mul_f32 v22, v22, v111
    s_waitcnt lgkmcnt(2)
    v_mfma_f32_32x32x16_bf16 v[84:99], a[52:55], v[60:63], v[84:99]
    s_waitcnt lgkmcnt(1)
    s_mov_b32 m0, s49
    ds_read_b128 v[60:63], v3 offset:128
    v_cvt_pk_bf16_f32 v28, v116, v117
    v_cvt_pk_bf16_f32 v29, v118, v119
    v_exp_f32_e64 v22, -v22
    v_mul_f32 v112, v112, v26
    v_mfma_f32_32x32x16_bf16 v[84:99], a[56:59], v[64:67], v[84:99]
    s_waitcnt lgkmcnt(1)
    ds_read_b128 v[64:67], v4 offset:128
    buffer_load_dwordx4 v10, s[24:27], s44 offen offset:0 lds
    v_cvt_pk_bf16_f32 v30, v120, v121
    v_add_f32 v22, 1.0, v22
    v_fmaak_f32 v24, v112, v112, 0x409d30fc
    v_mfma_f32_32x32x16_bf16 v[84:99], a[60:63], v[56:59], v[84:99]
    s_waitcnt lgkmcnt(1)
    ds_read_b128 v[68:71], v7 offset:12544
    ds_read_b128 v[56:59], v5 offset:128
    v_cvt_pk_bf16_f32 v31, v122, v123
    v_cvt_pk_bf16_f32 v32, v124, v125
    v_rcp_f32 v22, v22
    v_mfma_f32_32x32x16_bf16 v[84:99], a[64:67], v[60:63], v[84:99]
    s_waitcnt lgkmcnt(2)
    ds_read_b128 v[72:75], v8 offset:12544
    ds_read_b128 v[60:63], v6 offset:128
    v_cvt_pk_bf16_f32 v33, v126, v127
    v_mul_f32 v111, v111, v22
    v_cvt_pk_bf16_f32 v53, v110, v111
    v_mul_f32 v24, v24, v112
    v_mfma_f32_32x32x16_bf16 v[84:99], a[68:71], v[64:67], v[84:99]
    s_waitcnt lgkmcnt(2)
    ds_read_b128 v[76:79], v9 offset:12544
    ds_read_b128 v[64:67], v3 offset:256
    v_exp_f32_e64 v24, -v24
    v_mul_f32 v113, v113, v26
    v_add_f32 v24, 1.0, v24
    v_mfma_f32_32x32x16_bf16 v[84:99], a[72:75], v[56:59], v[84:99]
    s_waitcnt lgkmcnt(2)
    ds_read_b128 v[80:83], v1 offset:32768
    ds_read_b128 v[56:59], v4 offset:256
    v_rcp_f32 v24, v24
    v_fmaak_f32 v25, v113, v113, 0x409d30fc
    v_mul_f32 v112, v112, v24
    v_mfma_f32_32x32x16_bf16 v[84:99], a[76:79], v[60:63], v[84:99]
    ds_read_b128 v[60:63], v5 offset:256
    v_mul_f32 v25, v25, v113
    v_exp_f32_e64 v25, -v25
    v_mul_f32 v114, v114, v26
    v_add_f32 v25, 1.0, v25
    v_mfma_f32_16x16x32_bf16 v[116:119], v[36:39], v[68:71], 0
    s_waitcnt lgkmcnt(3)
    v_rcp_f32 v25, v25
    v_mfma_f32_32x32x16_bf16 v[84:99], a[80:83], v[64:67], v[84:99]
    ds_read_b128 v[68:71], v1 offset:33792
    ds_read_b128 v[64:67], v6 offset:256
    buffer_load_dwordx4 v11, s[24:27], s44 offen offset:1024 lds
    v_mul_f32 v113, v113, v25
    v_cvt_pk_bf16_f32 v54, v112, v113
    v_mfma_f32_16x16x32_bf16 v[120:123], v[40:43], v[72:75], 0
    s_waitcnt lgkmcnt(3)
    v_fmaak_f32 v21, v114, v114, 0x409d30fc
    v_mul_f32 v21, v21, v114
    v_mfma_f32_32x32x16_bf16 v[84:99], a[84:87], v[56:59], v[84:99]
    ds_read_b128 v[72:75], v1 offset:34816
    buffer_load_dwordx4 v12, s[24:27], s44 offen offset:2048 lds
    v_exp_f32_e64 v21, -v21
    v_mul_f32 v115, v115, v26
    v_mfma_f32_16x16x32_bf16 v[124:127], v[44:47], v[76:79], 0
    s_waitcnt lgkmcnt(3)
    s_sub_u32 s44, s44, 12288
    v_add_f32 v21, 1.0, v21
    v_fmaak_f32 v22, v115, v115, 0x409d30fc
    v_mfma_f32_32x32x16_bf16 v[84:99], a[88:91], v[60:63], v[84:99]
    s_waitcnt lgkmcnt(1)
    s_min_u32 s44, s44, 0x40000000
    ds_read_b128 v[76:79], v1 offset:35840
    s_mov_b32 s42, 221184
    v_rcp_f32 v21, v21
    v_mul_f32 v22, v22, v115
    v_mul_f32 v114, v114, v21
    v_mfma_f32_32x32x16_bf16 v[84:99], a[92:95], v[64:67], v[84:99]
    s_add_u32 s49, s49, 12544
    ds_write_b128 v14, v[48:51] offset:0
    v_exp_f32_e64 v22, -v22
    v_mfma_f32_16x16x32_bf16 v[116:119], a[96:99], v[80:83], v[116:119]
    s_add_u32 m0, s48, 16384
    v_add_f32 v22, 1.0, v22
    v_rcp_f32 v22, v22
    v_mfma_f32_16x16x32_bf16 v[116:119], a[108:111], v[68:71], v[116:119]
    v_mul_f32 v115, v115, v22
    v_cvt_pk_bf16_f32 v55, v114, v115
    v_mfma_f32_16x16x32_bf16 v[120:123], a[100:103], v[80:83], v[120:123]
    ds_write_b128 v14, v[52:55] offset:512
    v_mfma_f32_16x16x32_bf16 v[120:123], a[112:115], v[68:71], v[120:123]
    buffer_load_dwordx4 v13, s[28:31], s45 offen offset:0 lds
    v_mfma_f32_16x16x32_bf16 v[124:127], a[104:107], v[80:83], v[124:127]
    ds_read_b128 v[80:83], v1 offset:36864
    v_mfma_f32_16x16x32_bf16 v[124:127], a[116:119], v[68:71], v[124:127]
    s_waitcnt lgkmcnt(4)
    ds_read_b128 v[68:71], v1 offset:37888
    v_mul_f32 v84, v84, v26
    v_fmaak_f32 v24, v84, v84, 0x409d30fc
    v_mul_f32 v24, v24, v84
    v_mul_f32 v85, v85, v26
    v_mfma_f32_16x16x32_bf16 v[116:119], a[120:123], v[72:75], v[116:119]
    s_waitcnt lgkmcnt(4)
    v_exp_f32_e64 v24, -v24
    v_mfma_f32_16x16x32_bf16 v[116:119], a[132:135], v[76:79], v[116:119]
    ds_write_b64 v15, v[28:29] offset:6400
    v_mfma_f32_16x16x32_bf16 v[120:123], a[124:127], v[72:75], v[120:123]
    v_add_f32 v24, 1.0, v24
    v_fmaak_f32 v25, v85, v85, 0x409d30fc
    v_mfma_f32_16x16x32_bf16 v[120:123], a[136:139], v[76:79], v[120:123]
    v_rcp_f32 v24, v24
    v_mfma_f32_16x16x32_bf16 v[124:127], a[128:131], v[72:75], v[124:127]
    ds_read_b128 v[72:75], v1 offset:38912
    v_mul_f32 v84, v84, v24
    v_mfma_f32_16x16x32_bf16 v[124:127], a[140:143], v[76:79], v[124:127]
    s_waitcnt lgkmcnt(3)
    ds_read_b128 v[76:79], v1 offset:39936
    v_mul_f32 v25, v25, v85
    v_mfma_f32_16x16x32_bf16 v[116:119], a[144:147], v[80:83], v[116:119]
    s_waitcnt lgkmcnt(3)
    v_exp_f32_e64 v25, -v25
    v_mfma_f32_16x16x32_bf16 v[116:119], a[156:159], v[68:71], v[116:119]
    ds_write_b64 v15, v[30:31] offset:6432
    v_mfma_f32_16x16x32_bf16 v[120:123], a[148:151], v[80:83], v[120:123]
    buffer_load_dwordx4 v13, s[28:31], s45 offen offset:1024 lds
    v_mfma_f32_16x16x32_bf16 v[120:123], a[160:163], v[68:71], v[120:123]
    v_add_f32 v25, 1.0, v25
    v_mul_f32 v86, v86, v26
    v_mfma_f32_16x16x32_bf16 v[124:127], a[152:155], v[80:83], v[124:127]
    ds_read_b128 v[80:83], v1 offset:40960
    v_fmaak_f32 v21, v86, v86, 0x409d30fc
    v_mfma_f32_16x16x32_bf16 v[124:127], a[164:167], v[68:71], v[124:127]
    s_waitcnt lgkmcnt(3)
    ds_read_b128 v[68:71], v1 offset:41984
    v_mul_f32 v21, v21, v86
    v_mfma_f32_16x16x32_bf16 v[116:119], a[168:171], v[72:75], v[116:119]
    s_waitcnt lgkmcnt(3)
    v_rcp_f32 v25, v25
    v_mfma_f32_16x16x32_bf16 v[116:119], a[180:183], v[76:79], v[116:119]
    ds_write_b64 v15, v[32:33] offset:6464
    v_mfma_f32_16x16x32_bf16 v[120:123], a[172:175], v[72:75], v[120:123]
    v_exp_f32_e64 v21, -v21
    v_mfma_f32_16x16x32_bf16 v[120:123], a[184:187], v[76:79], v[120:123]
    v_mul_f32 v85, v85, v25
    v_cvt_pk_bf16_f32 v48, v84, v85
    v_mfma_f32_16x16x32_bf16 v[124:127], a[176:179], v[72:75], v[124:127]
    ds_read_b128 v[72:75], v1 offset:43008
    v_add_f32 v21, 1.0, v21
    v_mfma_f32_16x16x32_bf16 v[124:127], a[188:191], v[76:79], v[124:127]
    s_waitcnt lgkmcnt(3)
    ds_read_b128 v[76:79], v1 offset:44032
    v_mul_f32 v87, v87, v26
    v_mfma_f32_16x16x32_bf16 v[116:119], a[192:195], v[80:83], v[116:119]
    s_waitcnt lgkmcnt(3)
    v_rcp_f32 v21, v21
    v_mfma_f32_16x16x32_bf16 v[116:119], a[204:207], v[68:71], v[116:119]
    ds_read_b128 v[28:31], v16 offset:0
    v_mul_f32 v86, v86, v21
    v_mfma_f32_16x16x32_bf16 v[120:123], a[196:199], v[80:83], v[120:123]
    buffer_load_dwordx4 v13, s[28:31], s45 offen offset:2048 lds
    v_mfma_f32_16x16x32_bf16 v[120:123], a[208:211], v[68:71], v[120:123]
    v_fmaak_f32 v22, v87, v87, 0x409d30fc
    v_mul_f32 v22, v22, v87
    v_mfma_f32_16x16x32_bf16 v[124:127], a[200:203], v[80:83], v[124:127]
    ds_read_b128 v[80:83], v1 offset:45056
    ds_read_b128 v[32:35], v17 offset:0
    v_mfma_f32_16x16x32_bf16 v[124:127], a[212:215], v[68:71], v[124:127]
    s_waitcnt lgkmcnt(4)
    ds_read_b128 v[68:71], v1 offset:46080
    v_mul_f32 v88, v88, v26
    v_mfma_f32_16x16x32_bf16 v[116:119], a[216:219], v[72:75], v[116:119]
    s_waitcnt lgkmcnt(4)
    v_exp_f32_e64 v22, -v22
    v_mfma_f32_16x16x32_bf16 v[116:119], a[228:231], v[76:79], v[116:119]
    v_add_f32 v22, 1.0, v22
    v_fmaak_f32 v24, v88, v88, 0x409d30fc
    v_mfma_f32_16x16x32_bf16 v[120:123], a[220:223], v[72:75], v[120:123]
    v_rcp_f32 v22, v22
    v_mfma_f32_16x16x32_bf16 v[120:123], a[232:235], v[76:79], v[120:123]
    v_mul_f32 v87, v87, v22
    v_cvt_pk_bf16_f32 v49, v86, v87
    v_mfma_f32_16x16x32_bf16 v[124:127], a[224:227], v[72:75], v[124:127]
    ds_read_b128 v[72:75], v1 offset:47104
    v_mul_f32 v24, v24, v88
    v_mfma_f32_16x16x32_bf16 v[124:127], a[236:239], v[76:79], v[124:127]
    s_waitcnt lgkmcnt(3)
    ds_read_b128 v[76:79], v1 offset:48128
    v_mul_f32 v89, v89, v26
    v_mfma_f32_16x16x32_bf16 v[116:119], a[240:243], v[80:83], v[116:119]
    s_waitcnt lgkmcnt(2)
    v_exp_f32_e64 v24, -v24
    v_mfma_f32_16x16x32_bf16 v[116:119], a[252:255], v[68:71], v[116:119]
    v_add_f32 v24, 1.0, v24
    v_fmaak_f32 v25, v89, v89, 0x409d30fc
    v_mfma_f32_16x16x32_bf16 v[120:123], a[244:247], v[80:83], v[120:123]
    buffer_load_dwordx4 v13, s[28:31], s45 offen offset:3072 lds
    v_mfma_f32_16x16x32_bf16 v[120:123], v[160:163], v[68:71], v[120:123]
    v_rcp_f32 v24, v24
    v_mfma_f32_16x16x32_bf16 v[124:127], a[248:251], v[80:83], v[124:127]
    ds_read_b128 v[80:83], v2 offset:16384
    v_mul_f32 v88, v88, v24
    v_mfma_f32_16x16x32_bf16 v[124:127], v[164:167], v[68:71], v[124:127]
    s_waitcnt lgkmcnt(2)
    ds_read_b128 v[68:71], v2 offset:17408
    v_mul_f32 v25, v25, v89
    v_mfma_f32_16x16x32_bf16 v[116:119], v[168:171], v[72:75], v[116:119]
    s_waitcnt lgkmcnt(2)
    buffer_store_dwordx4 v[28:31], v18, s[40:43], s46 offen nt
    v_mfma_f32_16x16x32_bf16 v[116:119], v[180:183], v[76:79], v[116:119]
    v_exp_f32_e64 v25, -v25
    v_mfma_f32_16x16x32_bf16 v[120:123], v[172:175], v[72:75], v[120:123]
    s_sub_u32 s45, s45, 49152
    v_add_f32 v25, 1.0, v25
    v_mul_f32 v90, v90, v26
    v_mfma_f32_16x16x32_bf16 v[120:123], v[184:187], v[76:79], v[120:123]
    s_min_u32 s45, s45, 0x40000000
    v_rcp_f32 v25, v25
    v_mfma_f32_16x16x32_bf16 v[124:127], v[176:179], v[72:75], v[124:127]
    ds_read_b128 v[72:75], v2 offset:18432
    v_mul_f32 v89, v89, v25
    v_mfma_f32_16x16x32_bf16 v[124:127], v[188:191], v[76:79], v[124:127]
    s_waitcnt lgkmcnt(2)
    ds_read_b128 v[76:79], v2 offset:19456
    v_cvt_pk_bf16_f32 v50, v88, v89
    v_mfma_f32_16x16x32_bf16 v[116:119], v[192:195], v[80:83], v[116:119]
    s_waitcnt lgkmcnt(2)
    v_fmaak_f32 v21, v90, v90, 0x409d30fc
    v_mul_f32 v21, v21, v90
    v_mfma_f32_16x16x32_bf16 v[116:119], v[204:207], v[68:71], v[116:119]
    v_exp_f32_e64 v21, -v21
    v_mfma_f32_16x16x32_bf16 v[120:123], v[196:199], v[80:83], v[120:123]
    v_add_f32 v21, 1.0, v21
    v_mul_f32 v91, v91, v26
    v_mfma_f32_16x16x32_bf16 v[120:123], v[208:211], v[68:71], v[120:123]
    v_rcp_f32 v21, v21
    v_mfma_f32_16x16x32_bf16 v[124:127], v[200:203], v[80:83], v[124:127]
    ds_read_b128 v[80:83], v2 offset:20480
    v_mul_f32 v90, v90, v21
    v_mfma_f32_16x16x32_bf16 v[124:127], v[212:215], v[68:71], v[124:127]
    s_waitcnt lgkmcnt(2)
    ds_read_b128 v[68:71], v2 offset:21504
    v_fmaak_f32 v22, v91, v91, 0x409d30fc
    v_mfma_f32_16x16x32_bf16 v[116:119], v[216:219], v[72:75], v[116:119]
    s_waitcnt lgkmcnt(2)
    buffer_store_dwordx4 v[32:35], v19, s[40:43], s46 offen nt
    v_mfma_f32_16x16x32_bf16 v[116:119], v[228:231], v[76:79], v[116:119]
    v_mul_f32 v22, v22, v91
    v_mul_f32 v92, v92, v26
    v_mfma_f32_16x16x32_bf16 v[120:123], v[220:223], v[72:75], v[120:123]
    v_exp_f32_e64 v22, -v22
    v_mfma_f32_16x16x32_bf16 v[120:123], v[232:235], v[76:79], v[120:123]
    v_add_f32 v22, 1.0, v22
    v_fmaak_f32 v24, v92, v92, 0x409d30fc
    v_mfma_f32_16x16x32_bf16 v[124:127], v[224:227], v[72:75], v[124:127]
    ds_read_b128 v[72:75], v2 offset:22528
    v_mul_f32 v24, v24, v92
    v_mfma_f32_16x16x32_bf16 v[124:127], v[236:239], v[76:79], v[124:127]
    s_waitcnt lgkmcnt(2)
    ds_read_b128 v[76:79], v2 offset:23552
    v_mul_f32 v93, v93, v26
    v_mfma_f32_16x16x32_bf16 v[116:119], v[240:243], v[80:83], v[116:119]
    s_waitcnt lgkmcnt(2)
    v_rcp_f32 v22, v22
    v_mfma_f32_16x16x32_bf16 v[116:119], v[252:255], v[68:71], v[116:119]
    v_exp_f32_e64 v24, -v24
    v_mfma_f32_16x16x32_bf16 v[120:123], v[244:247], v[80:83], v[120:123]
    v_mul_f32 v91, v91, v22
    v_cvt_pk_bf16_f32 v51, v90, v91
    v_mfma_f32_16x16x32_bf16 v[120:123], v[128:131], v[68:71], v[120:123]
    v_add_f32 v24, 1.0, v24
    v_fmaak_f32 v25, v93, v93, 0x409d30fc
    v_mfma_f32_16x16x32_bf16 v[124:127], v[248:251], v[80:83], v[124:127]
    ds_read_b128 v[56:59], v3 offset:12544
    v_mul_f32 v25, v25, v93
    v_mfma_f32_16x16x32_bf16 v[124:127], v[132:135], v[68:71], v[124:127]
    s_waitcnt lgkmcnt(2)
    s_add_u32 s46, s46, 6144
    v_rcp_f32 v24, v24
    v_mfma_f32_16x16x32_bf16 v[116:119], v[136:139], v[72:75], v[116:119]
    s_waitcnt lgkmcnt(1)
    ds_read_b128 v[60:63], v4 offset:12544
    v_mul_f32 v92, v92, v24
    v_mfma_f32_16x16x32_bf16 v[116:119], v[148:151], v[76:79], v[116:119]
    v_exp_f32_e64 v25, -v25
    v_mfma_f32_16x16x32_bf16 v[120:123], v[140:143], v[72:75], v[120:123]
    ds_read_b128 v[64:67], v5 offset:12544
    v_add_f32 v25, 1.0, v25
    v_mfma_f32_16x16x32_bf16 v[120:123], v[152:155], v[76:79], v[120:123]
    v_rcp_f32 v25, v25
    v_mfma_f32_16x16x32_bf16 v[124:127], v[144:147], v[72:75], v[124:127]
    v_mul_f32 v93, v93, v25
    v_cvt_pk_bf16_f32 v52, v92, v93
    v_mfma_f32_16x16x32_bf16 v[124:127], v[156:159], v[76:79], v[124:127]
    s_waitcnt lgkmcnt(2)
    v_mul_f32 v94, v94, v26
    v_fmaak_f32 v21, v94, v94, 0x409d30fc
    v_mfma_f32_32x32x16_bf16 v[100:115], a[0:3], v[56:59], 0
    s_waitcnt vmcnt(18)
    s_barrier
    ds_read_b128 v[56:59], v6 offset:12544
    v_mul_f32 v21, v21, v94
    v_exp_f32_e64 v21, -v21
    v_mul_f32 v95, v95, v26
    v_add_f32 v21, 1.0, v21
    s_waitcnt lgkmcnt(2)
    v_mfma_f32_32x32x16_bf16 v[100:115], a[4:7], v[60:63], v[100:115]
    s_waitcnt lgkmcnt(1)
    ds_read_b128 v[60:63], v3 offset:12672
    v_cvt_pk_bf16_f32 v28, v116, v117
    v_cvt_pk_bf16_f32 v29, v118, v119
    v_rcp_f32 v21, v21
    v_fmaak_f32 v22, v95, v95, 0x409d30fc
    v_mfma_f32_32x32x16_bf16 v[100:115], a[8:11], v[64:67], v[100:115]
    s_waitcnt lgkmcnt(1)
    ds_read_b128 v[64:67], v4 offset:12672
    v_cvt_pk_bf16_f32 v30, v120, v121
    v_mul_f32 v94, v94, v21
    v_mul_f32 v22, v22, v95
    v_exp_f32_e64 v22, -v22
    v_mfma_f32_32x32x16_bf16 v[100:115], a[12:15], v[56:59], v[100:115]
    s_waitcnt lgkmcnt(1)
    ds_read_b128 v[68:71], v7 offset:18816
    ds_read_b128 v[56:59], v5 offset:12672
    v_cvt_pk_bf16_f32 v31, v122, v123
    v_cvt_pk_bf16_f32 v32, v124, v125
    v_add_f32 v22, 1.0, v22
    v_mul_f32 v96, v96, v26
    v_mfma_f32_32x32x16_bf16 v[100:115], a[16:19], v[60:63], v[100:115]
    s_waitcnt lgkmcnt(2)
    ds_read_b128 v[72:75], v8 offset:18816
    ds_read_b128 v[60:63], v6 offset:12672
    v_cvt_pk_bf16_f32 v33, v126, v127
    v_rcp_f32 v22, v22
    v_fmaak_f32 v24, v96, v96, 0x409d30fc
    v_mfma_f32_32x32x16_bf16 v[100:115], a[20:23], v[64:67], v[100:115]
    s_waitcnt lgkmcnt(2)
    ds_read_b128 v[76:79], v9 offset:18816
    ds_read_b128 v[64:67], v3 offset:12800
    v_mul_f32 v95, v95, v22
    v_cvt_pk_bf16_f32 v53, v94, v95
    v_mul_f32 v24, v24, v96
    v_mul_f32 v97, v97, v26
    v_mfma_f32_32x32x16_bf16 v[100:115], a[24:27], v[56:59], v[100:115]
    s_waitcnt lgkmcnt(2)
    ds_read_b128 v[80:83], v1 offset:49152
    ds_read_b128 v[56:59], v4 offset:12800
    v_exp_f32_e64 v24, -v24
    v_fmaak_f32 v25, v97, v97, 0x409d30fc
    v_add_f32 v24, 1.0, v24
    v_mfma_f32_32x32x16_bf16 v[100:115], a[28:31], v[60:63], v[100:115]
    ds_read_b128 v[60:63], v5 offset:12800
    v_rcp_f32 v24, v24
    v_mul_f32 v25, v25, v97
    v_exp_f32_e64 v25, -v25
    v_mfma_f32_16x16x32_bf16 v[116:119], v[36:39], v[68:71], 0
    s_waitcnt lgkmcnt(3)
    v_mul_f32 v96, v96, v24
    v_add_f32 v25, 1.0, v25
    v_mfma_f32_32x32x16_bf16 v[100:115], a[32:35], v[64:67], v[100:115]
    ds_read_b128 v[68:71], v1 offset:50176
    ds_read_b128 v[64:67], v6 offset:12800
    v_rcp_f32 v25, v25
    v_mul_f32 v98, v98, v26
    v_mul_f32 v97, v97, v25
    v_mfma_f32_16x16x32_bf16 v[120:123], v[40:43], v[72:75], 0
    s_waitcnt lgkmcnt(3)
    v_cvt_pk_bf16_f32 v54, v96, v97
    v_fmaak_f32 v21, v98, v98, 0x409d30fc
    v_mfma_f32_32x32x16_bf16 v[100:115], a[36:39], v[56:59], v[100:115]
    ds_read_b128 v[72:75], v1 offset:51200
    v_mul_f32 v21, v21, v98
    v_exp_f32_e64 v21, -v21
    v_mul_f32 v99, v99, v26
    v_add_f32 v21, 1.0, v21
    v_mfma_f32_16x16x32_bf16 v[124:127], v[44:47], v[76:79], 0
    s_waitcnt lgkmcnt(3)
    v_rcp_f32 v21, v21
    v_mfma_f32_32x32x16_bf16 v[100:115], a[40:43], v[60:63], v[100:115]
    s_waitcnt lgkmcnt(1)
    ds_read_b128 v[76:79], v1 offset:52224
    v_mul_f32 v98, v98, v21
    v_fmaak_f32 v22, v99, v99, 0x409d30fc
    v_mul_f32 v22, v22, v99
    v_exp_f32_e64 v22, -v22
    v_mfma_f32_32x32x16_bf16 v[100:115], a[44:47], v[64:67], v[100:115]
    ds_write_b128 v14, v[48:51] offset:1024
    v_add_f32 v22, 1.0, v22
    v_mfma_f32_16x16x32_bf16 v[116:119], a[96:99], v[80:83], v[116:119]
    s_add_u32 m0, s48, 32768
    v_add_u32 v7, s50, v7
    v_rcp_f32 v22, v22
    v_mfma_f32_16x16x32_bf16 v[116:119], a[108:111], v[68:71], v[116:119]
    v_add_u32 v8, s50, v8
    v_mul_f32 v99, v99, v22
    v_cvt_pk_bf16_f32 v55, v98, v99
    v_mfma_f32_16x16x32_bf16 v[120:123], a[100:103], v[80:83], v[120:123]
    ds_write_b128 v14, v[52:55] offset:1536
    v_mfma_f32_16x16x32_bf16 v[120:123], a[112:115], v[68:71], v[120:123]
    buffer_load_dwordx4 v13, s[28:31], s45 offen offset:0 lds
    v_mfma_f32_16x16x32_bf16 v[124:127], a[104:107], v[80:83], v[124:127]
    ds_read_b128 v[80:83], v1 offset:53248
    v_add_u32 v9, s50, v9
    v_mfma_f32_16x16x32_bf16 v[124:127], a[116:119], v[68:71], v[124:127]
    s_waitcnt vmcnt(11) lgkmcnt(4)
    ds_read_b128 v[68:71], v1 offset:54272
    v_mul_f32 v100, v100, v27
    v_fmaak_f32 v24, v100, v100, 0x409d30fc
    v_mul_f32 v24, v24, v100
    v_mul_f32 v101, v101, v27
    v_fmaak_f32 v25, v101, v101, 0x409d30fc
    v_mul_f32 v25, v25, v101
    v_mul_f32 v102, v102, v27
    v_fmaak_f32 v21, v102, v102, 0x409d30fc
    v_mul_f32 v21, v21, v102
    v_mul_f32 v103, v103, v27
    v_fmaak_f32 v22, v103, v103, 0x409d30fc
    v_mul_f32 v22, v22, v103
    v_mfma_f32_16x16x32_bf16 v[116:119], a[120:123], v[72:75], v[116:119]
    s_waitcnt lgkmcnt(4)
    v_exp_f32_e64 v24, -v24
    v_mfma_f32_16x16x32_bf16 v[116:119], a[132:135], v[76:79], v[116:119]
    ds_write_b64 v15, v[28:29] offset:0
    v_mfma_f32_16x16x32_bf16 v[120:123], a[124:127], v[72:75], v[120:123]
    v_exp_f32_e64 v25, -v25
    v_mfma_f32_16x16x32_bf16 v[120:123], a[136:139], v[76:79], v[120:123]
    v_exp_f32_e64 v21, -v21
    v_mfma_f32_16x16x32_bf16 v[124:127], a[128:131], v[72:75], v[124:127]
    ds_read_b128 v[72:75], v1 offset:55296
    v_add_f32 v24, 1.0, v24
    v_mfma_f32_16x16x32_bf16 v[124:127], a[140:143], v[76:79], v[124:127]
    s_waitcnt lgkmcnt(3)
    ds_read_b128 v[76:79], v1 offset:56320
    v_add_f32 v25, 1.0, v25
    v_mfma_f32_16x16x32_bf16 v[116:119], a[144:147], v[80:83], v[116:119]
    s_waitcnt lgkmcnt(3)
    v_rcp_f32 v24, v24
    v_mfma_f32_16x16x32_bf16 v[116:119], a[156:159], v[68:71], v[116:119]
    ds_write_b64 v15, v[30:31] offset:32
    v_mfma_f32_16x16x32_bf16 v[120:123], a[148:151], v[80:83], v[120:123]
    buffer_load_dwordx4 v13, s[28:31], s45 offen offset:1024 lds
    v_mfma_f32_16x16x32_bf16 v[120:123], a[160:163], v[68:71], v[120:123]
    v_rcp_f32 v25, v25
    v_mfma_f32_16x16x32_bf16 v[124:127], a[152:155], v[80:83], v[124:127]
    ds_read_b128 v[80:83], v1 offset:57344
    v_mul_f32 v100, v100, v24
    v_mfma_f32_16x16x32_bf16 v[124:127], a[164:167], v[68:71], v[124:127]
    s_waitcnt lgkmcnt(3)
    ds_read_b128 v[68:71], v1 offset:58368
    v_mul_f32 v101, v101, v25
    v_mfma_f32_16x16x32_bf16 v[116:119], a[168:171], v[72:75], v[116:119]
    s_waitcnt lgkmcnt(3)
    v_exp_f32_e64 v22, -v22
    v_mfma_f32_16x16x32_bf16 v[116:119], a[180:183], v[76:79], v[116:119]
    ds_write_b64 v15, v[32:33] offset:64
    v_mfma_f32_16x16x32_bf16 v[120:123], a[172:175], v[72:75], v[120:123]
    v_cvt_pk_bf16_f32 v48, v100, v101
    v_add_f32 v21, 1.0, v21
    v_mfma_f32_16x16x32_bf16 v[120:123], a[184:187], v[76:79], v[120:123]
    v_rcp_f32 v21, v21
    v_mfma_f32_16x16x32_bf16 v[124:127], a[176:179], v[72:75], v[124:127]
    ds_read_b128 v[72:75], v1 offset:59392
    v_mul_f32 v102, v102, v21
    v_mfma_f32_16x16x32_bf16 v[124:127], a[188:191], v[76:79], v[124:127]
    s_waitcnt lgkmcnt(3)
    ds_read_b128 v[76:79], v1 offset:60416
    v_add_f32 v22, 1.0, v22
    v_mfma_f32_16x16x32_bf16 v[116:119], a[192:195], v[80:83], v[116:119]
    s_waitcnt lgkmcnt(3)
    v_rcp_f32 v22, v22
    v_mfma_f32_16x16x32_bf16 v[116:119], a[204:207], v[68:71], v[116:119]
    ds_read_b128 v[28:31], v16 offset:6400
    v_mul_f32 v103, v103, v22
    v_mfma_f32_16x16x32_bf16 v[120:123], a[196:199], v[80:83], v[120:123]
    buffer_load_dwordx4 v13, s[28:31], s45 offen offset:2048 lds
    v_mfma_f32_16x16x32_bf16 v[120:123], a[208:211], v[68:71], v[120:123]
    v_cvt_pk_bf16_f32 v49, v102, v103
    v_mul_f32 v104, v104, v27
    v_mfma_f32_16x16x32_bf16 v[124:127], a[200:203], v[80:83], v[124:127]
    ds_read_b128 v[80:83], v1 offset:61440
    ds_read_b128 v[32:35], v17 offset:6400
    v_mfma_f32_16x16x32_bf16 v[124:127], a[212:215], v[68:71], v[124:127]
    s_waitcnt lgkmcnt(4)
    ds_read_b128 v[68:71], v1 offset:62464
    v_fmaak_f32 v24, v104, v104, 0x409d30fc
    v_mfma_f32_16x16x32_bf16 v[116:119], a[216:219], v[72:75], v[116:119]
    s_waitcnt lgkmcnt(4)
    v_mul_f32 v24, v24, v104
    v_mul_f32 v105, v105, v27
    v_mfma_f32_16x16x32_bf16 v[116:119], a[228:231], v[76:79], v[116:119]
    v_exp_f32_e64 v24, -v24
    v_mfma_f32_16x16x32_bf16 v[120:123], a[220:223], v[72:75], v[120:123]
    v_add_f32 v24, 1.0, v24
    v_fmaak_f32 v25, v105, v105, 0x409d30fc
    v_mfma_f32_16x16x32_bf16 v[120:123], a[232:235], v[76:79], v[120:123]
    v_rcp_f32 v24, v24
    v_mfma_f32_16x16x32_bf16 v[124:127], a[224:227], v[72:75], v[124:127]
    ds_read_b128 v[72:75], v1 offset:63488
    v_mul_f32 v104, v104, v24
    v_mfma_f32_16x16x32_bf16 v[124:127], a[236:239], v[76:79], v[124:127]
    s_waitcnt lgkmcnt(3)
    ds_read_b128 v[76:79], v1 offset:64512
    v_mul_f32 v25, v25, v105
    v_mfma_f32_16x16x32_bf16 v[116:119], a[240:243], v[80:83], v[116:119]
    s_waitcnt lgkmcnt(2)
    v_exp_f32_e64 v25, -v25
    v_mfma_f32_16x16x32_bf16 v[116:119], a[252:255], v[68:71], v[116:119]
    v_add_f32 v25, 1.0, v25
    v_mul_f32 v106, v106, v27
    v_mfma_f32_16x16x32_bf16 v[120:123], a[244:247], v[80:83], v[120:123]
    buffer_load_dwordx4 v13, s[28:31], s45 offen offset:3072 lds
    v_mfma_f32_16x16x32_bf16 v[120:123], v[160:163], v[68:71], v[120:123]
    v_rcp_f32 v25, v25
    v_mfma_f32_16x16x32_bf16 v[124:127], a[248:251], v[80:83], v[124:127]
    ds_read_b128 v[80:83], v2 offset:24576
    v_mul_f32 v105, v105, v25
    v_mfma_f32_16x16x32_bf16 v[124:127], v[164:167], v[68:71], v[124:127]
    s_waitcnt lgkmcnt(2)
    ds_read_b128 v[68:71], v2 offset:25600
    v_cvt_pk_bf16_f32 v50, v104, v105
    v_mfma_f32_16x16x32_bf16 v[116:119], v[168:171], v[72:75], v[116:119]
    s_waitcnt lgkmcnt(2)
    buffer_store_dwordx4 v[28:31], v18, s[40:43], s46 offen nt
    v_mfma_f32_16x16x32_bf16 v[116:119], v[180:183], v[76:79], v[116:119]
    v_fmaak_f32 v21, v106, v106, 0x409d30fc
    v_mul_f32 v21, v21, v106
    v_mfma_f32_16x16x32_bf16 v[120:123], v[172:175], v[72:75], v[120:123]
    s_add_u32 s45, s45, 16384
    v_exp_f32_e64 v21, -v21
    v_mfma_f32_16x16x32_bf16 v[120:123], v[184:187], v[76:79], v[120:123]
    v_add_f32 v21, 1.0, v21
    v_mul_f32 v107, v107, v27
    v_mfma_f32_16x16x32_bf16 v[124:127], v[176:179], v[72:75], v[124:127]
    ds_read_b128 v[72:75], v2 offset:26624
    v_fmaak_f32 v22, v107, v107, 0x409d30fc
    v_mfma_f32_16x16x32_bf16 v[124:127], v[188:191], v[76:79], v[124:127]
    s_waitcnt lgkmcnt(2)
    ds_read_b128 v[76:79], v2 offset:27648
    v_mul_f32 v22, v22, v107
    v_mfma_f32_16x16x32_bf16 v[116:119], v[192:195], v[80:83], v[116:119]
    s_waitcnt lgkmcnt(2)
    v_rcp_f32 v21, v21
    v_mfma_f32_16x16x32_bf16 v[116:119], v[204:207], v[68:71], v[116:119]
    v_exp_f32_e64 v22, -v22
    v_mfma_f32_16x16x32_bf16 v[120:123], v[196:199], v[80:83], v[120:123]
    buffer_load_dword v26, v20, s[32:35], s47 offen
    v_mfma_f32_16x16x32_bf16 v[120:123], v[208:211], v[68:71], v[120:123]
    v_mul_f32 v106, v106, v21
    v_add_f32 v22, 1.0, v22
    v_mfma_f32_16x16x32_bf16 v[124:127], v[200:203], v[80:83], v[124:127]
    ds_read_b128 v[80:83], v2 offset:28672
    v_mul_f32 v108, v108, v27
    v_mfma_f32_16x16x32_bf16 v[124:127], v[212:215], v[68:71], v[124:127]
    s_waitcnt lgkmcnt(2)
    s_sub_u32 s47, s47, 128
    ds_read_b128 v[68:71], v2 offset:29696
    v_fmaak_f32 v24, v108, v108, 0x409d30fc
    v_mfma_f32_16x16x32_bf16 v[116:119], v[216:219], v[72:75], v[116:119]
    s_waitcnt lgkmcnt(2)
    s_min_u32 s47, s47, 0x40000000
    buffer_store_dwordx4 v[32:35], v19, s[40:43], s46 offen nt
    v_mfma_f32_16x16x32_bf16 v[116:119], v[228:231], v[76:79], v[116:119]
    v_rcp_f32 v22, v22
    v_mfma_f32_16x16x32_bf16 v[120:123], v[220:223], v[72:75], v[120:123]
    v_mul_f32 v107, v107, v22
    v_cvt_pk_bf16_f32 v51, v106, v107
    v_mfma_f32_16x16x32_bf16 v[120:123], v[232:235], v[76:79], v[120:123]
    v_mul_f32 v24, v24, v108
    v_mul_f32 v109, v109, v27
    v_mfma_f32_16x16x32_bf16 v[124:127], v[224:227], v[72:75], v[124:127]
    ds_read_b128 v[72:75], v2 offset:30720
    v_fmaak_f32 v25, v109, v109, 0x409d30fc
    v_mfma_f32_16x16x32_bf16 v[124:127], v[236:239], v[76:79], v[124:127]
    s_waitcnt lgkmcnt(2)
    ds_read_b128 v[76:79], v2 offset:31744
    v_mul_f32 v25, v25, v109
    v_mfma_f32_16x16x32_bf16 v[116:119], v[240:243], v[80:83], v[116:119]
    s_waitcnt lgkmcnt(2)
    v_exp_f32_e64 v24, -v24
    v_mfma_f32_16x16x32_bf16 v[116:119], v[252:255], v[68:71], v[116:119]
    v_exp_f32_e64 v25, -v25
    v_mfma_f32_16x16x32_bf16 v[120:123], v[244:247], v[80:83], v[120:123]
    v_add_f32 v24, 1.0, v24
    v_add_f32 v25, 1.0, v25
    v_mfma_f32_16x16x32_bf16 v[120:123], v[128:131], v[68:71], v[120:123]
    s_sub_u32 s50, 0, s50
    v_rcp_f32 v24, v24
    v_mfma_f32_16x16x32_bf16 v[124:127], v[248:251], v[80:83], v[124:127]
    ds_read_b128 v[56:59], v3 offset:12544
    v_mul_f32 v108, v108, v24
    v_mfma_f32_16x16x32_bf16 v[124:127], v[132:135], v[68:71], v[124:127]
    s_waitcnt lgkmcnt(2)
    s_sub_u32 s46, s46, 18432
    v_rcp_f32 v25, v25
    v_mfma_f32_16x16x32_bf16 v[116:119], v[136:139], v[72:75], v[116:119]
    s_waitcnt lgkmcnt(1)
    s_sub_u32 s52, s53, s52
    ds_read_b128 v[60:63], v4 offset:12544
    v_mul_f32 v109, v109, v25
    v_mfma_f32_16x16x32_bf16 v[116:119], v[148:151], v[76:79], v[116:119]
    v_cvt_pk_bf16_f32 v52, v108, v109
    v_mul_f32 v110, v110, v27
    v_mfma_f32_16x16x32_bf16 v[120:123], v[140:143], v[72:75], v[120:123]
    ds_read_b128 v[64:67], v5 offset:12544
    v_fmaak_f32 v21, v110, v110, 0x409d30fc
    v_mfma_f32_16x16x32_bf16 v[120:123], v[152:155], v[76:79], v[120:123]
    v_mul_f32 v21, v21, v110
    v_mul_f32 v111, v111, v27
    v_mfma_f32_16x16x32_bf16 v[124:127], v[144:147], v[72:75], v[124:127]
    s_sub_u32 s51, s51, 1
    v_exp_f32_e64 v21, -v21
    v_mfma_f32_16x16x32_bf16 v[124:127], v[156:159], v[76:79], v[124:127]
    v_add_f32 v21, 1.0, v21
    v_fmaak_f32 v22, v111, v111, 0x409d30fc
    s_cmp_lg_u32 s51, 0
    s_cbranch_scc1 L3_loop
    s_barrier
    v_cvt_pk_bf16_f32 v28, v116, v117
    v_cvt_pk_bf16_f32 v29, v118, v119
    v_cvt_pk_bf16_f32 v30, v120, v121
    v_cvt_pk_bf16_f32 v31, v122, v123
    v_cvt_pk_bf16_f32 v32, v124, v125
    v_cvt_pk_bf16_f32 v33, v126, v127
    ds_write_b64 v15, v[28:29] offset:6400
    ds_write_b64 v15, v[30:31] offset:6432
    ds_write_b64 v15, v[32:33] offset:6464
    ds_read_b128 v[28:31], v16 offset:0
    ds_read_b128 v[32:35], v17 offset:0
    s_waitcnt lgkmcnt(1)
    buffer_store_dwordx4 v[28:31], v18, s[40:43], s46 offen nt
    s_waitcnt lgkmcnt(0)
    buffer_store_dwordx4 v[32:35], v19, s[40:43], s46 offen nt
    s_add_u32 s46, s46, 6144
    s_barrier
    ds_read_b128 v[28:31], v16 offset:6400
    ds_read_b128 v[32:35], v17 offset:6400
    s_waitcnt lgkmcnt(1)
    buffer_store_dwordx4 v[28:31], v18, s[40:43], s46 offen nt
    s_waitcnt lgkmcnt(0)
    buffer_store_dwordx4 v[32:35], v19, s[40:43], s46 offen nt
L_end:
    s_endpgm
L1_sig:
    s_cmp_eq_u32 s78, 524288
    s_cbranch_scc1 L1_sig2
    v_mov_b32 v60, 1
    v_mov_b32 v61, 0
    s_mov_b64 exec, 1
    buffer_atomic_add v60, v61, s[56:59], s79 offen
    s_mov_b64 exec, -1
    s_mov_b32 s78, 524288
    s_branch L1_back
L1_sig2:
    s_load_dwordx8 s[8:15], s[56:57], 128
    s_load_dword s85, s[56:57], s6
    s_load_dwordx4 s[72:75], s[0:1], 32
    s_load_dwordx2 s[76:77], s[0:1], 48
    s_branch L1_back
L_code_end:
.section .rodata,"a"
.p2align 6
.amdhsa_kernel standalone__modern_conv_block_convnext_v2__vision_kernel
  .amdhsa_next_free_vgpr 512
  .amdhsa_next_free_sgpr 102
  .amdhsa_accum_offset 256
  .amdhsa_group_segment_fixed_size 0
  .amdhsa_kernarg_size 72
  .amdhsa_user_sgpr_count 2
  .amdhsa_user_sgpr_kernarg_segment_ptr 1
  .amdhsa_system_sgpr_workgroup_id_x 1
  .amdhsa_float_denorm_mode_32 3
.end_amdhsa_kernel
```
